```python
import torch

def _softmax(x, axis=-1):
    return torch.softmax(x, dim=axis)
def _gelu(x):
    return torch.nn.functional.gelu(x, approximate="tanh")
def _silu(x):
    return torch.nn.functional.silu(x)
def _sigmoid(x):
    return torch.sigmoid(x)
def _layernorm(x, axis=-1, eps=1e-5):
    m = x.mean(dim=axis, keepdim=True)
    v = x.var(dim=axis, keepdim=True, unbiased=False)
    return (x - m) / torch.sqrt(v + eps)
def _scatter_add(tgt, idx, src, axis=0):
    return tgt.clone().index_add_(axis, idx, src)
def _segment_sum(src, seg, n):
    out = torch.zeros((n,) + src.shape[1:], dtype=src.dtype)
    return out.index_add_(0, seg, src)
def _pad(x, pw):
    flat = tuple(v for pair in reversed(pw) for v in pair)
    return torch.nn.functional.pad(x, flat)

kernel_name = 'parallel_sum__mha_block__geglu_ffn__prompt'

def setup_inputs():

    _w = (lambda a: (lambda t: t.to(torch.bfloat16) if t.is_floating_point() else t)(torch.as_tensor(a)))
    def _A_setup():
        B, S, D, H = 1, 2048, 512, 32
        return {
            "x": _w((lambda *s: torch.randn(*s, dtype=torch.bfloat16) * 0.05)(B, S, D)),
            "wqkv": _w((lambda *s: torch.randn(*s, dtype=torch.bfloat16) * 0.2)(D, 3 * D)),
            "wo": _w((lambda *s: torch.randn(*s, dtype=torch.bfloat16) * 0.1)(D, D)),
        }
    _A_in = _A_setup()

    def _B_setup():
        B, S, D, F = 1, 2048, 512, 1376
        return {
            "x": _w((lambda *s: torch.randn(*s, dtype=torch.bfloat16) * 0.05)(B, S, D)),
            "w_gate": _w((lambda *s: torch.randn(*s, dtype=torch.bfloat16) * 0.1)(D, F)),
            "w_up": _w((lambda *s: torch.randn(*s, dtype=torch.bfloat16) * 0.1)(D, F)),
            "w_down": _w((lambda *s: torch.randn(*s, dtype=torch.bfloat16) * 0.1)(F, D)),
        }
    _B_in = _B_setup()

    return {
        "A_x": _A_in["x"],
        "A_wqkv": _A_in["wqkv"],
        "A_wo": _A_in["wo"],
        "B_x": _B_in["x"],
        "B_w_gate": _B_in["w_gate"],
        "B_w_up": _B_in["w_up"],
        "B_w_down": _B_in["w_down"],
    }

def reference(A_x, A_wqkv, A_wo, B_x, B_w_gate, B_w_up, B_w_down):
    def _A_ref(x, wqkv, wo):
        B, S, D = x.shape
        H = 32
        Dh = D // H
        qkv = (lambda x, *d: x.permute(*d))((x @ wqkv).reshape(B, S, 3, H, Dh), 2, 0, 3, 1, 4)
        q, k, v = qkv[0], qkv[1], qkv[2]
        scores = torch.einsum("bhqd,bhkd->bhqk", q, k) * (Dh ** -0.5)
        p = _softmax(scores, axis=-1)
        o = torch.einsum("bhqk,bhkd->bhqd", p, v)
        return (lambda x, *d: x.permute(*d))(o, 0, 2, 1, 3).reshape(B, S, D) @ wo

    def _B_ref(x, w_gate, w_up, w_down):
        return (_gelu(x @ w_gate) * (x @ w_up)) @ w_down

    x = A_x
    xn = _layernorm(x, axis=-1)
    return x + _A_ref(xn, A_wqkv, A_wo) + _B_ref(xn, B_w_gate, B_w_up, B_w_down)
```

```asm
; @launch grid=(256,1,1) block=(768,1,1) lds=163840
.amdgcn_target "amdgcn-amd-amdhsa--gfx950"
.text
.globl parallel_sum__mha_block__geglu_ffn__prompt_kernel
.p2align 8
.type parallel_sum__mha_block__geglu_ffn__prompt_kernel,@function
parallel_sum__mha_block__geglu_ffn__prompt_kernel:
    s_load_dwordx2 s[24:25], s[0:1], 0
    s_load_dwordx2 s[28:29], s[0:1], 8
    s_load_dwordx2 s[32:33], s[0:1], 72
    s_load_dwordx2 s[56:57], s[0:1], 64
    s_load_dwordx2 s[36:37], s[0:1], 32
    s_load_dwordx2 s[40:41], s[0:1], 40
    s_cmp_ge_u32 s2, 256
    s_cbranch_scc1 L_end
    s_getpc_b64 s[8:9]
L_pc:
    s_bfe_u32 s10, s2, 327683
    s_mul_i32 s10, s10, 1280
    v_min_u32 v166, 9, v0
    v_lshl_add_u32 v166, v166, 7, s10
    v_min_u32 v166, L_last-L_pc, v166
    v_mov_b32 v167, s9
    v_add_co_u32 v166, vcc, s8, v166
    v_addc_co_u32 v167, vcc, 0, v167, vcc
    global_load_dword v167, v[166:167], off
    v_lshrrev_b32 v96, 6, v0
    v_and_b32 v1, 63, v0
    v_readfirstlane_b32 s3, v96
    s_and_b32 s4, s2, 1
    s_lshl_b32 s4, s4, 4
    s_bfe_u32 s8, s2, 0x40003
    s_add_u32 s4, s4, s8
    s_and_b32 s5, s2, 6
    s_lshr_b32 s8, s2, 7
    s_add_u32 s5, s5, s8
    s_lshl_b32 s8, s5, 1
    s_add_u32 s10, s4, s8
    s_and_b32 s10, s10, 7
    s_mov_b32 s26, 2097152
    s_mov_b32 s27, 0x20000
    s_mov_b32 s30, 1572864
    s_mov_b32 s31, 0x20000
    s_mov_b32 s34, 17825792
    s_mov_b32 s35, 0x20000
    s_mov_b32 s58, 256
    s_mov_b32 s59, 0x20000
    v_lshlrev_b32 v2, 4, v1
    v_mov_b32 v6, 0
    s_and_b32 s17, s3, 1
    s_cmp_ge_u32 s3, 8
    s_cbranch_scc1 L_ffn
    v_lshrrev_b32 v96, 3, v0
    v_and_b32 v97, 7, v0
    v_lshlrev_b32 v98, 4, v97
    v_lshl_add_u32 v157, v96, 10, v98
    s_lshl_b32 s12, s4, 16
    s_cmp_ge_u32 s3, 4
    s_cbranch_scc1 L_a_su
L_a_ld:
    s_waitcnt lgkmcnt(0)
    buffer_load_dwordx4 v[8:11], v157, s[24:27], s12 offen offset:0
    buffer_load_dwordx4 v[12:15], v157, s[24:27], s12 offen offset:128
    buffer_load_dwordx4 v[16:19], v157, s[24:27], s12 offen offset:256
    buffer_load_dwordx4 v[20:23], v157, s[24:27], s12 offen offset:384
    buffer_load_dwordx4 v[24:27], v157, s[24:27], s12 offen offset:512
    buffer_load_dwordx4 v[28:31], v157, s[24:27], s12 offen offset:640
    buffer_load_dwordx4 v[32:35], v157, s[24:27], s12 offen offset:768
    buffer_load_dwordx4 v[36:39], v157, s[24:27], s12 offen offset:896
    s_cmp_ge_u32 s3, 4
    s_cbranch_scc1 L_a_bar
L_a_su:
    s_and_b32 s18, s3, 3
    s_lshl_b32 s19, s5, 2
    s_add_u32 s19, s19, s18
    s_lshl_b32 s20, s4, 1
    s_mul_i32 s8, s20, 118
    s_add_u32 s8, s8, s19
    s_lshl_b32 s8, s8, 10
    s_add_u32 s15, s8, 8388608
    v_mov_b64 v[40:41], -1
    v_mov_b64 v[42:43], -1
    v_mov_b32 v159, 0x4091afa4
    s_lshl_b32 s23, s19, 5
    s_add_u32 s23, s23, s4
    s_lshl_b32 s23, s23, 8
    s_add_u32 s23, s23, 7340032
    v_lshlrev_b32 v158, 2, v1
    s_mul_i32 s21, s19, 196608
    s_mul_i32 s20, s20, 3072
    s_add_u32 s21, s21, s20
    v_bfe_u32 v98, v0, 4, 3
    v_xor_b32 v98, v98, v97
    v_lshlrev_b32 v98, 4, v98
    v_lshl_add_u32 v156, v96, 7, v98
    v_and_b32 v96, 15, v1
    v_lshrrev_b32 v97, 4, v1
    v_bfe_u32 v98, v1, 1, 3
    v_xor_b32 v98, v98, v97
    v_lshlrev_b32 v98, 4, v98
    v_lshl_add_u32 v98, v96, 7, v98
    s_mov_b32 s8, 0
    s_and_b32 s9, s10, 7
    s_lshl_b32 s9, s9, 13
    s_add_u32 s8, s8, s9
    s_movk_i32 s14, 0x2000
    v_add_u32 v152, s8, v98
    v_xor_b32 v153, 64, v152
    v_mul_u32_u24 v98, 3072, v97
    v_bfe_u32 v99, v1, 2, 2
    v_lshl_add_u32 v98, v99, 7, v98
    v_bfe_u32 v99, v1, 3, 2
    v_xor_b32 v99, s18, v99
    v_lshl_add_u32 v98, v99, 5, v98
    v_and_b32 v99, 3, v1
    v_lshl_add_u32 v98, v99, 3, v98
    v_add_u32 v154, 65536, v98
    v_add_u32 v155, 114688, v98
    s_waitcnt lgkmcnt(0)
    s_lshl_b32 s8, s5, 10
    s_add_u32 s8, s8, 17039360
    s_add_u32 s36, s32, s8
    s_addc_u32 s37, s33, 0
    s_bfe_u32 s8, s2, 0x30002
    s_lshl_b32 s8, s8, 3
    s_lshr_b32 s9, s2, 5
    s_and_b32 s9, s9, 7
    s_add_u32 s8, s8, s9
    s_lshl_b32 s8, s8, 7
    s_add_u32 s8, s8, 17039360
    s_add_u32 s38, s32, s8
    s_addc_u32 s39, s33, 0
    s_mov_b32 s40, 1
    s_mov_b32 s41, 1
    s_mov_b32 s42, 1
    s_mov_b32 s43, 1
    s_mov_b32 s44, 1
    s_mov_b32 s45, 1
    s_mov_b32 s46, 1
    s_mov_b32 s47, 1
    v_mov_b64 v[160:161], 0
    v_mov_b64 v[162:163], 0
    s_mov_b32 s16, 0x3f803f80
    s_setprio 3
    s_cmp_ge_u32 s3, 4
    s_cbranch_scc1 L_a_ld
    s_branch L_a_nopois
L_a_bar:
    s_barrier
L_a_nopois:
    s_cbranch_scc1 L_a_xb
    s_barrier
L_a_xb:
    s_waitcnt vmcnt(7)
    v_dot2c_f32_bf16 v160, s16, v8
    v_dot2c_f32_bf16 v162, v8, v8
    v_dot2c_f32_bf16 v161, s16, v9
    v_dot2c_f32_bf16 v163, v9, v9
    v_dot2c_f32_bf16 v160, s16, v10
    v_dot2c_f32_bf16 v162, v10, v10
    v_dot2c_f32_bf16 v161, s16, v11
    v_dot2c_f32_bf16 v163, v11, v11
    v_lshlrev_b32 v48, 16, v8
    v_and_b32 v49, 0xffff0000, v8
    v_lshlrev_b32 v50, 16, v9
    v_and_b32 v51, 0xffff0000, v9
    v_lshlrev_b32 v52, 16, v10
    v_and_b32 v53, 0xffff0000, v10
    v_lshlrev_b32 v54, 16, v11
    v_and_b32 v55, 0xffff0000, v11
    s_waitcnt vmcnt(6)
    v_dot2c_f32_bf16 v160, s16, v12
    v_dot2c_f32_bf16 v162, v12, v12
    v_dot2c_f32_bf16 v161, s16, v13
    v_dot2c_f32_bf16 v163, v13, v13
    v_dot2c_f32_bf16 v160, s16, v14
    v_dot2c_f32_bf16 v162, v14, v14
    v_dot2c_f32_bf16 v161, s16, v15
    v_dot2c_f32_bf16 v163, v15, v15
    v_lshlrev_b32 v56, 16, v12
    v_and_b32 v57, 0xffff0000, v12
    v_lshlrev_b32 v58, 16, v13
    v_and_b32 v59, 0xffff0000, v13
    v_lshlrev_b32 v60, 16, v14
    v_and_b32 v61, 0xffff0000, v14
    v_lshlrev_b32 v62, 16, v15
    v_and_b32 v63, 0xffff0000, v15
    s_waitcnt vmcnt(5)
    v_dot2c_f32_bf16 v160, s16, v16
    v_dot2c_f32_bf16 v162, v16, v16
    v_dot2c_f32_bf16 v161, s16, v17
    v_dot2c_f32_bf16 v163, v17, v17
    v_dot2c_f32_bf16 v160, s16, v18
    v_dot2c_f32_bf16 v162, v18, v18
    v_dot2c_f32_bf16 v161, s16, v19
    v_dot2c_f32_bf16 v163, v19, v19
    v_lshlrev_b32 v64, 16, v16
    v_and_b32 v65, 0xffff0000, v16
    v_lshlrev_b32 v66, 16, v17
    v_and_b32 v67, 0xffff0000, v17
    v_lshlrev_b32 v68, 16, v18
    v_and_b32 v69, 0xffff0000, v18
    v_lshlrev_b32 v70, 16, v19
    v_and_b32 v71, 0xffff0000, v19
    s_waitcnt vmcnt(4)
    v_dot2c_f32_bf16 v160, s16, v20
    v_dot2c_f32_bf16 v162, v20, v20
    v_dot2c_f32_bf16 v161, s16, v21
    v_dot2c_f32_bf16 v163, v21, v21
    v_dot2c_f32_bf16 v160, s16, v22
    v_dot2c_f32_bf16 v162, v22, v22
    v_dot2c_f32_bf16 v161, s16, v23
    v_dot2c_f32_bf16 v163, v23, v23
    v_lshlrev_b32 v72, 16, v20
    v_and_b32 v73, 0xffff0000, v20
    v_lshlrev_b32 v74, 16, v21
    v_and_b32 v75, 0xffff0000, v21
    v_lshlrev_b32 v76, 16, v22
    v_and_b32 v77, 0xffff0000, v22
    v_lshlrev_b32 v78, 16, v23
    v_and_b32 v79, 0xffff0000, v23
    s_waitcnt vmcnt(3)
    v_dot2c_f32_bf16 v160, s16, v24
    v_dot2c_f32_bf16 v162, v24, v24
    v_dot2c_f32_bf16 v161, s16, v25
    v_dot2c_f32_bf16 v163, v25, v25
    v_dot2c_f32_bf16 v160, s16, v26
    v_dot2c_f32_bf16 v162, v26, v26
    v_dot2c_f32_bf16 v161, s16, v27
    v_dot2c_f32_bf16 v163, v27, v27
    v_lshlrev_b32 v80, 16, v24
    v_and_b32 v81, 0xffff0000, v24
    v_lshlrev_b32 v82, 16, v25
    v_and_b32 v83, 0xffff0000, v25
    v_lshlrev_b32 v84, 16, v26
    v_and_b32 v85, 0xffff0000, v26
    v_lshlrev_b32 v86, 16, v27
    v_and_b32 v87, 0xffff0000, v27
    s_waitcnt vmcnt(2)
    v_dot2c_f32_bf16 v160, s16, v28
    v_dot2c_f32_bf16 v162, v28, v28
    v_dot2c_f32_bf16 v161, s16, v29
    v_dot2c_f32_bf16 v163, v29, v29
    v_dot2c_f32_bf16 v160, s16, v30
    v_dot2c_f32_bf16 v162, v30, v30
    v_dot2c_f32_bf16 v161, s16, v31
    v_dot2c_f32_bf16 v163, v31, v31
    v_lshlrev_b32 v88, 16, v28
    v_and_b32 v89, 0xffff0000, v28
    v_lshlrev_b32 v90, 16, v29
    v_and_b32 v91, 0xffff0000, v29
    v_lshlrev_b32 v92, 16, v30
    v_and_b32 v93, 0xffff0000, v30
    v_lshlrev_b32 v94, 16, v31
    v_and_b32 v95, 0xffff0000, v31
    s_waitcnt vmcnt(1)
    v_dot2c_f32_bf16 v160, s16, v32
    v_dot2c_f32_bf16 v162, v32, v32
    v_dot2c_f32_bf16 v161, s16, v33
    v_dot2c_f32_bf16 v163, v33, v33
    v_dot2c_f32_bf16 v160, s16, v34
    v_dot2c_f32_bf16 v162, v34, v34
    v_dot2c_f32_bf16 v161, s16, v35
    v_dot2c_f32_bf16 v163, v35, v35
    v_lshlrev_b32 v96, 16, v32
    v_and_b32 v97, 0xffff0000, v32
    v_lshlrev_b32 v98, 16, v33
    v_and_b32 v99, 0xffff0000, v33
    v_lshlrev_b32 v100, 16, v34
    v_and_b32 v101, 0xffff0000, v34
    v_lshlrev_b32 v102, 16, v35
    v_and_b32 v103, 0xffff0000, v35
    s_waitcnt vmcnt(0)
    v_dot2c_f32_bf16 v160, s16, v36
    v_dot2c_f32_bf16 v162, v36, v36
    v_dot2c_f32_bf16 v161, s16, v37
    v_dot2c_f32_bf16 v163, v37, v37
    v_dot2c_f32_bf16 v160, s16, v38
    v_dot2c_f32_bf16 v162, v38, v38
    v_dot2c_f32_bf16 v161, s16, v39
    v_dot2c_f32_bf16 v163, v39, v39
    v_lshlrev_b32 v104, 16, v36
    v_and_b32 v105, 0xffff0000, v36
    v_lshlrev_b32 v106, 16, v37
    v_add_f32 v160, v160, v161
    v_add_f32 v162, v162, v163
    v_and_b32 v107, 0xffff0000, v37
    v_add_f32_dpp v160, v160, v160 quad_perm:[1,0,3,2] row_mask:0xf bank_mask:0xf
    v_add_f32_dpp v162, v162, v162 quad_perm:[1,0,3,2] row_mask:0xf bank_mask:0xf
    v_lshlrev_b32 v108, 16, v38
    v_add_f32_dpp v160, v160, v160 quad_perm:[2,3,0,1] row_mask:0xf bank_mask:0xf
    v_add_f32_dpp v162, v162, v162 quad_perm:[2,3,0,1] row_mask:0xf bank_mask:0xf
    v_and_b32 v109, 0xffff0000, v38
    v_add_f32_dpp v160, v160, v160 row_half_mirror row_mask:0xf bank_mask:0xf
    v_add_f32_dpp v162, v162, v162 row_half_mirror row_mask:0xf bank_mask:0xf
    v_mul_f32 v160, 0xbb000000, v160
    v_mul_f32 v162, 0x3b000000, v162
    v_fma_f32 v162, -v160, v160, v162
    v_max_f32 v162, 0, v162
    v_fmaak_f32 v162, v159, v162, 0x383ef424
    v_rsq_f32 v162, v162
    v_lshlrev_b32 v110, 16, v39
    v_and_b32 v111, 0xffff0000, v39
    v_mul_f32 v160, v160, v162
    s_cmp_lt_u32 s3, 4
    v_pk_fma_f32 v[48:49], v[48:49], v[162:163], v[160:161] op_sel_hi:[1,0,0]
    v_pk_fma_f32 v[50:51], v[50:51], v[162:163], v[160:161] op_sel_hi:[1,0,0]
    v_pk_fma_f32 v[52:53], v[52:53], v[162:163], v[160:161] op_sel_hi:[1,0,0]
    v_pk_fma_f32 v[54:55], v[54:55], v[162:163], v[160:161] op_sel_hi:[1,0,0]
    v_cvt_pk_bf16_f32 v8, v48, v49
    v_cvt_pk_bf16_f32 v9, v50, v51
    v_cvt_pk_bf16_f32 v10, v52, v53
    v_cvt_pk_bf16_f32 v11, v54, v55
    ds_write_b128 v156, v[8:11] offset:0
    v_pk_fma_f32 v[56:57], v[56:57], v[162:163], v[160:161] op_sel_hi:[1,0,0]
    v_pk_fma_f32 v[58:59], v[58:59], v[162:163], v[160:161] op_sel_hi:[1,0,0]
    v_pk_fma_f32 v[60:61], v[60:61], v[162:163], v[160:161] op_sel_hi:[1,0,0]
    v_pk_fma_f32 v[62:63], v[62:63], v[162:163], v[160:161] op_sel_hi:[1,0,0]
    v_cvt_pk_bf16_f32 v12, v56, v57
    v_cvt_pk_bf16_f32 v13, v58, v59
    v_cvt_pk_bf16_f32 v14, v60, v61
    v_cvt_pk_bf16_f32 v15, v62, v63
    ds_write_b128 v156, v[12:15] offset:8192
    v_pk_fma_f32 v[64:65], v[64:65], v[162:163], v[160:161] op_sel_hi:[1,0,0]
    v_pk_fma_f32 v[66:67], v[66:67], v[162:163], v[160:161] op_sel_hi:[1,0,0]
    v_pk_fma_f32 v[68:69], v[68:69], v[162:163], v[160:161] op_sel_hi:[1,0,0]
    v_pk_fma_f32 v[70:71], v[70:71], v[162:163], v[160:161] op_sel_hi:[1,0,0]
    v_cvt_pk_bf16_f32 v16, v64, v65
    v_cvt_pk_bf16_f32 v17, v66, v67
    v_cvt_pk_bf16_f32 v18, v68, v69
    v_cvt_pk_bf16_f32 v19, v70, v71
    ds_write_b128 v156, v[16:19] offset:16384
    v_pk_fma_f32 v[72:73], v[72:73], v[162:163], v[160:161] op_sel_hi:[1,0,0]
    v_pk_fma_f32 v[74:75], v[74:75], v[162:163], v[160:161] op_sel_hi:[1,0,0]
    v_pk_fma_f32 v[76:77], v[76:77], v[162:163], v[160:161] op_sel_hi:[1,0,0]
    v_pk_fma_f32 v[78:79], v[78:79], v[162:163], v[160:161] op_sel_hi:[1,0,0]
    v_cvt_pk_bf16_f32 v20, v72, v73
    v_cvt_pk_bf16_f32 v21, v74, v75
    v_cvt_pk_bf16_f32 v22, v76, v77
    v_cvt_pk_bf16_f32 v23, v78, v79
    ds_write_b128 v156, v[20:23] offset:24576
    v_pk_fma_f32 v[80:81], v[80:81], v[162:163], v[160:161] op_sel_hi:[1,0,0]
    v_pk_fma_f32 v[82:83], v[82:83], v[162:163], v[160:161] op_sel_hi:[1,0,0]
    v_pk_fma_f32 v[84:85], v[84:85], v[162:163], v[160:161] op_sel_hi:[1,0,0]
    v_pk_fma_f32 v[86:87], v[86:87], v[162:163], v[160:161] op_sel_hi:[1,0,0]
    v_cvt_pk_bf16_f32 v24, v80, v81
    v_cvt_pk_bf16_f32 v25, v82, v83
    v_cvt_pk_bf16_f32 v26, v84, v85
    v_cvt_pk_bf16_f32 v27, v86, v87
    ds_write_b128 v156, v[24:27] offset:32768
    v_pk_fma_f32 v[88:89], v[88:89], v[162:163], v[160:161] op_sel_hi:[1,0,0]
    v_pk_fma_f32 v[90:91], v[90:91], v[162:163], v[160:161] op_sel_hi:[1,0,0]
    v_pk_fma_f32 v[92:93], v[92:93], v[162:163], v[160:161] op_sel_hi:[1,0,0]
    v_pk_fma_f32 v[94:95], v[94:95], v[162:163], v[160:161] op_sel_hi:[1,0,0]
    v_cvt_pk_bf16_f32 v28, v88, v89
    v_cvt_pk_bf16_f32 v29, v90, v91
    v_cvt_pk_bf16_f32 v30, v92, v93
    v_cvt_pk_bf16_f32 v31, v94, v95
    ds_write_b128 v156, v[28:31] offset:40960
    v_pk_fma_f32 v[96:97], v[96:97], v[162:163], v[160:161] op_sel_hi:[1,0,0]
    v_pk_fma_f32 v[98:99], v[98:99], v[162:163], v[160:161] op_sel_hi:[1,0,0]
    v_pk_fma_f32 v[100:101], v[100:101], v[162:163], v[160:161] op_sel_hi:[1,0,0]
    v_pk_fma_f32 v[102:103], v[102:103], v[162:163], v[160:161] op_sel_hi:[1,0,0]
    v_cvt_pk_bf16_f32 v32, v96, v97
    v_cvt_pk_bf16_f32 v33, v98, v99
    v_cvt_pk_bf16_f32 v34, v100, v101
    v_cvt_pk_bf16_f32 v35, v102, v103
    ds_write_b128 v156, v[32:35] offset:49152
    v_pk_fma_f32 v[104:105], v[104:105], v[162:163], v[160:161] op_sel_hi:[1,0,0]
    v_pk_fma_f32 v[106:107], v[106:107], v[162:163], v[160:161] op_sel_hi:[1,0,0]
    v_pk_fma_f32 v[108:109], v[108:109], v[162:163], v[160:161] op_sel_hi:[1,0,0]
    v_pk_fma_f32 v[110:111], v[110:111], v[162:163], v[160:161] op_sel_hi:[1,0,0]
    v_cvt_pk_bf16_f32 v36, v104, v105
    v_cvt_pk_bf16_f32 v37, v106, v107
    v_cvt_pk_bf16_f32 v38, v108, v109
    v_cvt_pk_bf16_f32 v39, v110, v111
    ds_write_b128 v156, v[36:39] offset:57344
    s_waitcnt lgkmcnt(0)
    s_cmp_ge_u32 s3, 4
    s_cbranch_scc1 L_a_idle
    s_mov_b32 s8, 0x3fd22e3c
    s_mov_b32 s9, s8
    s_add_u32 s20, s21, 3072
    s_barrier
    ds_read_b64_tr_b16 v[24:25], v154 offset:0
    ds_read_b64_tr_b16 v[26:27], v154 offset:512
    ds_read_b128 v[8:11], v152 offset:0
    ds_read_b128 v[12:15], v152 offset:2048
    ds_read_b128 v[16:19], v152 offset:4096
    ds_read_b128 v[20:23], v152 offset:6144
    v_add_u16 v152, s14, v152
    ds_read_b64_tr_b16 v[28:29], v154 offset:1024
    ds_read_b64_tr_b16 v[30:31], v154 offset:1536
    ds_read_b64_tr_b16 v[32:33], v154 offset:2048
    ds_read_b64_tr_b16 v[34:35], v154 offset:2560
    s_waitcnt lgkmcnt(7)
    v_mfma_f32_16x16x32_bf16 v[104:107], v[24:27], v[8:11], 0
    ds_read_b64_tr_b16 v[52:53], v154 offset:12288
    s_waitcnt lgkmcnt(7)
    v_mfma_f32_16x16x32_bf16 v[108:111], v[24:27], v[12:15], 0
    ds_read_b64_tr_b16 v[54:55], v154 offset:12800
    s_waitcnt lgkmcnt(7)
    v_mfma_f32_16x16x32_bf16 v[112:115], v[24:27], v[16:19], 0
    ds_read_b128 v[36:39], v153 offset:0
    s_waitcnt lgkmcnt(7)
    v_mfma_f32_16x16x32_bf16 v[116:119], v[24:27], v[20:23], 0
    ds_read_b128 v[40:43], v153 offset:2048
    s_waitcnt lgkmcnt(6)
    v_mfma_f32_16x16x32_bf16 v[132:135], v[28:31], v[20:23], 0
    ds_read_b128 v[44:47], v153 offset:4096
    v_mfma_f32_16x16x32_bf16 v[128:131], v[28:31], v[16:19], 0
    ds_read_b128 v[48:51], v153 offset:6144
    v_add_u16 v153, s14, v153
    v_mfma_f32_16x16x32_bf16 v[124:127], v[28:31], v[12:15], 0
    ds_read_b64_tr_b16 v[56:57], v154 offset:13312
    v_mfma_f32_16x16x32_bf16 v[120:123], v[28:31], v[8:11], 0
    ds_read_b64_tr_b16 v[58:59], v154 offset:13824
    s_waitcnt lgkmcnt(8)
    v_mfma_f32_16x16x32_bf16 v[136:139], v[8:11], v[32:35], 0
    ds_read_b64_tr_b16 v[60:61], v154 offset:14336
    v_mfma_f32_16x16x32_bf16 v[140:143], v[12:15], v[32:35], 0
    ds_read_b64_tr_b16 v[62:63], v154 offset:14848
    v_mfma_f32_16x16x32_bf16 v[144:147], v[16:19], v[32:35], 0
    v_mfma_f32_16x16x32_bf16 v[148:151], v[20:23], v[32:35], 0
    s_waitcnt lgkmcnt(0)
    s_barrier
    ds_read_b64_tr_b16 v[80:81], v154 offset:24576
    ds_read_b64_tr_b16 v[82:83], v154 offset:25088
    v_mfma_f32_16x16x32_bf16 v[104:107], v[52:55], v[36:39], v[104:107]
    ds_read_b128 v[64:67], v152 offset:0
    v_mfma_f32_16x16x32_bf16 v[108:111], v[52:55], v[40:43], v[108:111]
    ds_read_b128 v[68:71], v152 offset:2048
    v_mfma_f32_16x16x32_bf16 v[112:115], v[52:55], v[44:47], v[112:115]
    ds_read_b128 v[72:75], v152 offset:4096
    v_mfma_f32_16x16x32_bf16 v[116:119], v[52:55], v[48:51], v[116:119]
    ds_read_b128 v[76:79], v152 offset:6144
    v_add_u16 v152, s14, v152
    v_mfma_f32_16x16x32_bf16 v[132:135], v[56:59], v[48:51], v[132:135]
    ds_read_b64_tr_b16 v[84:85], v154 offset:25600
    v_mfma_f32_16x16x32_bf16 v[128:131], v[56:59], v[44:47], v[128:131]
    ds_read_b64_tr_b16 v[86:87], v154 offset:26112
    v_mfma_f32_16x16x32_bf16 v[124:127], v[56:59], v[40:43], v[124:127]
    ds_read_b64_tr_b16 v[88:89], v154 offset:26624
    v_mfma_f32_16x16x32_bf16 v[120:123], v[56:59], v[36:39], v[120:123]
    ds_read_b64_tr_b16 v[90:91], v154 offset:27136
    v_mfma_f32_16x16x32_bf16 v[136:139], v[36:39], v[60:63], v[136:139]
    ds_read_b64_tr_b16 v[24:25], v154 offset:36864
    v_mfma_f32_16x16x32_bf16 v[140:143], v[40:43], v[60:63], v[140:143]
    ds_read_b64_tr_b16 v[26:27], v154 offset:37376
    v_mfma_f32_16x16x32_bf16 v[144:147], v[44:47], v[60:63], v[144:147]
    ds_read_b128 v[8:11], v153 offset:0
    v_mfma_f32_16x16x32_bf16 v[148:151], v[48:51], v[60:63], v[148:151]
    ds_read_b128 v[12:15], v153 offset:2048
    s_waitcnt lgkmcnt(11)
    v_mfma_f32_16x16x32_bf16 v[104:107], v[80:83], v[64:67], v[104:107]
    ds_read_b128 v[16:19], v153 offset:4096
    s_waitcnt lgkmcnt(11)
    v_mfma_f32_16x16x32_bf16 v[108:111], v[80:83], v[68:71], v[108:111]
    ds_read_b128 v[20:23], v153 offset:6144
    v_add_u16 v153, s14, v153
    s_waitcnt lgkmcnt(11)
    v_mfma_f32_16x16x32_bf16 v[112:115], v[80:83], v[72:75], v[112:115]
    ds_read_b64_tr_b16 v[28:29], v154 offset:37888
    s_waitcnt lgkmcnt(11)
    v_mfma_f32_16x16x32_bf16 v[116:119], v[80:83], v[76:79], v[116:119]
    ds_read_b64_tr_b16 v[30:31], v154 offset:38400
    s_waitcnt lgkmcnt(10)
    v_mfma_f32_16x16x32_bf16 v[132:135], v[84:87], v[76:79], v[132:135]
    ds_read_b64_tr_b16 v[32:33], v154 offset:38912
    v_mfma_f32_16x16x32_bf16 v[128:131], v[84:87], v[72:75], v[128:131]
    ds_read_b64_tr_b16 v[34:35], v154 offset:39424
    v_mfma_f32_16x16x32_bf16 v[124:127], v[84:87], v[68:71], v[124:127]
    v_mfma_f32_16x16x32_bf16 v[120:123], v[84:87], v[64:67], v[120:123]
    s_waitcnt lgkmcnt(10)
    v_mfma_f32_16x16x32_bf16 v[136:139], v[64:67], v[88:91], v[136:139]
    v_mfma_f32_16x16x32_bf16 v[140:143], v[68:71], v[88:91], v[140:143]
    v_mfma_f32_16x16x32_bf16 v[144:147], v[72:75], v[88:91], v[144:147]
    v_mfma_f32_16x16x32_bf16 v[148:151], v[76:79], v[88:91], v[148:151]
    s_waitcnt lgkmcnt(0)
    s_barrier
    ds_read_b64_tr_b16 v[52:53], v155 offset:0
    ds_read_b64_tr_b16 v[54:55], v155 offset:512
    v_mfma_f32_16x16x32_bf16 v[104:107], v[24:27], v[8:11], v[104:107]
    ds_read_b128 v[36:39], v152 offset:0
    v_mfma_f32_16x16x32_bf16 v[108:111], v[24:27], v[12:15], v[108:111]
    ds_read_b128 v[40:43], v152 offset:2048
    v_mfma_f32_16x16x32_bf16 v[112:115], v[24:27], v[16:19], v[112:115]
    ds_read_b128 v[44:47], v152 offset:4096
    v_mfma_f32_16x16x32_bf16 v[116:119], v[24:27], v[20:23], v[116:119]
    ds_read_b128 v[48:51], v152 offset:6144
    v_add_u16 v152, s14, v152
    v_mfma_f32_16x16x32_bf16 v[132:135], v[28:31], v[20:23], v[132:135]
    ds_read_b64_tr_b16 v[56:57], v155 offset:1024
    v_mfma_f32_16x16x32_bf16 v[128:131], v[28:31], v[16:19], v[128:131]
    ds_read_b64_tr_b16 v[58:59], v155 offset:1536
    v_mfma_f32_16x16x32_bf16 v[124:127], v[28:31], v[12:15], v[124:127]
    ds_read_b64_tr_b16 v[60:61], v155 offset:2048
    v_mfma_f32_16x16x32_bf16 v[120:123], v[28:31], v[8:11], v[120:123]
    ds_read_b64_tr_b16 v[62:63], v155 offset:2560
    v_mfma_f32_16x16x32_bf16 v[136:139], v[8:11], v[32:35], v[136:139]
    ds_read_b64_tr_b16 v[80:81], v155 offset:12288
    v_mfma_f32_16x16x32_bf16 v[140:143], v[12:15], v[32:35], v[140:143]
    ds_read_b64_tr_b16 v[82:83], v155 offset:12800
    v_mfma_f32_16x16x32_bf16 v[144:147], v[16:19], v[32:35], v[144:147]
    ds_read_b128 v[64:67], v153 offset:0
    v_mfma_f32_16x16x32_bf16 v[148:151], v[20:23], v[32:35], v[148:151]
    ds_read_b128 v[68:71], v153 offset:2048
    s_waitcnt lgkmcnt(11)
    v_mfma_f32_16x16x32_bf16 v[104:107], v[52:55], v[36:39], v[104:107]
    ds_read_b128 v[72:75], v153 offset:4096
    s_waitcnt lgkmcnt(11)
    v_mfma_f32_16x16x32_bf16 v[108:111], v[52:55], v[40:43], v[108:111]
    ds_read_b128 v[76:79], v153 offset:6144
    v_add_u16 v153, s14, v153
    s_waitcnt lgkmcnt(11)
    v_mfma_f32_16x16x32_bf16 v[112:115], v[52:55], v[44:47], v[112:115]
    ds_read_b64_tr_b16 v[84:85], v155 offset:13312
    s_waitcnt lgkmcnt(11)
    v_mfma_f32_16x16x32_bf16 v[116:119], v[52:55], v[48:51], v[116:119]
    ds_read_b64_tr_b16 v[86:87], v155 offset:13824
    s_waitcnt lgkmcnt(10)
    v_mfma_f32_16x16x32_bf16 v[132:135], v[56:59], v[48:51], v[132:135]
    ds_read_b64_tr_b16 v[88:89], v155 offset:14336
    v_mfma_f32_16x16x32_bf16 v[128:131], v[56:59], v[44:47], v[128:131]
    ds_read_b64_tr_b16 v[90:91], v155 offset:14848
    v_mfma_f32_16x16x32_bf16 v[124:127], v[56:59], v[40:43], v[124:127]
    v_mfma_f32_16x16x32_bf16 v[120:123], v[56:59], v[36:39], v[120:123]
    s_waitcnt lgkmcnt(10)
    v_mfma_f32_16x16x32_bf16 v[136:139], v[36:39], v[60:63], v[136:139]
    v_mfma_f32_16x16x32_bf16 v[140:143], v[40:43], v[60:63], v[140:143]
    v_mfma_f32_16x16x32_bf16 v[144:147], v[44:47], v[60:63], v[144:147]
    v_mfma_f32_16x16x32_bf16 v[148:151], v[48:51], v[60:63], v[148:151]
    s_waitcnt lgkmcnt(0)
    s_barrier
    ds_read_b64_tr_b16 v[24:25], v155 offset:24576
    ds_read_b64_tr_b16 v[26:27], v155 offset:25088
    v_mfma_f32_16x16x32_bf16 v[104:107], v[80:83], v[64:67], v[104:107]
    ds_read_b128 v[8:11], v152 offset:0
    v_mfma_f32_16x16x32_bf16 v[108:111], v[80:83], v[68:71], v[108:111]
    ds_read_b128 v[12:15], v152 offset:2048
    v_mfma_f32_16x16x32_bf16 v[112:115], v[80:83], v[72:75], v[112:115]
    ds_read_b128 v[16:19], v152 offset:4096
    v_mfma_f32_16x16x32_bf16 v[116:119], v[80:83], v[76:79], v[116:119]
    ds_read_b128 v[20:23], v152 offset:6144
    v_add_u16 v152, s14, v152
    v_mfma_f32_16x16x32_bf16 v[132:135], v[84:87], v[76:79], v[132:135]
    ds_read_b64_tr_b16 v[28:29], v155 offset:25600
    v_mfma_f32_16x16x32_bf16 v[128:131], v[84:87], v[72:75], v[128:131]
    ds_read_b64_tr_b16 v[30:31], v155 offset:26112
    v_mfma_f32_16x16x32_bf16 v[124:127], v[84:87], v[68:71], v[124:127]
    ds_read_b64_tr_b16 v[32:33], v155 offset:26624
    v_mfma_f32_16x16x32_bf16 v[120:123], v[84:87], v[64:67], v[120:123]
    ds_read_b64_tr_b16 v[34:35], v155 offset:27136
    v_mfma_f32_16x16x32_bf16 v[136:139], v[64:67], v[88:91], v[136:139]
    ds_read_b64_tr_b16 v[52:53], v155 offset:36864
    v_mfma_f32_16x16x32_bf16 v[140:143], v[68:71], v[88:91], v[140:143]
    ds_read_b64_tr_b16 v[54:55], v155 offset:37376
    v_mfma_f32_16x16x32_bf16 v[144:147], v[72:75], v[88:91], v[144:147]
    ds_read_b128 v[36:39], v153 offset:0
    v_mfma_f32_16x16x32_bf16 v[148:151], v[76:79], v[88:91], v[148:151]
    ds_read_b128 v[40:43], v153 offset:2048
    s_waitcnt lgkmcnt(11)
    v_mfma_f32_16x16x32_bf16 v[104:107], v[24:27], v[8:11], v[104:107]
    ds_read_b128 v[44:47], v153 offset:4096
    s_waitcnt lgkmcnt(11)
    v_mfma_f32_16x16x32_bf16 v[108:111], v[24:27], v[12:15], v[108:111]
    ds_read_b128 v[48:51], v153 offset:6144
    v_add_u16 v153, s14, v153
    s_waitcnt lgkmcnt(11)
    v_mfma_f32_16x16x32_bf16 v[112:115], v[24:27], v[16:19], v[112:115]
    ds_read_b64_tr_b16 v[56:57], v155 offset:37888
    s_waitcnt lgkmcnt(11)
    v_mfma_f32_16x16x32_bf16 v[116:119], v[24:27], v[20:23], v[116:119]
    ds_read_b64_tr_b16 v[58:59], v155 offset:38400
    s_waitcnt lgkmcnt(10)
    v_mfma_f32_16x16x32_bf16 v[132:135], v[28:31], v[20:23], v[132:135]
    ds_read_b64_tr_b16 v[60:61], v155 offset:38912
    v_mfma_f32_16x16x32_bf16 v[128:131], v[28:31], v[16:19], v[128:131]
    ds_read_b64_tr_b16 v[62:63], v155 offset:39424
    v_mfma_f32_16x16x32_bf16 v[124:127], v[28:31], v[12:15], v[124:127]
    v_mfma_f32_16x16x32_bf16 v[120:123], v[28:31], v[8:11], v[120:123]
    s_waitcnt lgkmcnt(10)
    v_mfma_f32_16x16x32_bf16 v[136:139], v[8:11], v[32:35], v[136:139]
    v_mfma_f32_16x16x32_bf16 v[140:143], v[12:15], v[32:35], v[140:143]
    v_mfma_f32_16x16x32_bf16 v[144:147], v[16:19], v[32:35], v[144:147]
    v_mfma_f32_16x16x32_bf16 v[148:151], v[20:23], v[32:35], v[148:151]
    s_waitcnt lgkmcnt(0)
    s_barrier
    ds_read_b64_tr_b16 v[80:81], v154 offset:0
    ds_read_b64_tr_b16 v[82:83], v154 offset:512
    v_mfma_f32_16x16x32_bf16 v[104:107], v[52:55], v[36:39], v[104:107]
    ds_read_b128 v[64:67], v152 offset:0
    v_mfma_f32_16x16x32_bf16 v[108:111], v[52:55], v[40:43], v[108:111]
    ds_read_b128 v[68:71], v152 offset:2048
    v_mfma_f32_16x16x32_bf16 v[112:115], v[52:55], v[44:47], v[112:115]
    ds_read_b128 v[72:75], v152 offset:4096
    v_mfma_f32_16x16x32_bf16 v[116:119], v[52:55], v[48:51], v[116:119]
    ds_read_b128 v[76:79], v152 offset:6144
    v_add_u16 v152, s14, v152
    v_mfma_f32_16x16x32_bf16 v[132:135], v[56:59], v[48:51], v[132:135]
    ds_read_b64_tr_b16 v[84:85], v154 offset:1024
    v_mfma_f32_16x16x32_bf16 v[128:131], v[56:59], v[44:47], v[128:131]
    ds_read_b64_tr_b16 v[86:87], v154 offset:1536
    v_mfma_f32_16x16x32_bf16 v[124:127], v[56:59], v[40:43], v[124:127]
    ds_read_b64_tr_b16 v[88:89], v154 offset:2048
    v_mfma_f32_16x16x32_bf16 v[120:123], v[56:59], v[36:39], v[120:123]
    ds_read_b64_tr_b16 v[90:91], v154 offset:2560
    v_mfma_f32_16x16x32_bf16 v[136:139], v[36:39], v[60:63], v[136:139]
    ds_read_b64_tr_b16 v[24:25], v154 offset:12288
    v_mfma_f32_16x16x32_bf16 v[140:143], v[40:43], v[60:63], v[140:143]
    ds_read_b64_tr_b16 v[26:27], v154 offset:12800
    v_mfma_f32_16x16x32_bf16 v[144:147], v[44:47], v[60:63], v[144:147]
    ds_read_b128 v[8:11], v153 offset:0
    v_mfma_f32_16x16x32_bf16 v[148:151], v[48:51], v[60:63], v[148:151]
    ds_read_b128 v[12:15], v153 offset:2048
    s_waitcnt lgkmcnt(11)
    v_mfma_f32_16x16x32_bf16 v[104:107], v[80:83], v[64:67], v[104:107]
    ds_read_b128 v[16:19], v153 offset:4096
    s_waitcnt lgkmcnt(11)
    v_mfma_f32_16x16x32_bf16 v[108:111], v[80:83], v[68:71], v[108:111]
    ds_read_b128 v[20:23], v153 offset:6144
    v_add_u16 v153, s14, v153
    s_waitcnt lgkmcnt(11)
    v_mfma_f32_16x16x32_bf16 v[112:115], v[80:83], v[72:75], v[112:115]
    ds_read_b64_tr_b16 v[28:29], v154 offset:13312
    s_waitcnt lgkmcnt(11)
    v_mfma_f32_16x16x32_bf16 v[116:119], v[80:83], v[76:79], v[116:119]
    ds_read_b64_tr_b16 v[30:31], v154 offset:13824
    s_waitcnt lgkmcnt(10)
    v_mfma_f32_16x16x32_bf16 v[132:135], v[84:87], v[76:79], v[132:135]
    ds_read_b64_tr_b16 v[32:33], v154 offset:14336
    v_mfma_f32_16x16x32_bf16 v[128:131], v[84:87], v[72:75], v[128:131]
    ds_read_b64_tr_b16 v[34:35], v154 offset:14848
    v_mfma_f32_16x16x32_bf16 v[124:127], v[84:87], v[68:71], v[124:127]
    v_mfma_f32_16x16x32_bf16 v[120:123], v[84:87], v[64:67], v[120:123]
    s_waitcnt lgkmcnt(10)
    v_mfma_f32_16x16x32_bf16 v[136:139], v[64:67], v[88:91], v[136:139]
    v_mfma_f32_16x16x32_bf16 v[140:143], v[68:71], v[88:91], v[140:143]
    v_mfma_f32_16x16x32_bf16 v[144:147], v[72:75], v[88:91], v[144:147]
    v_mfma_f32_16x16x32_bf16 v[148:151], v[76:79], v[88:91], v[148:151]
    s_waitcnt lgkmcnt(0)
    s_barrier
    ds_read_b64_tr_b16 v[52:53], v154 offset:24576
    ds_read_b64_tr_b16 v[54:55], v154 offset:25088
    v_mfma_f32_16x16x32_bf16 v[104:107], v[24:27], v[8:11], v[104:107]
    ds_read_b128 v[36:39], v152 offset:0
    v_mfma_f32_16x16x32_bf16 v[108:111], v[24:27], v[12:15], v[108:111]
    ds_read_b128 v[40:43], v152 offset:2048
    v_mfma_f32_16x16x32_bf16 v[112:115], v[24:27], v[16:19], v[112:115]
    ds_read_b128 v[44:47], v152 offset:4096
    v_mfma_f32_16x16x32_bf16 v[116:119], v[24:27], v[20:23], v[116:119]
    ds_read_b128 v[48:51], v152 offset:6144
    v_add_u16 v152, s14, v152
    v_mfma_f32_16x16x32_bf16 v[132:135], v[28:31], v[20:23], v[132:135]
    ds_read_b64_tr_b16 v[56:57], v154 offset:25600
    v_mfma_f32_16x16x32_bf16 v[128:131], v[28:31], v[16:19], v[128:131]
    ds_read_b64_tr_b16 v[58:59], v154 offset:26112
    v_mfma_f32_16x16x32_bf16 v[124:127], v[28:31], v[12:15], v[124:127]
    ds_read_b64_tr_b16 v[60:61], v154 offset:26624
    v_mfma_f32_16x16x32_bf16 v[120:123], v[28:31], v[8:11], v[120:123]
    ds_read_b64_tr_b16 v[62:63], v154 offset:27136
    v_mfma_f32_16x16x32_bf16 v[136:139], v[8:11], v[32:35], v[136:139]
    ds_read_b64_tr_b16 v[80:81], v154 offset:36864
    v_mfma_f32_16x16x32_bf16 v[140:143], v[12:15], v[32:35], v[140:143]
    ds_read_b64_tr_b16 v[82:83], v154 offset:37376
    v_mfma_f32_16x16x32_bf16 v[144:147], v[16:19], v[32:35], v[144:147]
    ds_read_b128 v[64:67], v153 offset:0
    v_mfma_f32_16x16x32_bf16 v[148:151], v[20:23], v[32:35], v[148:151]
    ds_read_b128 v[68:71], v153 offset:2048
    s_waitcnt lgkmcnt(11)
    v_mfma_f32_16x16x32_bf16 v[104:107], v[52:55], v[36:39], v[104:107]
    ds_read_b128 v[72:75], v153 offset:4096
    s_waitcnt lgkmcnt(11)
    v_mfma_f32_16x16x32_bf16 v[108:111], v[52:55], v[40:43], v[108:111]
    ds_read_b128 v[76:79], v153 offset:6144
    v_add_u16 v153, s14, v153
    s_waitcnt lgkmcnt(11)
    v_mfma_f32_16x16x32_bf16 v[112:115], v[52:55], v[44:47], v[112:115]
    ds_read_b64_tr_b16 v[84:85], v154 offset:37888
    s_waitcnt lgkmcnt(11)
    v_mfma_f32_16x16x32_bf16 v[116:119], v[52:55], v[48:51], v[116:119]
    ds_read_b64_tr_b16 v[86:87], v154 offset:38400
    s_waitcnt lgkmcnt(10)
    v_mfma_f32_16x16x32_bf16 v[132:135], v[56:59], v[48:51], v[132:135]
    ds_read_b64_tr_b16 v[88:89], v154 offset:38912
    v_mfma_f32_16x16x32_bf16 v[128:131], v[56:59], v[44:47], v[128:131]
    ds_read_b64_tr_b16 v[90:91], v154 offset:39424
    v_mfma_f32_16x16x32_bf16 v[124:127], v[56:59], v[40:43], v[124:127]
    v_mfma_f32_16x16x32_bf16 v[120:123], v[56:59], v[36:39], v[120:123]
    s_waitcnt lgkmcnt(10)
    v_mfma_f32_16x16x32_bf16 v[136:139], v[36:39], v[60:63], v[136:139]
    v_mfma_f32_16x16x32_bf16 v[140:143], v[40:43], v[60:63], v[140:143]
    v_mfma_f32_16x16x32_bf16 v[144:147], v[44:47], v[60:63], v[144:147]
    v_mfma_f32_16x16x32_bf16 v[148:151], v[48:51], v[60:63], v[148:151]
    s_waitcnt lgkmcnt(0)
    s_barrier
    ds_read_b64_tr_b16 v[24:25], v155 offset:0
    ds_read_b64_tr_b16 v[26:27], v155 offset:512
    v_mfma_f32_16x16x32_bf16 v[104:107], v[80:83], v[64:67], v[104:107]
    ds_read_b128 v[8:11], v152 offset:0
    v_mfma_f32_16x16x32_bf16 v[108:111], v[80:83], v[68:71], v[108:111]
    ds_read_b128 v[12:15], v152 offset:2048
    v_mfma_f32_16x16x32_bf16 v[112:115], v[80:83], v[72:75], v[112:115]
    ds_read_b128 v[16:19], v152 offset:4096
    v_mfma_f32_16x16x32_bf16 v[116:119], v[80:83], v[76:79], v[116:119]
    ds_read_b128 v[20:23], v152 offset:6144
    v_add_u16 v152, s14, v152
    v_mfma_f32_16x16x32_bf16 v[132:135], v[84:87], v[76:79], v[132:135]
    ds_read_b64_tr_b16 v[28:29], v155 offset:1024
    v_mfma_f32_16x16x32_bf16 v[128:131], v[84:87], v[72:75], v[128:131]
    ds_read_b64_tr_b16 v[30:31], v155 offset:1536
    v_mfma_f32_16x16x32_bf16 v[124:127], v[84:87], v[68:71], v[124:127]
    ds_read_b64_tr_b16 v[32:33], v155 offset:2048
    v_mfma_f32_16x16x32_bf16 v[120:123], v[84:87], v[64:67], v[120:123]
    ds_read_b64_tr_b16 v[34:35], v155 offset:2560
    v_mfma_f32_16x16x32_bf16 v[136:139], v[64:67], v[88:91], v[136:139]
    ds_read_b64_tr_b16 v[52:53], v155 offset:12288
    v_mfma_f32_16x16x32_bf16 v[140:143], v[68:71], v[88:91], v[140:143]
    ds_read_b64_tr_b16 v[54:55], v155 offset:12800
    v_mfma_f32_16x16x32_bf16 v[144:147], v[72:75], v[88:91], v[144:147]
    ds_read_b128 v[36:39], v153 offset:0
    v_mfma_f32_16x16x32_bf16 v[148:151], v[76:79], v[88:91], v[148:151]
    ds_read_b128 v[40:43], v153 offset:2048
    s_waitcnt lgkmcnt(11)
    v_mfma_f32_16x16x32_bf16 v[104:107], v[24:27], v[8:11], v[104:107]
    ds_read_b128 v[44:47], v153 offset:4096
    s_waitcnt lgkmcnt(11)
    v_mfma_f32_16x16x32_bf16 v[108:111], v[24:27], v[12:15], v[108:111]
    ds_read_b128 v[48:51], v153 offset:6144
    v_add_u16 v153, s14, v153
    s_waitcnt lgkmcnt(11)
    v_mfma_f32_16x16x32_bf16 v[112:115], v[24:27], v[16:19], v[112:115]
    ds_read_b64_tr_b16 v[56:57], v155 offset:13312
    s_waitcnt lgkmcnt(11)
    v_mfma_f32_16x16x32_bf16 v[116:119], v[24:27], v[20:23], v[116:119]
    ds_read_b64_tr_b16 v[58:59], v155 offset:13824
    s_waitcnt lgkmcnt(10)
    v_mfma_f32_16x16x32_bf16 v[132:135], v[28:31], v[20:23], v[132:135]
    ds_read_b64_tr_b16 v[60:61], v155 offset:14336
    v_mfma_f32_16x16x32_bf16 v[128:131], v[28:31], v[16:19], v[128:131]
    ds_read_b64_tr_b16 v[62:63], v155 offset:14848
    v_mfma_f32_16x16x32_bf16 v[124:127], v[28:31], v[12:15], v[124:127]
    v_mfma_f32_16x16x32_bf16 v[120:123], v[28:31], v[8:11], v[120:123]
    s_waitcnt lgkmcnt(10)
    v_mfma_f32_16x16x32_bf16 v[136:139], v[8:11], v[32:35], v[136:139]
    v_mfma_f32_16x16x32_bf16 v[140:143], v[12:15], v[32:35], v[140:143]
    v_mfma_f32_16x16x32_bf16 v[144:147], v[16:19], v[32:35], v[144:147]
    v_mfma_f32_16x16x32_bf16 v[148:151], v[20:23], v[32:35], v[148:151]
    s_waitcnt lgkmcnt(0)
    s_barrier
    ds_read_b64_tr_b16 v[80:81], v155 offset:24576
    ds_read_b64_tr_b16 v[82:83], v155 offset:25088
    v_mfma_f32_16x16x32_bf16 v[104:107], v[52:55], v[36:39], v[104:107]
    ds_read_b128 v[64:67], v152 offset:0
    v_mfma_f32_16x16x32_bf16 v[108:111], v[52:55], v[40:43], v[108:111]
    ds_read_b128 v[68:71], v152 offset:2048
    v_mfma_f32_16x16x32_bf16 v[112:115], v[52:55], v[44:47], v[112:115]
    ds_read_b128 v[72:75], v152 offset:4096
    v_mfma_f32_16x16x32_bf16 v[116:119], v[52:55], v[48:51], v[116:119]
    ds_read_b128 v[76:79], v152 offset:6144
    v_mfma_f32_16x16x32_bf16 v[132:135], v[56:59], v[48:51], v[132:135]
    ds_read_b64_tr_b16 v[24:25], v155 offset:36864
    v_mfma_f32_16x16x32_bf16 v[128:131], v[56:59], v[44:47], v[128:131]
    ds_read_b64_tr_b16 v[26:27], v155 offset:37376
    v_mfma_f32_16x16x32_bf16 v[124:127], v[56:59], v[40:43], v[124:127]
    ds_read_b128 v[8:11], v153 offset:0
    v_mfma_f32_16x16x32_bf16 v[120:123], v[56:59], v[36:39], v[120:123]
    ds_read_b128 v[12:15], v153 offset:2048
    v_mfma_f32_16x16x32_bf16 v[136:139], v[36:39], v[60:63], v[136:139]
    ds_read_b128 v[16:19], v153 offset:4096
    v_mfma_f32_16x16x32_bf16 v[140:143], v[40:43], v[60:63], v[140:143]
    ds_read_b128 v[20:23], v153 offset:6144
    v_mfma_f32_16x16x32_bf16 v[144:147], v[44:47], v[60:63], v[144:147]
    ds_read_b64_tr_b16 v[84:85], v155 offset:25600
    v_mfma_f32_16x16x32_bf16 v[148:151], v[48:51], v[60:63], v[148:151]
    ds_read_b64_tr_b16 v[86:87], v155 offset:26112
    s_waitcnt lgkmcnt(11)
    v_mfma_f32_16x16x32_bf16 v[104:107], v[80:83], v[64:67], v[104:107]
    ds_read_b64_tr_b16 v[28:29], v155 offset:37888
    s_waitcnt lgkmcnt(11)
    v_mfma_f32_16x16x32_bf16 v[108:111], v[80:83], v[68:71], v[108:111]
    ds_read_b64_tr_b16 v[30:31], v155 offset:38400
    s_waitcnt lgkmcnt(11)
    v_mfma_f32_16x16x32_bf16 v[112:115], v[80:83], v[72:75], v[112:115]
    ds_read_b64_tr_b16 v[88:89], v155 offset:26624
    s_waitcnt lgkmcnt(11)
    v_mfma_f32_16x16x32_bf16 v[116:119], v[80:83], v[76:79], v[116:119]
    ds_read_b64_tr_b16 v[90:91], v155 offset:27136
    s_waitcnt lgkmcnt(9)
    v_mfma_f32_16x16x32_bf16 v[104:107], v[24:27], v[8:11], v[104:107]
    ds_read_b64_tr_b16 v[32:33], v155 offset:38912
    s_waitcnt lgkmcnt(9)
    v_mfma_f32_16x16x32_bf16 v[108:111], v[24:27], v[12:15], v[108:111]
    s_nop 0
    s_nop 0
    ds_read_b64_tr_b16 v[34:35], v155 offset:39424
    s_waitcnt lgkmcnt(9)
    v_mfma_f32_16x16x32_bf16 v[112:115], v[24:27], v[16:19], v[112:115]
    s_nop 0
    s_nop 0
    s_waitcnt lgkmcnt(8)
    v_mfma_f32_16x16x32_bf16 v[116:119], v[24:27], v[20:23], v[116:119]
    v_pk_mul_f32 v[104:105], v[104:105], s[8:9]
    v_pk_mul_f32 v[106:107], v[106:107], s[8:9]
    s_waitcnt lgkmcnt(6)
    v_mfma_f32_16x16x32_bf16 v[120:123], v[84:87], v[64:67], v[120:123]
    v_pk_mul_f32 v[108:109], v[108:109], s[8:9]
    v_pk_mul_f32 v[110:111], v[110:111], s[8:9]
    v_mfma_f32_16x16x32_bf16 v[124:127], v[84:87], v[68:71], v[124:127]
    v_cvt_pk_bf16_f32 v104, v104, v105
    v_cvt_pk_bf16_f32 v105, v106, v107
    s_waitcnt lgkmcnt(4)
    v_mfma_f32_16x16x32_bf16 v[120:123], v[28:31], v[8:11], v[120:123]
    v_cvt_pk_bf16_f32 v106, v108, v109
    v_cvt_pk_bf16_f32 v107, v110, v111
    v_mfma_f32_16x16x32_bf16 v[124:127], v[28:31], v[12:15], v[124:127]
    s_nop 0
    v_permlane16_swap_b32 v104, v106
    v_mfma_f32_16x16x32_bf16 v[128:131], v[84:87], v[72:75], v[128:131]
    v_permlane16_swap_b32 v105, v107
    s_nop 0
    v_mfma_f32_16x16x32_bf16 v[132:135], v[84:87], v[76:79], v[132:135]
    buffer_store_dwordx4 v[104:107], v2, s[32:35], s21 offen offset:2048 sc1
    v_pk_mul_f32 v[112:113], v[112:113], s[8:9]
    v_mfma_f32_16x16x32_bf16 v[128:131], v[28:31], v[16:19], v[128:131]
    v_pk_mul_f32 v[114:115], v[114:115], s[8:9]
    v_pk_mul_f32 v[116:117], v[116:117], s[8:9]
    v_mfma_f32_16x16x32_bf16 v[132:135], v[28:31], v[20:23], v[132:135]
    v_pk_mul_f32 v[118:119], v[118:119], s[8:9]
    v_cvt_pk_bf16_f32 v112, v112, v113
    s_waitcnt lgkmcnt(2)
    v_mfma_f32_16x16x32_bf16 v[136:139], v[64:67], v[88:91], v[136:139]
    v_cvt_pk_bf16_f32 v113, v114, v115
    v_cvt_pk_bf16_f32 v114, v116, v117
    v_mfma_f32_16x16x32_bf16 v[140:143], v[68:71], v[88:91], v[140:143]
    v_cvt_pk_bf16_f32 v115, v118, v119
    s_nop 0
    s_waitcnt lgkmcnt(0)
    v_mfma_f32_16x16x32_bf16 v[136:139], v[8:11], v[32:35], v[136:139]
    v_permlane16_swap_b32 v112, v114
    v_permlane16_swap_b32 v113, v115
    v_mfma_f32_16x16x32_bf16 v[140:143], v[12:15], v[32:35], v[140:143]
    s_nop 0
    buffer_store_dwordx4 v[112:115], v2, s[32:35], s20 offen offset:2048 sc1
    v_mfma_f32_16x16x32_bf16 v[144:147], v[72:75], v[88:91], v[144:147]
    v_cvt_pk_bf16_f32 v120, v120, v121
    v_cvt_pk_bf16_f32 v121, v122, v123
    v_mfma_f32_16x16x32_bf16 v[148:151], v[76:79], v[88:91], v[148:151]
    v_cvt_pk_bf16_f32 v122, v124, v125
    v_cvt_pk_bf16_f32 v123, v126, v127
    v_mfma_f32_16x16x32_bf16 v[144:147], v[16:19], v[32:35], v[144:147]
    s_nop 0
    v_permlane16_swap_b32 v120, v122
    v_mfma_f32_16x16x32_bf16 v[148:151], v[20:23], v[32:35], v[148:151]
    v_permlane16_swap_b32 v121, v123
    s_nop 0
    buffer_store_dwordx4 v[120:123], v2, s[32:35], s21 offen offset:0 sc1
    v_mfma_f32_32x32x16_bf16 v[36:51], v[120:123], v[104:107], 0
    v_cvt_pk_bf16_f32 v128, v128, v129
    v_cvt_pk_bf16_f32 v129, v130, v131
    v_cvt_pk_bf16_f32 v130, v132, v133
    v_cvt_pk_bf16_f32 v131, v134, v135
    v_mfma_f32_32x32x16_bf16 v[52:67], v[120:123], v[112:115], 0
    v_permlane16_swap_b32 v128, v130
    v_permlane16_swap_b32 v129, v131
    s_nop 0
    buffer_store_dwordx4 v[128:131], v2, s[32:35], s20 offen offset:0 sc1
    v_mfma_f32_32x32x16_bf16 v[68:83], v[128:131], v[104:107], 0
    v_cvt_pk_bf16_f32 v136, v136, v137
    v_cvt_pk_bf16_f32 v137, v138, v139
    v_cvt_pk_bf16_f32 v138, v140, v141
    v_cvt_pk_bf16_f32 v139, v142, v143
    v_mfma_f32_32x32x16_bf16 v[8:23], v[128:131], v[112:115], 0
    v_permlane16_swap_b32 v136, v138
    v_permlane16_swap_b32 v137, v139
    v_max_f32 v92, v36, v37
    buffer_store_dwordx4 v[136:139], v2, s[32:35], s21 offen offset:1024 sc1
    v_max_f32 v93, v52, v53
    v_max3_f32 v92, v92, v38, v39
    v_max3_f32 v93, v93, v54, v55
    v_max3_f32 v92, v92, v40, v41
    v_max3_f32 v93, v93, v56, v57
    v_max3_f32 v92, v92, v42, v43
    v_max3_f32 v93, v93, v58, v59
    v_max3_f32 v92, v92, v44, v45
    v_max3_f32 v93, v93, v60, v61
    v_max3_f32 v92, v92, v46, v47
    v_max3_f32 v93, v93, v62, v63
    v_max3_f32 v92, v92, v48, v49
    v_max3_f32 v93, v93, v64, v65
    v_max3_f32 v92, v92, v50, v51
    v_max3_f32 v93, v93, v66, v67
    v_max3_f32 v92, v92, v68, v69
    v_max3_f32 v93, v93, v8, v9
    v_max3_f32 v92, v92, v70, v71
    v_max3_f32 v93, v93, v10, v11
    v_max3_f32 v92, v92, v72, v73
    v_max3_f32 v93, v93, v12, v13
    v_max3_f32 v92, v92, v74, v75
    v_max3_f32 v93, v93, v14, v15
    v_max3_f32 v92, v92, v76, v77
    v_max3_f32 v93, v93, v16, v17
    v_max3_f32 v92, v92, v78, v79
    v_max3_f32 v93, v93, v18, v19
    v_max3_f32 v92, v92, v80, v81
    v_max3_f32 v93, v93, v20, v21
    v_max3_f32 v92, v92, v82, v83
    v_max3_f32 v93, v93, v22, v23
    v_cvt_pk_bf16_f32 v144, v144, v145
    v_cvt_pk_bf16_f32 v145, v146, v147
    v_permlane32_swap_b32 v92, v93
    v_cvt_pk_bf16_f32 v146, v148, v149
    v_cvt_pk_bf16_f32 v147, v150, v151
    v_max_f32 v92, v92, v93
    v_sub_f32 v92, 0xc2cc0000, v92
    s_nop 0
    s_nop 0
    v_mov_b32_dpp v93, v92 quad_perm:[1,1,1,1] row_mask:0xf bank_mask:0xf
    v_mov_b32_dpp v94, v92 quad_perm:[2,2,2,2] row_mask:0xf bank_mask:0xf
    v_mov_b32_dpp v95, v92 quad_perm:[3,3,3,3] row_mask:0xf bank_mask:0xf
    s_mov_b32 exec_lo, 0x11111111
    s_mov_b32 exec_hi, 0x11111111
    buffer_store_dwordx4 v[92:95], v158, s[32:35], s23 offen sc1
    s_mov_b64 exec, -1
    v_permlane16_swap_b32 v144, v146
    v_permlane16_swap_b32 v145, v147
    s_nop 0
    buffer_store_dwordx4 v[144:147], v2, s[32:35], s20 offen offset:1024 sc1
L_a_nost:
L_att:
    s_barrier
L_att1:
    s_and_b32 s60, s2, 31
    s_lshr_b32 s61, s2, 5
    s_and_b32 s62, s3, 3
    s_lshr_b32 s63, s3, 2
    s_mov_b32 s66, 0x0000ffff
    s_mov_b32 s67, 0x0000ffff
    s_lshl_b32 s71, s61, 3
    s_lshl_b32 s8, s62, 1
    s_add_u32 s71, s71, s8
    s_mul_i32 s69, s60, 196608
    s_mul_i32 s8, s71, 3072
    s_add_u32 s68, s69, s8
    s_add_u32 s68, s68, 2048
    s_mul_i32 s8, s63, 3072
    s_add_u32 s65, s68, s8
    s_add_u32 s68, s68, 3072
    s_sub_u32 s68, s68, s8
    s_mov_b32 s64, s69
    s_add_u32 s8, s71, s63
    s_mul_i32 s9, s8, 512
    s_add_u32 s9, s9, 17080320
    s_add_u32 s50, s32, s9
    s_addc_u32 s51, s33, 0
    s_lshl_b32 s52, 1, s60
    s_lshl_b32 s53, 1, s60
    s_lshl_b32 s54, 1, s60
    s_lshl_b32 s55, 1, s60
    s_mul_i32 s8, s8, 118
    s_add_u32 s8, s8, s60
    s_lshl_b32 s8, s8, 10
    s_add_u32 s18, s8, 8388608
    s_mul_i32 s8, s63, 98304
    s_add_u32 s70, s69, s8
    s_mul_i32 s9, s61, 12288
    s_lshl_b32 s69, s60, 6
    s_add_u32 s69, s69, s71
    s_add_u32 s69, s69, s63
    s_lshl_b32 s69, s69, 7
    s_add_u32 s69, s69, 7340032
    s_xor_b32 s24, s69, 128
    v_and_b32 v144, 31, v1
    v_lshlrev_b32 v144, 2, v144
    s_lshr_b32 s8, s62, 1
    s_mul_i32 s8, s8, 3072
    s_and_b32 s10, s62, 1
    s_lshl_b32 s10, s10, 10
    s_add_u32 s8, s8, s10
    s_add_u32 s12, s70, s8
    s_add_u32 s13, s12, 98304
    s_add_u32 s72, s12, s9
    s_mul_i32 s14, s63, 20480
    s_add_u32 s14, s14, 122880
    s_add_u32 s15, s14, 20480
    s_mov_b32 s75, s14
    s_lshl_b32 s8, s62, 10
    s_add_u32 s16, s14, s8
    s_add_u32 s17, s15, s8
    s_mov_b32 s74, s16
    s_lshl_b32 s8, s3, 2
    s_add_u32 s8, s8, 65536
    v_mov_b32 v139, s8
    s_and_b32 s8, s8, 0xfffffff0
    v_and_b32 v140, 3, v1
    v_lshl_add_u32 v140, v140, 2, s8
    v_mov_b32 v137, 1
    s_mov_b32 s73, 0
    s_mul_i32 s8, s62, 3072
    s_add_u32 s8, s8, 4096
    s_add_u32 s9, s8, s14
    v_add_u32 v152, s9, v2
    s_sub_u32 s9, 266240, s14
    s_add_u32 s9, s9, s8
    v_add_u32 v153, s9, v2
    v_xor_b32 v154, 16, v139
    v_mov_b32 v155, 0x7e800000
    s_branch L_pad0
L_padb0:
    s_branch L_pad1
L_padb1:
    v_mov_b32 v141, 0xdddddddd
    v_and_b32 v120, 27, v1
    v_cmp_eq_u32 vcc, 16, v120
    v_mov_b32 v121, 0x3f803f80
    v_cndmask_b32 v120, 0, v121, vcc
    v_mov_b32 v121, v120
    v_mov_b64 v[122:123], v[120:121]
    v_mov_b64 v[124:125], v[120:121]
    v_mov_b64 v[126:127], v[120:121]
    v_mov_b64 v[128:129], v[120:121]
    v_mov_b64 v[130:131], v[120:121]
    v_mov_b64 v[132:133], v[120:121]
    v_mov_b64 v[134:135], v[120:121]
    v_mov_b64 v[72:73], 0
    v_mov_b64 v[74:75], 0
    v_mov_b64 v[76:77], 0
    v_mov_b64 v[78:79], 0
    v_mov_b64 v[80:81], 0
    v_mov_b64 v[82:83], 0
    v_mov_b64 v[84:85], 0
    v_mov_b64 v[86:87], 0
    v_mov_b64 v[88:89], 0
    v_mov_b64 v[90:91], 0
    v_mov_b64 v[92:93], 0
    v_mov_b64 v[94:95], 0
    v_mov_b64 v[96:97], 0
    v_mov_b64 v[98:99], 0
    v_mov_b64 v[100:101], 0
    v_mov_b64 v[102:103], 0
    v_add_u32 v136, s75, v2
    v_mov_b32 v146, 65632
    s_mov_b64 exec, 1
    s_cmp_lg_u32 s63, 0
    s_waitcnt vmcnt(0)
    s_cbranch_scc1 L_a_bar8
    ds_add_rtn_u32 v147, v146, v137 offset:4
    s_waitcnt lgkmcnt(0)
    v_cmp_eq_u32 vcc, 3, v147
    s_cbranch_vccnz L_qlast
L_qw:
    s_sleep 1
    ds_read_b32 v147, v146
    s_waitcnt lgkmcnt(0)
    v_cmp_eq_u32 vcc, 0, v147
    s_cbranch_vccnz L_qw
    s_mov_b64 exec, -1
    s_branch L_qgo
L_a_idle:
    s_barrier
    s_barrier
    s_barrier
    s_barrier
    s_barrier
    s_barrier
    s_barrier
    s_add_u32 s8, s15, 120832
    buffer_store_dwordx4 v[40:43], v2, s[32:35], s15 offen sc1
    buffer_store_dwordx4 v[40:43], v2, s[32:35], s8 offen sc1
    s_barrier
    s_setprio 0
    s_branch L_att1
L_a_bar8:
    s_barrier
    s_setprio 3
    s_branch L_qw
L_pad0:
    s_branch L_padb0
L_qlast:
    s_atomic_add s40, s[36:37], 0 glc
    s_atomic_add s41, s[36:37], 128 glc
    s_atomic_add s42, s[36:37], 256 glc
    s_atomic_add s43, s[36:37], 384 glc
    s_atomic_add s44, s[36:37], 512 glc
    s_atomic_add s45, s[36:37], 640 glc
    s_atomic_add s46, s[36:37], 768 glc
    s_atomic_add s47, s[36:37], 896 glc
    s_mov_b64 exec, -1
    s_mov_b32 s22, 262144
L_qpoll:
    s_load_dword s48, s[38:39], 0 glc
    s_sub_u32 s22, s22, 1
    s_cbranch_scc1 L_qpoll_ok
    s_waitcnt lgkmcnt(0)
L_qchk:
    s_cmp_eq_u32 s48, 32
    s_cbranch_scc0 L_qpoll
L_qpoll_ok:
    ds_write_b32 v146, v137
L_qgo:
    s_mov_b32 m0, s74
    s_add_u32 s74, s74, 4096
    buffer_load_dwordx4 v2, s[32:35], s72 offen sc1 lds
    s_cmp_eq_u32 s74, s17
    s_cselect_b32 s74, s16, s74
    s_add_u32 s72, s72, 6144
    s_cmp_eq_u32 s72, s13
    s_cselect_b32 s72, s12, s72
    buffer_load_dword v40, v144, s[32:35], s24 offen sc1
    buffer_load_dwordx4 v[104:107], v2, s[32:35], s68 offen sc1
    buffer_load_dword v56, v144, s[32:35], s69 offen sc1
    buffer_load_dwordx4 v[108:111], v2, s[32:35], s65 offen sc1
    s_waitcnt vmcnt(4)
    ds_write_b32 v139, v137
    s_mov_b32 m0, s74
    s_add_u32 s74, s74, 4096
    buffer_load_dwordx4 v2, s[32:35], s72 offen sc1 lds
    s_cmp_eq_u32 s74, s17
    s_cselect_b32 s74, s16, s74
    s_add_u32 s72, s72, 6144
    s_cmp_eq_u32 s72, s13
    s_cselect_b32 s72, s12, s72
    s_mov_b32 m0, s74
    s_add_u32 s74, s74, 4096
    buffer_load_dwordx4 v2, s[32:35], s72 offen sc1 lds
    s_cmp_eq_u32 s74, s17
    s_cselect_b32 s74, s16, s74
    s_add_u32 s72, s72, 6144
    s_cmp_eq_u32 s72, s13
    s_cselect_b32 s72, s12, s72
    s_mov_b32 m0, s74
    s_add_u32 s74, s74, 4096
    buffer_load_dwordx4 v2, s[32:35], s72 offen sc1 lds
    s_cmp_eq_u32 s74, s17
    s_cselect_b32 s74, s16, s74
    s_add_u32 s72, s72, 6144
    s_cmp_eq_u32 s72, s13
    s_cselect_b32 s72, s12, s72
    ds_read_b32 v138, v140
    s_waitcnt vmcnt(6)
    v_mov_b32 v41, v40
    v_mov_b64 v[42:43], v[40:41]
    v_mov_b64 v[44:45], v[40:41]
    v_mov_b64 v[46:47], v[40:41]
    s_waitcnt lgkmcnt(0)
    v_cmp_lt_u32 vcc, v138, v137
    s_cbranch_vccz L_sp0k
L_sp0:
    ds_read_b32 v138, v140
    s_waitcnt lgkmcnt(0)
    v_cmp_lt_u32 vcc, v138, v137
    s_cbranch_vccnz L_sp0
L_sp0k:
    ds_read_b128 v[112:115], v136 offset:0
    s_mov_b64 exec, s[66:67]
    ds_read_b128 v[120:123], v136 offset:1024
    ds_read_b128 v[124:127], v136 offset:1280
    s_mov_b64 exec, -1
    v_mov_b64 v[48:49], v[40:41]
    v_mov_b64 v[50:51], v[40:41]
    v_mov_b64 v[52:53], v[40:41]
    v_mov_b64 v[54:55], v[40:41]
    v_add_u32 v137, 1, v137
    s_waitcnt vmcnt(4)
    v_mov_b32 v57, v56
    s_waitcnt lgkmcnt(2)
    v_mfma_f32_32x32x16_bf16 v[8:23], v[112:115], v[104:107], v[40:55]
    v_mov_b64 v[58:59], v[56:57]
    v_mov_b64 v[60:61], v[56:57]
    v_mov_b64 v[62:63], v[56:57]
    v_mov_b64 v[64:65], v[56:57]
    v_mov_b64 v[66:67], v[56:57]
    v_mov_b64 v[68:69], v[56:57]
    v_mov_b64 v[70:71], v[56:57]
    s_waitcnt vmcnt(3) lgkmcnt(0)
    s_setprio 1
    s_cmp_eq_u32 s63, 0
    s_nop 1
    s_cbranch_scc0 L_go1
L_loop:
    v_exp_f32 v8, v8
    v_exp_f32 v9, v9
    v_exp_f32 v10, v10
    v_exp_f32 v11, v11
    v_exp_f32 v12, v12
    v_exp_f32 v13, v13
    v_exp_f32 v14, v14
    s_setprio 3
    v_mfma_f32_32x32x16_bf16 v[24:39], v[112:115], v[108:111], v[56:71]
    s_setprio 1
    v_exp_f32 v15, v15
    ds_read_b128 v[116:119], v136 offset:2048
    s_mov_b64 exec, s[66:67]
    ds_read_b128 v[128:131], v136 offset:3072
    ds_read_b128 v[132:135], v136 offset:3328
    s_mov_b64 exec, -1
    v_exp_f32 v16, v16
    v_exp_f32 v17, v17
    v_exp_f32 v18, v18
    v_exp_f32 v19, v19
    s_setprio 3
    v_smfmac_f32_32x32x32_bf16 v[72:87], v[120:123], v[8:15], v141
    s_setprio 1
    v_exp_f32 v20, v20
    v_exp_f32 v21, v21
    v_exp_f32 v22, v22
    v_exp_f32 v23, v23
    v_exp_f32 v24, v24
    v_exp_f32 v25, v25
    s_setprio 3
    v_smfmac_f32_32x32x32_bf16 v[72:87], v[124:127], v[16:23], v141
    s_setprio 0
    v_exp_f32 v26, v26
    v_exp_f32 v27, v27
    v_exp_f32 v28, v28
    v_exp_f32 v29, v29
    v_exp_f32 v30, v30
    s_waitcnt lgkmcnt(0)
    s_setprio 3
    v_mfma_f32_32x32x16_bf16 v[8:23], v[116:119], v[104:107], v[40:55]
    s_setprio 0
    v_exp_f32 v31, v31
    v_exp_f32 v32, v32
    s_waitcnt vmcnt(1)
    ds_write_b32 v139, v137
    v_exp_f32 v33, v33
    v_exp_f32 v34, v34
    v_exp_f32 v35, v35
    s_setprio 3
    v_smfmac_f32_32x32x32_bf16 v[88:103], v[120:123], v[24:31], v141
    s_setprio 0
    v_exp_f32 v36, v36
    ds_read_b32 v138, v140
    v_exp_f32 v37, v37
    v_exp_f32 v38, v38
    v_exp_f32 v39, v39
    v_exp_f32 v8, v8
    s_add_u32 s75, s75, 4096
    s_cmp_eq_u32 s75, s15
    s_cselect_b32 s75, s14, s75
    v_exp_f32 v9, v9
    s_waitcnt lgkmcnt(0)
    v_cmp_lt_u32 vcc, v138, v137
    s_cbranch_vccnz L_sp101
L_sp1b01:
    s_setprio 3
    v_smfmac_f32_32x32x32_bf16 v[88:103], v[124:127], v[32:39], v141
    s_setprio 1
    v_exp_f32 v10, v10
    v_add_u32 v136, s75, v2
    s_add_u32 s73, s73, 1
    s_mov_b32 m0, s74
    s_add_u32 s74, s74, 4096
    buffer_load_dwordx4 v2, s[32:35], s72 offen sc1 lds
    v_exp_f32 v11, v11
    s_cmp_eq_u32 s74, s17
    s_cselect_b32 s74, s16, s74
    v_add_u32 v137, 1, v137
    v_exp_f32 v12, v12
    v_exp_f32 v13, v13
    s_add_u32 s72, s72, 6144
    s_cmp_eq_u32 s72, s13
    s_cselect_b32 s72, s12, s72
    v_exp_f32 v14, v14
    s_setprio 3
    v_mfma_f32_32x32x16_bf16 v[24:39], v[116:119], v[108:111], v[56:71]
    s_setprio 1
    v_exp_f32 v15, v15
    ds_read_b128 v[112:115], v136 offset:0
    s_mov_b64 exec, s[66:67]
    ds_read_b128 v[120:123], v136 offset:1024
    ds_read_b128 v[124:127], v136 offset:1280
    s_mov_b64 exec, -1
    v_exp_f32 v16, v16
    v_exp_f32 v17, v17
    v_exp_f32 v18, v18
    v_exp_f32 v19, v19
    s_setprio 3
    v_smfmac_f32_32x32x32_bf16 v[72:87], v[128:131], v[8:15], v141
    s_setprio 1
    v_exp_f32 v20, v20
    v_exp_f32 v21, v21
    v_exp_f32 v22, v22
    v_exp_f32 v23, v23
    s_branch L_odd0
L_loop0:
    v_exp_f32 v24, v24
    v_exp_f32 v25, v25
    s_setprio 3
    v_smfmac_f32_32x32x32_bf16 v[72:87], v[132:135], v[16:23], v141
    s_setprio 1
    v_exp_f32 v26, v26
    v_exp_f32 v27, v27
    v_exp_f32 v28, v28
    v_exp_f32 v29, v29
    v_exp_f32 v30, v30
    s_waitcnt lgkmcnt(0)
    s_setprio 3
    v_mfma_f32_32x32x16_bf16 v[8:23], v[112:115], v[104:107], v[40:55]
    s_setprio 1
    v_exp_f32 v31, v31
    v_exp_f32 v32, v32
    s_waitcnt vmcnt(0)
    ds_write_b32 v139, v137
    v_exp_f32 v33, v33
    v_exp_f32 v34, v34
    v_exp_f32 v35, v35
    s_setprio 3
    v_smfmac_f32_32x32x32_bf16 v[88:103], v[128:131], v[24:31], v141
    s_setprio 1
    v_exp_f32 v36, v36
    v_exp_f32 v37, v37
    v_exp_f32 v38, v38
    v_exp_f32 v39, v39
    v_exp_f32 v8, v8
    v_exp_f32 v9, v9
    s_setprio 3
    v_smfmac_f32_32x32x32_bf16 v[88:103], v[132:135], v[32:39], v141
    s_setprio 1
    v_exp_f32 v10, v10
    v_exp_f32 v11, v11
    v_exp_f32 v12, v12
    v_exp_f32 v13, v13
    v_exp_f32 v14, v14
    s_setprio 3
    v_mfma_f32_32x32x16_bf16 v[24:39], v[112:115], v[108:111], v[56:71]
    s_setprio 1
    v_exp_f32 v15, v15
    ds_read_b128 v[116:119], v136 offset:2048
    s_mov_b64 exec, s[66:67]
    ds_read_b128 v[128:131], v136 offset:3072
    ds_read_b128 v[132:135], v136 offset:3328
    s_mov_b64 exec, -1
    v_exp_f32 v16, v16
    v_exp_f32 v17, v17
    v_exp_f32 v18, v18
    v_exp_f32 v19, v19
    s_setprio 3
    v_smfmac_f32_32x32x32_bf16 v[72:87], v[120:123], v[8:15], v141
    s_setprio 1
    v_exp_f32 v20, v20
    v_exp_f32 v21, v21
    v_exp_f32 v22, v22
    v_exp_f32 v23, v23
    v_exp_f32 v24, v24
    v_exp_f32 v25, v25
    s_setprio 3
    v_smfmac_f32_32x32x32_bf16 v[72:87], v[124:127], v[16:23], v141
    s_setprio 0
    v_exp_f32 v26, v26
    v_exp_f32 v27, v27
    v_exp_f32 v28, v28
    v_exp_f32 v29, v29
    v_exp_f32 v30, v30
    s_waitcnt lgkmcnt(0)
    s_setprio 3
    v_mfma_f32_32x32x16_bf16 v[8:23], v[116:119], v[104:107], v[40:55]
    s_setprio 0
    v_exp_f32 v31, v31
    v_exp_f32 v32, v32
    v_exp_f32 v33, v33
    v_exp_f32 v34, v34
    v_exp_f32 v35, v35
    s_setprio 3
    v_smfmac_f32_32x32x32_bf16 v[88:103], v[120:123], v[24:31], v141
    s_setprio 0
    v_exp_f32 v36, v36
    ds_read_b32 v138, v140
    v_exp_f32 v37, v37
    v_exp_f32 v38, v38
    v_exp_f32 v39, v39
    v_exp_f32 v8, v8
    s_add_u32 s75, s75, 4096
    s_cmp_eq_u32 s75, s15
    s_cselect_b32 s75, s14, s75
    v_exp_f32 v9, v9
    s_waitcnt lgkmcnt(0)
    v_cmp_lt_u32 vcc, v138, v137
    s_cbranch_vccnz L_sp100
L_sp1b00:
    s_setprio 3
    v_smfmac_f32_32x32x32_bf16 v[88:103], v[124:127], v[32:39], v141
    s_setprio 1
    v_exp_f32 v10, v10
    v_add_u32 v136, s75, v2
    s_add_u32 s73, s73, 1
    s_cmp_ge_u32 s73, 8
    s_cbranch_scc1 L_nd00
    s_mov_b32 m0, s74
    s_add_u32 s74, s74, 4096
    buffer_load_dwordx4 v2, s[32:35], s72 offen sc1 lds
L_nd00:
    v_exp_f32 v11, v11
    s_cmp_eq_u32 s74, s17
    s_cselect_b32 s74, s16, s74
    v_add_u32 v137, 1, v137
    v_exp_f32 v12, v12
    v_exp_f32 v13, v13
    s_add_u32 s72, s72, 6144
    s_cmp_eq_u32 s72, s13
    s_cselect_b32 s72, s12, s72
    v_exp_f32 v14, v14
    s_setprio 3
    v_mfma_f32_32x32x16_bf16 v[24:39], v[116:119], v[108:111], v[56:71]
    s_setprio 1
    v_exp_f32 v15, v15
    ds_read_b128 v[112:115], v136 offset:0
    s_mov_b64 exec, s[66:67]
    ds_read_b128 v[120:123], v136 offset:1024
    ds_read_b128 v[124:127], v136 offset:1280
    s_mov_b64 exec, -1
    v_exp_f32 v16, v16
    v_exp_f32 v17, v17
    s_cmp_ge_u32 s73, 7
    s_cbranch_scc1 L_nd01
    s_mov_b32 m0, s74
    s_add_u32 s74, s74, 4096
    buffer_load_dwordx4 v2, s[32:35], s72 offen sc1 lds
L_nd01:
    v_exp_f32 v18, v18
    s_cmp_eq_u32 s74, s17
    s_cselect_b32 s74, s16, s74
    v_exp_f32 v19, v19
    s_setprio 3
    v_smfmac_f32_32x32x32_bf16 v[72:87], v[128:131], v[8:15], v141
    s_setprio 1
    v_exp_f32 v20, v20
    s_add_u32 s72, s72, 6144
    s_cmp_eq_u32 s72, s13
    s_cselect_b32 s72, s12, s72
    v_exp_f32 v21, v21
    v_exp_f32 v22, v22
    v_exp_f32 v23, v23
L_odd0:
    v_exp_f32 v24, v24
    v_exp_f32 v25, v25
    s_setprio 3
    v_smfmac_f32_32x32x32_bf16 v[72:87], v[132:135], v[16:23], v141
    s_setprio 1
    v_exp_f32 v26, v26
    v_exp_f32 v27, v27
    v_exp_f32 v28, v28
    v_exp_f32 v29, v29
    v_exp_f32 v30, v30
    s_waitcnt lgkmcnt(0)
    s_setprio 3
    v_mfma_f32_32x32x16_bf16 v[8:23], v[112:115], v[104:107], v[40:55]
    s_setprio 1
    v_exp_f32 v31, v31
    v_exp_f32 v32, v32
    v_exp_f32 v33, v33
    v_exp_f32 v34, v34
    v_exp_f32 v35, v35
    s_setprio 3
    v_smfmac_f32_32x32x32_bf16 v[88:103], v[128:131], v[24:31], v141
    s_setprio 1
    v_exp_f32 v36, v36
    v_exp_f32 v37, v37
    v_exp_f32 v38, v38
    v_exp_f32 v39, v39
    v_exp_f32 v8, v8
    v_exp_f32 v9, v9
    s_setprio 3
    v_smfmac_f32_32x32x32_bf16 v[88:103], v[132:135], v[32:39], v141
    s_setprio 1
    v_exp_f32 v10, v10
    v_exp_f32 v11, v11
    v_exp_f32 v12, v12
    v_exp_f32 v13, v13
    v_exp_f32 v14, v14
    s_setprio 3
    v_mfma_f32_32x32x16_bf16 v[24:39], v[112:115], v[108:111], v[56:71]
    s_setprio 1
    v_exp_f32 v15, v15
    ds_read_b128 v[116:119], v136 offset:2048
    s_mov_b64 exec, s[66:67]
    ds_read_b128 v[128:131], v136 offset:3072
    ds_read_b128 v[132:135], v136 offset:3328
    s_mov_b64 exec, -1
    v_exp_f32 v16, v16
    v_exp_f32 v17, v17
    v_exp_f32 v18, v18
    v_exp_f32 v19, v19
    s_setprio 3
    v_smfmac_f32_32x32x32_bf16 v[72:87], v[120:123], v[8:15], v141
    s_setprio 1
    v_exp_f32 v20, v20
    v_exp_f32 v21, v21
    v_exp_f32 v22, v22
    v_exp_f32 v23, v23
    v_exp_f32 v24, v24
    v_exp_f32 v25, v25
    s_setprio 3
    v_smfmac_f32_32x32x32_bf16 v[72:87], v[124:127], v[16:23], v141
    s_setprio 0
    v_exp_f32 v26, v26
    v_exp_f32 v27, v27
    v_exp_f32 v28, v28
    v_exp_f32 v29, v29
    v_exp_f32 v30, v30
    s_waitcnt lgkmcnt(0)
    s_setprio 3
    v_mfma_f32_32x32x16_bf16 v[8:23], v[116:119], v[104:107], v[40:55]
    s_setprio 0
    v_exp_f32 v31, v31
    v_exp_f32 v32, v32
    v_exp_f32 v33, v33
    v_exp_f32 v34, v34
    v_exp_f32 v35, v35
    s_setprio 3
    v_smfmac_f32_32x32x32_bf16 v[88:103], v[120:123], v[24:31], v141
    s_setprio 0
    v_exp_f32 v36, v36
    v_exp_f32 v37, v37
    v_exp_f32 v38, v38
    v_exp_f32 v39, v39
    v_exp_f32 v8, v8
    s_add_u32 s75, s75, 4096
    s_cmp_eq_u32 s75, s15
    s_cselect_b32 s75, s14, s75
    v_exp_f32 v9, v9
    s_setprio 3
    v_smfmac_f32_32x32x32_bf16 v[88:103], v[124:127], v[32:39], v141
    s_setprio 1
    v_exp_f32 v10, v10
    v_add_u32 v136, s75, v2
    v_exp_f32 v11, v11
    v_exp_f32 v12, v12
    v_exp_f32 v13, v13
    v_exp_f32 v14, v14
    s_setprio 3
    v_mfma_f32_32x32x16_bf16 v[24:39], v[116:119], v[108:111], v[56:71]
    s_setprio 1
    v_exp_f32 v15, v15
    ds_read_b128 v[112:115], v136 offset:0
    s_mov_b64 exec, s[66:67]
    ds_read_b128 v[120:123], v136 offset:1024
    ds_read_b128 v[124:127], v136 offset:1280
    s_mov_b64 exec, -1
    v_exp_f32 v16, v16
    v_exp_f32 v17, v17
    v_exp_f32 v18, v18
    v_exp_f32 v19, v19
    s_setprio 3
    v_smfmac_f32_32x32x32_bf16 v[72:87], v[128:131], v[8:15], v141
    s_setprio 1
    v_exp_f32 v20, v20
    v_exp_f32 v21, v21
    s_cmp_lg_u32 s73, 8
    v_exp_f32 v22, v22
    v_exp_f32 v23, v23
    s_cbranch_scc1 L_loop0
    v_exp_f32 v24, v24
    v_exp_f32 v25, v25
    s_setprio 3
    v_smfmac_f32_32x32x32_bf16 v[72:87], v[132:135], v[16:23], v141
    s_setprio 1
    v_exp_f32 v26, v26
    v_exp_f32 v27, v27
    v_exp_f32 v28, v28
    v_exp_f32 v29, v29
    v_exp_f32 v30, v30
    v_exp_f32 v31, v31
    v_exp_f32 v32, v32
    v_exp_f32 v33, v33
    s_setprio 3
    v_smfmac_f32_32x32x32_bf16 v[88:103], v[128:131], v[24:31], v141
    s_setprio 1
    v_exp_f32 v34, v34
    ds_write_b128 v152, v[72:75]
    ds_write_b128 v152, v[76:79] offset:1024
    ds_write_b32 v152, v80 offset:2048
    ds_write_b32 v139, v137 offset:32
    v_exp_f32 v35, v35
    v_exp_f32 v36, v36
    ds_read_b32 v17, v154 offset:32
    ds_read_b128 v[8:11], v153
    ds_read_b128 v[12:15], v153 offset:1024
    ds_read_b32 v16, v153 offset:2048
    v_exp_f32 v37, v37
    v_exp_f32 v38, v38
    v_exp_f32 v39, v39
    s_setprio 3
    s_waitcnt lgkmcnt(0)
    v_smfmac_f32_32x32x32_bf16 v[88:103], v[132:135], v[32:39], v141
L_xc0:
    v_cmp_eq_u32 vcc, 0, v17
    s_cbranch_vccnz L_xs0
    s_atomic_add s52, s[50:51], 0 glc
    s_atomic_add s53, s[50:51], 128 glc
    s_atomic_add s54, s[50:51], 256 glc
    s_atomic_add s55, s[50:51], 384 glc
    v_mul_f32 v16, 0x3eeff558, v16
    s_nop 4
    v_fmamk_f32 v96, v96, 0x3eeff558, v16
    v_rcp_f32 v16, v96
    v_add_f32 v88, v88, v8
    v_add_f32 v89, v89, v9
    v_add_f32 v90, v90, v10
    v_add_f32 v91, v91, v11
    v_add_f32 v92, v92, v12
    v_add_f32 v93, v93, v13
    v_add_f32 v94, v94, v14
    v_add_f32 v95, v95, v15
    v_mul_f32 v8, v88, v16
    v_mul_f32 v9, v89, v16
    v_maximum3_f32 v96, abs(v88), abs(v89), v96
    v_mul_f32 v10, v90, v16
    v_mul_f32 v11, v91, v16
    v_maximum3_f32 v96, abs(v90), abs(v91), v96
    v_mul_f32 v12, v92, v16
    v_mul_f32 v13, v93, v16
    v_maximum3_f32 v96, abs(v92), abs(v93), v96
    v_mul_f32 v14, v94, v16
    v_mul_f32 v15, v95, v16
    v_maximum3_f32 v17, abs(v94), abs(v95), v96
    v_cvt_pk_bf16_f32 v20, v8, v9
    v_cmp_nlt_f32 vcc, v17, v155
    v_cvt_pk_bf16_f32 v21, v10, v11
    v_cvt_pk_bf16_f32 v22, v12, v13
    v_cvt_pk_bf16_f32 v23, v14, v15
    s_cbranch_vccnz L_fallback
    buffer_store_dwordx4 v[20:23], v2, s[32:35], s18 offen sc1
    s_waitcnt lgkmcnt(0)
    s_endpgm
L_xs0:
    s_sleep 1
    ds_read_b32 v17, v154 offset:32
    ds_read_b128 v[8:11], v153
    ds_read_b128 v[12:15], v153 offset:1024
    ds_read_b32 v16, v153 offset:2048
    s_waitcnt lgkmcnt(0)
    s_branch L_xc0
L_sp101:
    ds_read_b32 v138, v140
    s_waitcnt lgkmcnt(0)
    v_cmp_lt_u32 vcc, v138, v137
    s_cbranch_vccnz L_sp101
    s_branch L_sp1b01
L_sp100:
    ds_read_b32 v138, v140
    s_waitcnt lgkmcnt(0)
    v_cmp_lt_u32 vcc, v138, v137
    s_cbranch_vccnz L_sp100
    s_branch L_sp1b00
.p2align 6
L_pad1:
    s_branch L_padb1
    s_nop 0
L_go1:
    v_exp_f32 v8, v8
    v_exp_f32 v9, v9
    v_exp_f32 v10, v10
    v_exp_f32 v11, v11
    v_exp_f32 v12, v12
    v_exp_f32 v13, v13
    v_exp_f32 v14, v14
    s_setprio 3
    v_mfma_f32_32x32x16_bf16 v[24:39], v[112:115], v[108:111], v[56:71]
    s_setprio 1
    v_exp_f32 v15, v15
    ds_read_b128 v[116:119], v136 offset:2048
    s_mov_b64 exec, s[66:67]
    ds_read_b128 v[128:131], v136 offset:3072
    ds_read_b128 v[132:135], v136 offset:3328
    s_mov_b64 exec, -1
    v_exp_f32 v16, v16
    v_exp_f32 v17, v17
    v_exp_f32 v18, v18
    v_exp_f32 v19, v19
    s_setprio 3
    v_smfmac_f32_32x32x32_bf16 v[72:87], v[120:123], v[8:15], v141
    s_setprio 1
    v_exp_f32 v20, v20
    v_exp_f32 v21, v21
    v_exp_f32 v22, v22
    v_exp_f32 v23, v23
    v_exp_f32 v24, v24
    v_exp_f32 v25, v25
    s_setprio 3
    v_smfmac_f32_32x32x32_bf16 v[72:87], v[124:127], v[16:23], v141
    s_setprio 1
    v_exp_f32 v26, v26
    v_exp_f32 v27, v27
    v_exp_f32 v28, v28
    v_exp_f32 v29, v29
    v_exp_f32 v30, v30
    s_waitcnt lgkmcnt(0)
    s_setprio 3
    v_mfma_f32_32x32x16_bf16 v[8:23], v[116:119], v[104:107], v[40:55]
    s_setprio 1
    v_exp_f32 v31, v31
    v_exp_f32 v32, v32
    s_waitcnt vmcnt(1)
    ds_write_b32 v139, v137
    v_exp_f32 v33, v33
    v_exp_f32 v34, v34
    v_exp_f32 v35, v35
    s_setprio 3
    v_smfmac_f32_32x32x32_bf16 v[88:103], v[120:123], v[24:31], v141
    s_setprio 1
    v_exp_f32 v36, v36
    ds_read_b32 v138, v140
    v_exp_f32 v37, v37
    v_exp_f32 v38, v38
    v_exp_f32 v39, v39
    v_exp_f32 v8, v8
    s_add_u32 s75, s75, 4096
    s_cmp_eq_u32 s75, s15
    s_cselect_b32 s75, s14, s75
    v_exp_f32 v9, v9
    s_waitcnt lgkmcnt(0)
    v_cmp_lt_u32 vcc, v138, v137
    s_cbranch_vccnz L_sp111
L_sp1b11:
    s_setprio 3
    v_smfmac_f32_32x32x32_bf16 v[88:103], v[124:127], v[32:39], v141
    s_setprio 1
    v_exp_f32 v10, v10
    v_add_u32 v136, s75, v2
    s_add_u32 s73, s73, 1
    s_mov_b32 m0, s74
    s_add_u32 s74, s74, 4096
    buffer_load_dwordx4 v2, s[32:35], s72 offen sc1 lds
    v_exp_f32 v11, v11
    s_cmp_eq_u32 s74, s17
    s_cselect_b32 s74, s16, s74
    v_add_u32 v137, 1, v137
    v_exp_f32 v12, v12
    v_exp_f32 v13, v13
    s_add_u32 s72, s72, 6144
    s_cmp_eq_u32 s72, s13
    s_cselect_b32 s72, s12, s72
    v_exp_f32 v14, v14
    s_setprio 3
    v_mfma_f32_32x32x16_bf16 v[24:39], v[116:119], v[108:111], v[56:71]
    s_setprio 1
    v_exp_f32 v15, v15
    ds_read_b128 v[112:115], v136 offset:0
    s_mov_b64 exec, s[66:67]
    ds_read_b128 v[120:123], v136 offset:1024
    ds_read_b128 v[124:127], v136 offset:1280
    s_mov_b64 exec, -1
    v_exp_f32 v16, v16
    v_exp_f32 v17, v17
    v_exp_f32 v18, v18
    v_exp_f32 v19, v19
    s_setprio 3
    v_smfmac_f32_32x32x32_bf16 v[72:87], v[128:131], v[8:15], v141
    s_setprio 1
    v_exp_f32 v20, v20
    v_exp_f32 v21, v21
    v_exp_f32 v22, v22
    v_exp_f32 v23, v23
    s_branch L_odd1
L_loop1:
    v_exp_f32 v24, v24
    v_exp_f32 v25, v25
    s_setprio 3
    v_smfmac_f32_32x32x32_bf16 v[72:87], v[132:135], v[16:23], v141
    s_setprio 1
    v_exp_f32 v26, v26
    v_exp_f32 v27, v27
    v_exp_f32 v28, v28
    v_exp_f32 v29, v29
    v_exp_f32 v30, v30
    s_waitcnt lgkmcnt(0)
    s_setprio 3
    v_mfma_f32_32x32x16_bf16 v[8:23], v[112:115], v[104:107], v[40:55]
    s_setprio 1
    v_exp_f32 v31, v31
    v_exp_f32 v32, v32
    s_waitcnt vmcnt(0)
    ds_write_b32 v139, v137
    v_exp_f32 v33, v33
    v_exp_f32 v34, v34
    v_exp_f32 v35, v35
    s_setprio 3
    v_smfmac_f32_32x32x32_bf16 v[88:103], v[128:131], v[24:31], v141
    s_setprio 1
    v_exp_f32 v36, v36
    v_exp_f32 v37, v37
    v_exp_f32 v38, v38
    v_exp_f32 v39, v39
    v_exp_f32 v8, v8
    v_exp_f32 v9, v9
    s_setprio 3
    v_smfmac_f32_32x32x32_bf16 v[88:103], v[132:135], v[32:39], v141
    s_setprio 1
    v_exp_f32 v10, v10
    v_exp_f32 v11, v11
    v_exp_f32 v12, v12
    v_exp_f32 v13, v13
    v_exp_f32 v14, v14
    s_setprio 3
    v_mfma_f32_32x32x16_bf16 v[24:39], v[112:115], v[108:111], v[56:71]
    s_setprio 1
    v_exp_f32 v15, v15
    ds_read_b128 v[116:119], v136 offset:2048
    s_mov_b64 exec, s[66:67]
    ds_read_b128 v[128:131], v136 offset:3072
    ds_read_b128 v[132:135], v136 offset:3328
    s_mov_b64 exec, -1
    v_exp_f32 v16, v16
    v_exp_f32 v17, v17
    v_exp_f32 v18, v18
    v_exp_f32 v19, v19
    s_setprio 3
    v_smfmac_f32_32x32x32_bf16 v[72:87], v[120:123], v[8:15], v141
    s_setprio 1
    v_exp_f32 v20, v20
    v_exp_f32 v21, v21
    v_exp_f32 v22, v22
    v_exp_f32 v23, v23
    v_exp_f32 v24, v24
    v_exp_f32 v25, v25
    s_setprio 3
    v_smfmac_f32_32x32x32_bf16 v[72:87], v[124:127], v[16:23], v141
    s_setprio 1
    v_exp_f32 v26, v26
    v_exp_f32 v27, v27
    v_exp_f32 v28, v28
    v_exp_f32 v29, v29
    v_exp_f32 v30, v30
    s_waitcnt lgkmcnt(0)
    s_setprio 3
    v_mfma_f32_32x32x16_bf16 v[8:23], v[116:119], v[104:107], v[40:55]
    s_setprio 1
    v_exp_f32 v31, v31
    v_exp_f32 v32, v32
    v_exp_f32 v33, v33
    v_exp_f32 v34, v34
    v_exp_f32 v35, v35
    s_setprio 3
    v_smfmac_f32_32x32x32_bf16 v[88:103], v[120:123], v[24:31], v141
    s_setprio 1
    v_exp_f32 v36, v36
    ds_read_b32 v138, v140
    v_exp_f32 v37, v37
    v_exp_f32 v38, v38
    v_exp_f32 v39, v39
    v_exp_f32 v8, v8
    s_add_u32 s75, s75, 4096
    s_cmp_eq_u32 s75, s15
    s_cselect_b32 s75, s14, s75
    v_exp_f32 v9, v9
    s_waitcnt lgkmcnt(0)
    v_cmp_lt_u32 vcc, v138, v137
    s_cbranch_vccnz L_sp110
L_sp1b10:
    s_setprio 3
    v_smfmac_f32_32x32x32_bf16 v[88:103], v[124:127], v[32:39], v141
    s_setprio 1
    v_exp_f32 v10, v10
    v_add_u32 v136, s75, v2
    s_add_u32 s73, s73, 1
    s_cmp_ge_u32 s73, 8
    s_cbranch_scc1 L_nd10
    s_mov_b32 m0, s74
    s_add_u32 s74, s74, 4096
    buffer_load_dwordx4 v2, s[32:35], s72 offen sc1 lds
L_nd10:
    v_exp_f32 v11, v11
    s_cmp_eq_u32 s74, s17
    s_cselect_b32 s74, s16, s74
    v_add_u32 v137, 1, v137
    v_exp_f32 v12, v12
    v_exp_f32 v13, v13
    s_add_u32 s72, s72, 6144
    s_cmp_eq_u32 s72, s13
    s_cselect_b32 s72, s12, s72
    v_exp_f32 v14, v14
    s_setprio 3
    v_mfma_f32_32x32x16_bf16 v[24:39], v[116:119], v[108:111], v[56:71]
    s_setprio 1
    v_exp_f32 v15, v15
    ds_read_b128 v[112:115], v136 offset:0
    s_mov_b64 exec, s[66:67]
    ds_read_b128 v[120:123], v136 offset:1024
    ds_read_b128 v[124:127], v136 offset:1280
    s_mov_b64 exec, -1
    v_exp_f32 v16, v16
    v_exp_f32 v17, v17
    s_cmp_ge_u32 s73, 7
    s_cbranch_scc1 L_nd11
    s_mov_b32 m0, s74
    s_add_u32 s74, s74, 4096
    buffer_load_dwordx4 v2, s[32:35], s72 offen sc1 lds
L_nd11:
    v_exp_f32 v18, v18
    s_cmp_eq_u32 s74, s17
    s_cselect_b32 s74, s16, s74
    v_exp_f32 v19, v19
    s_setprio 3
    v_smfmac_f32_32x32x32_bf16 v[72:87], v[128:131], v[8:15], v141
    s_setprio 1
    v_exp_f32 v20, v20
    s_add_u32 s72, s72, 6144
    s_cmp_eq_u32 s72, s13
    s_cselect_b32 s72, s12, s72
    v_exp_f32 v21, v21
    v_exp_f32 v22, v22
    v_exp_f32 v23, v23
L_odd1:
    v_exp_f32 v24, v24
    v_exp_f32 v25, v25
    s_setprio 3
    v_smfmac_f32_32x32x32_bf16 v[72:87], v[132:135], v[16:23], v141
    s_setprio 1
    v_exp_f32 v26, v26
    v_exp_f32 v27, v27
    v_exp_f32 v28, v28
    v_exp_f32 v29, v29
    v_exp_f32 v30, v30
    s_waitcnt lgkmcnt(0)
    s_setprio 3
    v_mfma_f32_32x32x16_bf16 v[8:23], v[112:115], v[104:107], v[40:55]
    s_setprio 1
    v_exp_f32 v31, v31
    v_exp_f32 v32, v32
    v_exp_f32 v33, v33
    v_exp_f32 v34, v34
    v_exp_f32 v35, v35
    s_setprio 3
    v_smfmac_f32_32x32x32_bf16 v[88:103], v[128:131], v[24:31], v141
    s_setprio 1
    v_exp_f32 v36, v36
    v_exp_f32 v37, v37
    v_exp_f32 v38, v38
    v_exp_f32 v39, v39
    v_exp_f32 v8, v8
    v_exp_f32 v9, v9
    s_setprio 3
    v_smfmac_f32_32x32x32_bf16 v[88:103], v[132:135], v[32:39], v141
    s_setprio 1
    v_exp_f32 v10, v10
    v_exp_f32 v11, v11
    v_exp_f32 v12, v12
    v_exp_f32 v13, v13
    v_exp_f32 v14, v14
    s_setprio 3
    v_mfma_f32_32x32x16_bf16 v[24:39], v[112:115], v[108:111], v[56:71]
    s_setprio 1
    v_exp_f32 v15, v15
    ds_read_b128 v[116:119], v136 offset:2048
    s_mov_b64 exec, s[66:67]
    ds_read_b128 v[128:131], v136 offset:3072
    ds_read_b128 v[132:135], v136 offset:3328
    s_mov_b64 exec, -1
    v_exp_f32 v16, v16
    v_exp_f32 v17, v17
    v_exp_f32 v18, v18
    v_exp_f32 v19, v19
    s_setprio 3
    v_smfmac_f32_32x32x32_bf16 v[72:87], v[120:123], v[8:15], v141
    s_setprio 1
    v_exp_f32 v20, v20
    v_exp_f32 v21, v21
    v_exp_f32 v22, v22
    v_exp_f32 v23, v23
    v_exp_f32 v24, v24
    v_exp_f32 v25, v25
    s_setprio 3
    v_smfmac_f32_32x32x32_bf16 v[72:87], v[124:127], v[16:23], v141
    s_setprio 1
    v_exp_f32 v26, v26
    v_exp_f32 v27, v27
    v_exp_f32 v28, v28
    v_exp_f32 v29, v29
    v_exp_f32 v30, v30
    s_waitcnt lgkmcnt(0)
    s_setprio 3
    v_mfma_f32_32x32x16_bf16 v[8:23], v[116:119], v[104:107], v[40:55]
    s_setprio 1
    v_exp_f32 v31, v31
    v_exp_f32 v32, v32
    v_exp_f32 v33, v33
    v_exp_f32 v34, v34
    v_exp_f32 v35, v35
    s_setprio 3
    v_smfmac_f32_32x32x32_bf16 v[88:103], v[120:123], v[24:31], v141
    s_setprio 1
    v_exp_f32 v36, v36
    v_exp_f32 v37, v37
    v_exp_f32 v38, v38
    v_exp_f32 v39, v39
    v_exp_f32 v8, v8
    s_add_u32 s75, s75, 4096
    s_cmp_eq_u32 s75, s15
    s_cselect_b32 s75, s14, s75
    v_exp_f32 v9, v9
    s_setprio 3
    v_smfmac_f32_32x32x32_bf16 v[88:103], v[124:127], v[32:39], v141
    s_setprio 1
    v_exp_f32 v10, v10
    v_add_u32 v136, s75, v2
    v_exp_f32 v11, v11
    v_exp_f32 v12, v12
    v_exp_f32 v13, v13
    v_exp_f32 v14, v14
    s_setprio 3
    v_mfma_f32_32x32x16_bf16 v[24:39], v[116:119], v[108:111], v[56:71]
    s_setprio 1
    v_exp_f32 v15, v15
    ds_read_b128 v[112:115], v136 offset:0
    s_mov_b64 exec, s[66:67]
    ds_read_b128 v[120:123], v136 offset:1024
    ds_read_b128 v[124:127], v136 offset:1280
    s_mov_b64 exec, -1
    v_exp_f32 v16, v16
    v_exp_f32 v17, v17
    v_exp_f32 v18, v18
    v_exp_f32 v19, v19
    s_setprio 3
    v_smfmac_f32_32x32x32_bf16 v[72:87], v[128:131], v[8:15], v141
    s_setprio 1
    v_exp_f32 v20, v20
    v_exp_f32 v21, v21
    s_cmp_lg_u32 s73, 8
    v_exp_f32 v22, v22
    v_exp_f32 v23, v23
    s_cbranch_scc1 L_loop1
    v_exp_f32 v24, v24
    v_exp_f32 v25, v25
    s_setprio 3
    v_smfmac_f32_32x32x32_bf16 v[72:87], v[132:135], v[16:23], v141
    s_setprio 1
    v_exp_f32 v26, v26
    v_exp_f32 v27, v27
    v_exp_f32 v28, v28
    v_exp_f32 v29, v29
    v_exp_f32 v30, v30
    v_exp_f32 v31, v31
    v_exp_f32 v32, v32
    v_exp_f32 v33, v33
    s_setprio 3
    v_smfmac_f32_32x32x32_bf16 v[88:103], v[128:131], v[24:31], v141
    s_setprio 1
    v_exp_f32 v34, v34
    ds_write_b128 v152, v[72:75]
    ds_write_b128 v152, v[76:79] offset:1024
    ds_write_b32 v152, v80 offset:2048
    ds_write_b32 v139, v137 offset:32
    v_exp_f32 v35, v35
    v_exp_f32 v36, v36
    ds_read_b32 v17, v154 offset:32
    ds_read_b128 v[8:11], v153
    ds_read_b128 v[12:15], v153 offset:1024
    ds_read_b32 v16, v153 offset:2048
    v_exp_f32 v37, v37
    v_exp_f32 v38, v38
    v_exp_f32 v39, v39
    s_setprio 3
    s_waitcnt lgkmcnt(0)
    v_smfmac_f32_32x32x32_bf16 v[88:103], v[132:135], v[32:39], v141
L_xc1:
    v_cmp_eq_u32 vcc, 0, v17
    s_cbranch_vccnz L_xs1
    s_atomic_add s52, s[50:51], 0 glc
    s_atomic_add s53, s[50:51], 128 glc
    s_atomic_add s54, s[50:51], 256 glc
    s_atomic_add s55, s[50:51], 384 glc
    v_mul_f32 v16, 0x3eeff558, v16
    s_nop 4
    v_fmamk_f32 v96, v96, 0x3eeff558, v16
    v_rcp_f32 v16, v96
    v_add_f32 v88, v88, v8
    v_add_f32 v89, v89, v9
    v_add_f32 v90, v90, v10
    v_add_f32 v91, v91, v11
    v_add_f32 v92, v92, v12
    v_add_f32 v93, v93, v13
    v_add_f32 v94, v94, v14
    v_add_f32 v95, v95, v15
    v_mul_f32 v8, v88, v16
    v_mul_f32 v9, v89, v16
    v_maximum3_f32 v96, abs(v88), abs(v89), v96
    v_mul_f32 v10, v90, v16
    v_mul_f32 v11, v91, v16
    v_maximum3_f32 v96, abs(v90), abs(v91), v96
    v_mul_f32 v12, v92, v16
    v_mul_f32 v13, v93, v16
    v_maximum3_f32 v96, abs(v92), abs(v93), v96
    v_mul_f32 v14, v94, v16
    v_mul_f32 v15, v95, v16
    v_maximum3_f32 v17, abs(v94), abs(v95), v96
    v_cvt_pk_bf16_f32 v20, v8, v9
    v_cmp_nlt_f32 vcc, v17, v155
    v_cvt_pk_bf16_f32 v21, v10, v11
    v_cvt_pk_bf16_f32 v22, v12, v13
    v_cvt_pk_bf16_f32 v23, v14, v15
    s_cbranch_vccnz L_fallback
    buffer_store_dwordx4 v[20:23], v2, s[32:35], s18 offen sc1
    s_waitcnt lgkmcnt(0)
    s_endpgm
L_xs1:
    s_sleep 1
    ds_read_b32 v17, v154 offset:32
    ds_read_b128 v[8:11], v153
    ds_read_b128 v[12:15], v153 offset:1024
    ds_read_b32 v16, v153 offset:2048
    s_waitcnt lgkmcnt(0)
    s_branch L_xc1
L_sp111:
    ds_read_b32 v138, v140
    s_waitcnt lgkmcnt(0)
    v_cmp_lt_u32 vcc, v138, v137
    s_cbranch_vccnz L_sp111
    s_branch L_sp1b11
L_sp110:
    ds_read_b32 v138, v140
    s_waitcnt lgkmcnt(0)
    v_cmp_lt_u32 vcc, v138, v137
    s_cbranch_vccnz L_sp110
    s_branch L_sp1b10
L_done:
L_fallback:
    s_mov_b32 s72, s64
    s_mov_b32 s73, 64
    v_mov_b32 v4, 0xff800000
L_fb_loop:
    buffer_load_dwordx4 v[112:115], v2, s[32:35], s72 offen sc1
    s_add_u32 s72, s72, 3072
    s_waitcnt vmcnt(0)
    v_mfma_f32_32x32x16_bf16 v[24:39], v[112:115], v[108:111], 0
    s_nop 12
    v_max3_f32 v4, v4, v24, v25
    v_max3_f32 v4, v4, v26, v27
    v_max3_f32 v4, v4, v28, v29
    v_max3_f32 v4, v4, v30, v31
    v_max3_f32 v4, v4, v32, v33
    v_max3_f32 v4, v4, v34, v35
    v_max3_f32 v4, v4, v36, v37
    v_max3_f32 v4, v4, v38, v39
    s_sub_u32 s73, s73, 1
    s_cmp_lg_u32 s73, 0
    s_cbranch_scc1 L_fb_loop
    v_mov_b32 v148, v4
    v_mov_b32 v149, v5
    s_nop 1
    v_permlane32_swap_b32 v148, v4
    v_permlane32_swap_b32 v149, v5
    s_nop 1
    v_max_f32 v4, v4, v148
    v_max_f32 v5, v5, v149
    v_sub_f32 v56, 0, v4
    v_sub_f32 v57, 0, v4
    v_sub_f32 v58, 0, v4
    v_sub_f32 v59, 0, v4
    v_sub_f32 v60, 0, v4
    v_sub_f32 v61, 0, v4
    v_sub_f32 v62, 0, v4
    v_sub_f32 v63, 0, v4
    v_sub_f32 v64, 0, v4
    v_sub_f32 v65, 0, v4
    v_sub_f32 v66, 0, v4
    v_sub_f32 v67, 0, v4
    v_sub_f32 v68, 0, v4
    v_sub_f32 v69, 0, v4
    v_sub_f32 v70, 0, v4
    v_sub_f32 v71, 0, v4
    v_mov_b64 v[88:89], 0
    v_mov_b64 v[90:91], 0
    v_mov_b64 v[92:93], 0
    v_mov_b64 v[94:95], 0
    v_mov_b64 v[96:97], 0
    v_mov_b64 v[98:99], 0
    v_mov_b64 v[100:101], 0
    v_mov_b64 v[102:103], 0
    s_mov_b32 s72, s64
    s_mov_b32 s73, 64
L_fb_2:
    buffer_load_dwordx4 v[112:115], v2, s[32:35], s72 offen sc1
    s_mov_b64 exec, s[66:67]
    buffer_load_dwordx4 v[120:123], v2, s[32:35], s72 offen offset:1024 sc1
    buffer_load_dwordx4 v[124:127], v2, s[32:35], s72 offen offset:1280 sc1
    s_mov_b64 exec, -1
    s_add_u32 s72, s72, 3072
    s_waitcnt vmcnt(0)
    v_mfma_f32_32x32x16_bf16 v[24:39], v[112:115], v[108:111], v[56:71]
    s_nop 12
    v_exp_f32 v24, v24
    v_exp_f32 v25, v25
    v_exp_f32 v26, v26
    v_exp_f32 v27, v27
    v_exp_f32 v28, v28
    v_exp_f32 v29, v29
    v_exp_f32 v30, v30
    v_exp_f32 v31, v31
    v_exp_f32 v32, v32
    v_exp_f32 v33, v33
    v_exp_f32 v34, v34
    v_exp_f32 v35, v35
    v_exp_f32 v36, v36
    v_exp_f32 v37, v37
    v_exp_f32 v38, v38
    v_exp_f32 v39, v39
    s_nop 2
    v_smfmac_f32_32x32x32_bf16 v[88:103], v[120:123], v[24:31], v141
    v_smfmac_f32_32x32x32_bf16 v[88:103], v[124:127], v[32:39], v141
    s_sub_u32 s73, s73, 1
    s_cmp_lg_u32 s73, 0
    s_nop 12
    s_cbranch_scc1 L_fb_2
    v_mul_f32 v96, 0x3eeff558, v96
    v_rcp_f32 v16, v96
    s_nop 0
    v_mul_f32 v8, v88, v16
    v_mul_f32 v9, v89, v16
    v_mul_f32 v10, v90, v16
    v_mul_f32 v11, v91, v16
    v_mul_f32 v12, v92, v16
    v_mul_f32 v13, v93, v16
    v_mul_f32 v14, v94, v16
    v_mul_f32 v15, v95, v16
    v_cvt_pk_bf16_f32 v20, v8, v9
    v_cvt_pk_bf16_f32 v21, v10, v11
    v_cvt_pk_bf16_f32 v22, v12, v13
    v_cvt_pk_bf16_f32 v23, v14, v15
    buffer_store_dwordx4 v[20:23], v2, s[32:35], s18 offen sc1
    s_waitcnt lgkmcnt(0)
    s_endpgm
L_end:
    s_endpgm
.p2align 6
L_ffn:
    s_sub_u32 s7, s3, 8
    v_lshrrev_b32 v18, 3, v1
    v_mul_u32_u24 v18, 3072, v18
    v_bfe_u32 v19, v1, 4, 1
    v_lshlrev_b32 v19, 1, v19
    v_and_b32 v20, 7, v1
    v_xor_b32 v19, v19, v20
    v_lshl_add_u32 v4, v19, 4, v18
    v_xor_b32 v5, 64, v4
    v_add_u32 v5, 24576, v5
    s_lshl_b32 s13, s5, 7
    s_mul_i32 s8, s7, 49152
    s_add_u32 s13, s13, s8
    s_mul_i32 s14, s7, 6144
    s_add_u32 s14, s14, 65536
    s_mov_b32 s11, s10
    s_lshr_b32 s20, s7, 1
    s_lshr_b32 s21, s2, 3
    s_lshl_b32 s21, s21, 1
    s_add_u32 s21, s21, s20
    s_mul_i32 s21, s21, 2752
    s_and_b32 s22, s2, 6
    s_mul_i32 s22, s22, 352
    s_add_u32 s70, s21, s22
    v_lshrrev_b32 v26, 3, v1
    v_min_u32 v26, 7, v26
    v_mul_u32_u24 v26, 176128, v26
    v_and_b32 v27, 7, v1
    v_lshlrev_b32 v27, 7, v27
    v_min_u32 v27, 700, v27
    v_add_u32 v26, v27, v26
    s_mov_b32 s38, 1409024
    s_mov_b32 s39, 0x20000
    s_cmp_eq_u32 s17, 1
    s_waitcnt lgkmcnt(0)
    s_lshl_b32 s8, s7, 3
    s_add_u32 s8, s8, s2
    s_cmp_ge_u32 s2, 8
    s_cselect_b32 s8, 16, s8
    s_cmp_ge_u32 s8, 9
    s_cbranch_scc1 L_f_noclr
    s_lshl_b32 s8, s8, 13
    s_add_u32 s8, s8, 17039360
    v_lshlrev_b32 v18, 7, v1
    buffer_store_dword v6, v18, s[32:35], s8 offen sc1
L_f_noclr:
    s_load_dwordx2 s[44:45], s[0:1], 48
    s_load_dwordx2 s[48:49], s[0:1], 16
    s_load_dwordx2 s[52:53], s[0:1], 56
    s_mov_b32 s42, 1409024
    s_mov_b32 s43, 0x20000
    s_mov_b32 s46, 1409024
    s_mov_b32 s47, 0x20000
    s_mov_b32 s50, 524288
    s_mov_b32 s51, 0x20000
    s_mov_b32 s54, 2097152
    s_mov_b32 s55, 0x20000
    s_lshr_b32 s20, s7, 1
    s_mul_i32 s60, s5, 11
    s_min_u32 s60, s60, 75
    s_lshl_b32 s22, s60, 5
    s_mul_i32 s61, s20, 160
    s_movk_i32 s21, 2752
    v_add3_u32 v20, 0, v1, s61
    v_mul_u32_u24 v18, 745, v20
    v_lshrrev_b32 v18, 14, v18
    v_mul_u32_u24 v19, 22, v18
    v_sub_u32 v19, v20, v19
    v_lshl_add_u32 v19, v19, 4, s22
    v_and_b32 v21, 8, v18
    v_add_u32 v18, v18, v21
    v_mad_u32_u24 v164, v18, s21, v19
    v_add3_u32 v20, 64, v1, s61
    v_mul_u32_u24 v18, 745, v20
    v_lshrrev_b32 v18, 14, v18
    v_mul_u32_u24 v19, 22, v18
    v_sub_u32 v19, v20, v19
    v_lshl_add_u32 v19, v19, 4, s22
    v_and_b32 v21, 8, v18
    v_add_u32 v18, v18, v21
    v_mad_u32_u24 v165, v18, s21, v19
    v_subrev_u32 v165, 1024, v165
    v_add_u32 v20, 64, v20
    v_mul_u32_u24 v18, 745, v20
    v_lshrrev_b32 v18, 14, v18
    v_mul_u32_u24 v19, 22, v18
    v_sub_u32 v19, v20, v19
    v_lshl_add_u32 v19, v19, 4, s22
    v_and_b32 v21, 8, v18
    v_add_u32 v18, v18, v21
    v_mad_u32_u24 v166, v18, s21, v19
    v_subrev_u32 v166, 2048, v166
    s_mul_i32 s21, s7, 3
    s_add_u32 s60, s60, s21
    s_lshl_b32 s61, s61, 4
    s_mul_i32 s21, s17, 5760
    s_add_u32 s61, s61, s21
    s_and_b32 s63, s10, 0
    s_mov_b32 s71, 0
    s_mul_i32 s63, s17, 22016
    s_mov_b32 s66, -1
    s_mov_b32 s67, 0xffff
    v_and_b32 v18, 15, v1
    v_lshrrev_b32 v19, 4, v1
    v_bfe_u32 v20, v1, 1, 3
    v_xor_b32 v20, v20, v19
    v_lshlrev_b32 v19, 7, v18
    v_lshl_add_u32 v3, v20, 4, v19
    s_mov_b32 s8, 65536
    v_lshl_add_u32 v25, v1, 2, s8
    s_cmp_eq_u32 s17, 1
    s_waitcnt lgkmcnt(0)
    s_lshl_b32 s8, s2, 7
    s_lshl_b32 s9, s7, 5
    s_add_u32 s8, s8, s9
    s_add_u32 s8, s8, 17170432
    s_buffer_load_dword s23, s[32:35], s8 glc
    s_add_u32 s8, s7, 65648
    v_mov_b32 v16, s8
    v_mov_b32 v17, 65648
    s_mov_b32 s62, 0x01010101
    v_mov_b32 v14, 1
    v_xor_b32 v13, 64, v3
    s_movk_i32 s71, 0x2000
    v_lshrrev_b32 v18, 5, v1
    v_bfe_u32 v19, v1, 2, 2
    v_lshl_add_u32 v18, v18, 3, v19
    v_mul_u32_u24 v18, 352, v18
    v_and_b32 v20, 1, v1
    v_lshl_add_u32 v18, v20, 4, v18
    v_bfe_u32 v20, v1, 1, 1
    v_lshl_add_u32 v18, v20, 3, v18
    v_bfe_u32 v19, v1, 4, 1
    v_mul_u32_u24 v19, 5760, v19
    s_mul_i32 s8, s7, 96
    s_add_u32 s8, s8, 65792
    v_add3_u32 v12, v18, v19, s8
    s_barrier
    s_add_u32 m0, s14, 0
    s_mul_i32 s9, s11, 196608
    s_add_u32 s9, s9, s13
    buffer_load_dwordx4 v4, s[28:31], s9 offen offset:0 lds
    buffer_load_dwordx4 v4, s[28:31], s9 offen offset:1024 lds
    buffer_load_dwordx4 v4, s[28:31], s9 offen offset:2048 lds
    s_add_u32 m0, m0, 3072
    s_add_u32 s11, s11, 1
    buffer_load_dwordx4 v5, s[28:31], s9 offen offset:0 lds
    buffer_load_dwordx4 v5, s[28:31], s9 offen offset:1024 lds
    buffer_load_dwordx4 v5, s[28:31], s9 offen offset:2048 lds
    s_and_b32 s11, s11, 7
    s_add_u32 m0, s14, 24576
    s_mul_i32 s9, s11, 196608
    s_add_u32 s9, s9, s13
    buffer_load_dwordx4 v4, s[28:31], s9 offen offset:0 lds
    buffer_load_dwordx4 v4, s[28:31], s9 offen offset:1024 lds
    buffer_load_dwordx4 v4, s[28:31], s9 offen offset:2048 lds
    s_add_u32 m0, m0, 3072
    s_add_u32 s11, s11, 1
    buffer_load_dwordx4 v5, s[28:31], s9 offen offset:0 lds
    buffer_load_dwordx4 v5, s[28:31], s9 offen offset:1024 lds
    buffer_load_dwordx4 v5, s[28:31], s9 offen offset:2048 lds
    s_and_b32 s11, s11, 7
    s_add_u32 m0, s14, 49152
    s_mul_i32 s9, s11, 196608
    s_add_u32 s9, s9, s13
    buffer_load_dwordx4 v4, s[28:31], s9 offen offset:0 lds
    buffer_load_dwordx4 v4, s[28:31], s9 offen offset:1024 lds
    buffer_load_dwordx4 v4, s[28:31], s9 offen offset:2048 lds
    s_add_u32 m0, m0, 3072
    s_add_u32 s11, s11, 1
    buffer_load_dwordx4 v5, s[28:31], s9 offen offset:0 lds
    buffer_load_dwordx4 v5, s[28:31], s9 offen offset:1024 lds
    buffer_load_dwordx4 v5, s[28:31], s9 offen offset:2048 lds
    s_and_b32 s11, s11, 7
    s_mov_b32 exec_lo, 0x7f7f7f7f
    s_mov_b32 exec_hi, 0x0
    s_cmp_eq_u32 s17, 1
    s_cbranch_scc1 L_pu1
    buffer_load_dword v27, v26, s[36:39], s70 offen
    s_branch L_pd1
L_pu1:
    buffer_load_dword v27, v26, s[40:43], s70 offen
L_pd1:
    s_mov_b64 exec, -1
    s_waitcnt vmcnt(13)
    s_barrier
    s_lshl_b32 s8, s7, 3
    s_or_b32 s8, s8, s2
    s_cmp_ge_u32 s8, 8
    s_cbranch_scc1 L_f_notag
    s_lshl_b32 s8, s2, 2
    s_mov_b64 exec, 1
    buffer_store_dword v14, off, s[56:59], s8 sc1
    s_mov_b64 exec, -1
L_f_notag:
    v_and_b32 v18, 7, v1
    v_lshlrev_b32 v18, 2, v18
    s_add_u32 m0, s14, 73728
    s_mul_i32 s9, s11, 196608
    s_add_u32 s9, s9, s13
    buffer_load_dwordx4 v4, s[28:31], s9 offen offset:0 lds
    buffer_load_dwordx4 v4, s[28:31], s9 offen offset:1024 lds
    buffer_load_dwordx4 v4, s[28:31], s9 offen offset:2048 lds
    s_add_u32 m0, m0, 3072
    s_add_u32 s11, s11, 1
    buffer_load_dwordx4 v5, s[28:31], s9 offen offset:0 lds
    buffer_load_dwordx4 v5, s[28:31], s9 offen offset:1024 lds
    buffer_load_dwordx4 v5, s[28:31], s9 offen offset:2048 lds
    s_and_b32 s11, s11, 7
    s_waitcnt vmcnt(13)
    s_barrier
    s_add_u32 m0, s14, 0
    s_mul_i32 s9, s11, 196608
    s_add_u32 s9, s9, s13
    buffer_load_dwordx4 v4, s[28:31], s9 offen offset:0 lds
    buffer_load_dwordx4 v4, s[28:31], s9 offen offset:1024 lds
    buffer_load_dwordx4 v4, s[28:31], s9 offen offset:2048 lds
    s_add_u32 m0, m0, 3072
    s_add_u32 s11, s11, 1
    buffer_load_dwordx4 v5, s[28:31], s9 offen offset:0 lds
    buffer_load_dwordx4 v5, s[28:31], s9 offen offset:1024 lds
    buffer_load_dwordx4 v5, s[28:31], s9 offen offset:2048 lds
    s_and_b32 s11, s11, 7
    s_waitcnt vmcnt(13)
    s_barrier
    s_add_u32 m0, s14, 24576
    s_mul_i32 s9, s11, 196608
    s_add_u32 s9, s9, s13
    buffer_load_dwordx4 v4, s[28:31], s9 offen offset:0 lds
    buffer_load_dwordx4 v4, s[28:31], s9 offen offset:1024 lds
    buffer_load_dwordx4 v4, s[28:31], s9 offen offset:2048 lds
    s_add_u32 m0, m0, 3072
    s_add_u32 s11, s11, 1
    buffer_load_dwordx4 v5, s[28:31], s9 offen offset:0 lds
    buffer_load_dwordx4 v5, s[28:31], s9 offen offset:1024 lds
    buffer_load_dwordx4 v5, s[28:31], s9 offen offset:2048 lds
    s_and_b32 s11, s11, 7
    s_waitcnt vmcnt(12)
    s_barrier
    s_add_u32 m0, s14, 49152
    s_mul_i32 s9, s11, 196608
    s_add_u32 s9, s9, s13
    buffer_load_dwordx4 v4, s[28:31], s9 offen offset:0 lds
    buffer_load_dwordx4 v4, s[28:31], s9 offen offset:1024 lds
    buffer_load_dwordx4 v4, s[28:31], s9 offen offset:2048 lds
    s_add_u32 m0, m0, 3072
    s_add_u32 s11, s11, 1
    buffer_load_dwordx4 v5, s[28:31], s9 offen offset:0 lds
    buffer_load_dwordx4 v5, s[28:31], s9 offen offset:1024 lds
    buffer_load_dwordx4 v5, s[28:31], s9 offen offset:2048 lds
    s_and_b32 s11, s11, 7
    s_waitcnt vmcnt(12)
    s_barrier
    s_add_u32 m0, s14, 73728
    s_mul_i32 s9, s11, 196608
    s_add_u32 s9, s9, s13
    buffer_load_dwordx4 v4, s[28:31], s9 offen offset:0 lds
    buffer_load_dwordx4 v4, s[28:31], s9 offen offset:1024 lds
    buffer_load_dwordx4 v4, s[28:31], s9 offen offset:2048 lds
    s_add_u32 m0, m0, 3072
    s_add_u32 s11, s11, 1
    buffer_load_dwordx4 v5, s[28:31], s9 offen offset:0 lds
    buffer_load_dwordx4 v5, s[28:31], s9 offen offset:1024 lds
    buffer_load_dwordx4 v5, s[28:31], s9 offen offset:2048 lds
    s_and_b32 s11, s11, 7
    s_waitcnt vmcnt(12)
    s_barrier
    buffer_load_dword v7, v18, s[56:59], 0 offen
    s_waitcnt vmcnt(7)
    s_barrier
    s_waitcnt vmcnt(0)
    s_barrier
    s_mov_b32 s22, 262144
L_ftag:
    v_cmp_eq_u32 vcc, 0, v7
    s_cbranch_vccz L_ftagok
    buffer_load_dword v7, v18, s[56:59], 0 offen sc1
    s_sub_u32 s22, s22, 1
    s_waitcnt vmcnt(0)
    s_cbranch_scc0 L_ftag
L_ftagok:
    s_cmp_lg_u32 s7, 0
    s_cbranch_scc1 L_f_noz
    ds_write_b32 v25, v6
L_f_noz:
    s_mul_i32 s16, s7, 12288
    s_add_u32 s16, s16, 65792
    s_lshl_b32 s15, s7, 11
    s_and_b32 s68, s2, 7
    s_lshl_b32 s68, s68, 2
    s_bfe_u32 s8, s2, 0x20003
    s_add_u32 s68, s68, s8
    s_lshr_b32 s69, s2, 5
    v_lshrrev_b32 v21, 3, v1
    v_bfe_u32 v22, v1, 4, 1
    v_lshlrev_b32 v22, 2, v22
    v_and_b32 v20, 7, v1
    v_xor_b32 v22, v22, v20
    v_lshlrev_b32 v22, 4, v22
    v_lshl_add_u32 v4, v21, 10, v22
    s_lshl_b32 s8, s69, 7
    v_add_u32 v4, s8, v4
    v_add_u32 v5, 7168, v4
    v_lshrrev_b32 v21, 5, v1
    v_bfe_u32 v22, v1, 2, 2
    v_lshl_add_u32 v21, v21, 2, v22
    v_lshlrev_b32 v21, 7, v21
    v_bfe_u32 v22, v1, 3, 1
    v_lshl_add_u32 v21, v22, 6, v21
    v_bfe_u32 v22, v1, 4, 1
    v_lshl_add_u32 v21, v22, 5, v21
    v_and_b32 v22, 3, v1
    v_lshl_add_u32 v21, v22, 3, v21
    s_lshl_b32 s8, s7, 5
    s_and_b32 s8, s8, 64
    v_xor_b32 v21, s8, v21
    v_add_u32 v6, s16, v21
    v_xor_b32 v7, 64, v6
    s_cmp_eq_u32 s7, 3
    s_cselect_b32 s9, 20, 22
    s_lshl_b32 s8, s68, 1
    s_add_u32 s8, s8, s69
    s_and_b32 s8, s8, 7
    s_mul_i32 s8, s8, s9
    s_lshr_b32 s8, s8, 3
    s_mul_i32 s72, s7, 22
    s_lshl_b32 s12, s72, 14
    s_add_u32 s9, s72, s9
    s_lshl_b32 s13, s9, 14
    s_add_u32 s8, s8, s72
    s_lshl_b32 s72, s8, 14
    s_mul_i32 s74, s68, 241664
    s_add_u32 s74, s74, 8388608
    s_add_u32 s14, s74, 32768
    s_mov_b32 s73, s72
    s_add_u32 s72, s72, 98304
    s_sub_u32 s8, s13, s12
    s_cmp_ge_u32 s72, s13
    s_cselect_b32 s8, s8, 0
    s_sub_u32 s72, s72, s8
    s_lshl_b32 s8, s68, 1
    s_and_b32 s9, s7, 1
    s_add_u32 s8, s8, s9
    s_lshl_b32 s8, s8, 15
    s_lshl_b32 s9, s69, 7
    s_add_u32 s8, s8, s9
    s_lshr_b32 s9, s7, 1
    s_lshl_b32 s9, s9, 6
    s_add_u32 s75, s8, s9
    s_waitcnt lgkmcnt(0)
    s_barrier
    s_add_u32 m0, s61, 65792
    s_nop 0
    buffer_load_dwordx4 v164, s[36:39], s63 offen offset:0 lds
    buffer_load_dwordx4 v165, s[36:39], s63 offen offset:1024 lds
    buffer_load_dwordx4 v166, s[36:39], s63 offen offset:2048 lds
    s_add_u32 m0, s61, 77184
    s_nop 0
    buffer_load_dwordx4 v164, s[40:43], s63 offen offset:0 lds
    buffer_load_dwordx4 v165, s[40:43], s63 offen offset:1024 lds
    buffer_load_dwordx4 v166, s[40:43], s63 offen offset:2048 lds
    s_add_u32 s63, s63, 88064
    s_add_u32 m0, s61, 88576
    s_nop 0
    buffer_load_dwordx4 v164, s[36:39], s63 offen offset:0 lds
    buffer_load_dwordx4 v165, s[36:39], s63 offen offset:1024 lds
    buffer_load_dwordx4 v166, s[36:39], s63 offen offset:2048 lds
    s_add_u32 m0, s61, 99968
    s_nop 0
    buffer_load_dwordx4 v164, s[40:43], s63 offen offset:0 lds
    buffer_load_dwordx4 v165, s[40:43], s63 offen offset:1024 lds
    buffer_load_dwordx4 v166, s[40:43], s63 offen offset:2048 lds
    s_add_u32 s63, s63, 88064
    s_add_u32 m0, s61, 111360
    s_nop 0
    buffer_load_dwordx4 v164, s[36:39], s63 offen offset:0 lds
    buffer_load_dwordx4 v165, s[36:39], s63 offen offset:1024 lds
    buffer_load_dwordx4 v166, s[36:39], s63 offen offset:2048 lds
    s_setprio 2
    s_lshr_b32 s8, s2, 3
    s_lshl_b32 s8, s8, 2
    s_add_u32 s8, s8, s7
    s_mul_i32 s64, s8, 11008
    s_lshl_b32 s65, s8, 12
    v_lshlrev_b32 v18, 7, v1
    v_mov_b32 v19, v21
    s_waitcnt vmcnt(9)
    ds_write_b8 v16, v14
L_f_sp:
    ds_read_b32 v15, v17
    s_waitcnt lgkmcnt(0)
    v_cmp_ne_u32 vcc, s62, v15
    s_cbranch_vccnz L_f_sp
    ds_read_b64_tr_b16 v[28:29], v12 offset:0
    ds_read_b64_tr_b16 v[30:31], v12 offset:1408
    ds_read_b128 v[44:47], v3 offset:0
    ds_read_b128 v[48:51], v3 offset:2048
    ds_read_b128 v[52:55], v3 offset:4096
    ds_read_b128 v[56:59], v3 offset:6144
    ds_read_b64_tr_b16 v[32:33], v12 offset:32
    ds_read_b64_tr_b16 v[34:35], v12 offset:1440
    ds_read_b64_tr_b16 v[36:37], v12 offset:64
    ds_read_b64_tr_b16 v[38:39], v12 offset:1472
    s_cmp_eq_u32 s7, 3
    s_waitcnt vmcnt(6) lgkmcnt(0)
    ds_write_b8 v16, v14 offset:4
    s_cbranch_scc1 L_f3
    v_mfma_f32_16x16x32_bf16 v[68:71], v[28:31], v[44:47], 0
    ds_read_b64_tr_b16 v[40:41], v12 offset:11392
    ds_read_b64_tr_b16 v[42:43], v12 offset:12800
    v_mfma_f32_16x16x32_bf16 v[72:75], v[28:31], v[48:51], 0
    ds_read_b128 v[60:63], v13 offset:0
    v_mfma_f32_16x16x32_bf16 v[84:87], v[28:31], v[52:55], 0
    ds_read_b128 v[64:67], v13 offset:2048
    v_mfma_f32_16x16x32_bf16 v[88:91], v[28:31], v[56:59], 0
    ds_read_b64_tr_b16 v[28:29], v12 offset:11424
    v_mfma_f32_16x16x32_bf16 v[120:123], v[32:35], v[56:59], 0
    ds_read_b64_tr_b16 v[30:31], v12 offset:12832
    ds_read_b32 v15, v17 offset:4
    v_mfma_f32_16x16x32_bf16 v[116:119], v[32:35], v[52:55], 0
    s_add_u32 m0, s61, 65792
    v_mfma_f32_16x16x32_bf16 v[104:107], v[32:35], v[48:51], 0
    v_mfma_f32_16x16x32_bf16 v[100:103], v[32:35], v[44:47], 0
    ds_read_b64_tr_b16 v[32:33], v12 offset:11456
    v_mfma_f32_16x16x32_bf16 v[132:135], v[36:39], v[44:47], 0
    ds_read_b64_tr_b16 v[34:35], v12 offset:12864
    s_waitcnt lgkmcnt(2)
    v_cmp_ne_u32 vcc, s62, v15
    s_cbranch_vccnz L_f_sp3_0
L_f_sb3_0:
    v_mfma_f32_16x16x32_bf16 v[136:139], v[36:39], v[48:51], 0
    buffer_load_dwordx4 v164, s[40:43], s63 offen offset:0 lds
    v_mfma_f32_16x16x32_bf16 v[148:151], v[36:39], v[52:55], 0
    buffer_load_dwordx4 v165, s[40:43], s63 offen offset:1024 lds
    v_mfma_f32_16x16x32_bf16 v[152:155], v[36:39], v[56:59], 0
    buffer_load_dwordx4 v166, s[40:43], s63 offen offset:2048 lds
    s_add_u32 s63, s63, 88064
    s_waitcnt vmcnt(6) lgkmcnt(0)
    ds_write_b8 v16, v14 offset:8
    v_mfma_f32_16x16x32_bf16 v[96:99], v[40:43], v[56:59], 0
    ds_read_b64_tr_b16 v[36:37], v12 offset:22784
    ds_read_b64_tr_b16 v[38:39], v12 offset:24192
    v_mfma_f32_16x16x32_bf16 v[92:95], v[40:43], v[52:55], 0
    ds_read_b128 v[8:11], v13 offset:4096
    v_mfma_f32_16x16x32_bf16 v[80:83], v[40:43], v[48:51], 0
    ds_read_b128 v[20:23], v13 offset:6144
    v_mfma_f32_16x16x32_bf16 v[76:79], v[40:43], v[44:47], 0
    ds_read_b64_tr_b16 v[40:41], v12 offset:22816
    v_mfma_f32_16x16x32_bf16 v[108:111], v[28:31], v[44:47], 0
    ds_read_b64_tr_b16 v[42:43], v12 offset:24224
    ds_read_b32 v15, v17 offset:8
    v_mfma_f32_16x16x32_bf16 v[112:115], v[28:31], v[48:51], 0
    s_add_u32 m0, s61, 77184
    v_mfma_f32_16x16x32_bf16 v[124:127], v[28:31], v[52:55], 0
    v_mfma_f32_16x16x32_bf16 v[128:131], v[28:31], v[56:59], 0
    ds_read_b64_tr_b16 v[28:29], v12 offset:22848
    v_mfma_f32_16x16x32_bf16 v[160:163], v[32:35], v[56:59], 0
    ds_read_b64_tr_b16 v[30:31], v12 offset:24256
    s_waitcnt lgkmcnt(2)
    v_cmp_ne_u32 vcc, s62, v15
    s_cbranch_vccnz L_f_sp3_1
L_f_sb3_1:
    v_mfma_f32_16x16x32_bf16 v[156:159], v[32:35], v[52:55], 0
    buffer_load_dwordx4 v164, s[36:39], s63 offen offset:0 lds
    v_mfma_f32_16x16x32_bf16 v[144:147], v[32:35], v[48:51], 0
    buffer_load_dwordx4 v165, s[36:39], s63 offen offset:1024 lds
    v_mfma_f32_16x16x32_bf16 v[140:143], v[32:35], v[44:47], 0
    buffer_load_dwordx4 v166, s[36:39], s63 offen offset:2048 lds
    s_waitcnt vmcnt(6) lgkmcnt(0)
    ds_write_b8 v16, v14 offset:12
    v_mfma_f32_16x16x32_bf16 v[68:71], v[36:39], v[60:63], v[68:71]
    ds_read_b64_tr_b16 v[32:33], v12 offset:34176
    ds_read_b64_tr_b16 v[34:35], v12 offset:35584
    v_mfma_f32_16x16x32_bf16 v[72:75], v[36:39], v[64:67], v[72:75]
    ds_read_b128 v[44:47], v3 offset:8192
    v_mfma_f32_16x16x32_bf16 v[84:87], v[36:39], v[8:11], v[84:87]
    ds_read_b128 v[48:51], v3 offset:10240
    v_mfma_f32_16x16x32_bf16 v[88:91], v[36:39], v[20:23], v[88:91]
    ds_read_b64_tr_b16 v[36:37], v12 offset:34208
    v_mfma_f32_16x16x32_bf16 v[120:123], v[40:43], v[20:23], v[120:123]
    ds_read_b64_tr_b16 v[38:39], v12 offset:35616
    ds_read_b32 v15, v17 offset:12
    v_mfma_f32_16x16x32_bf16 v[116:119], v[40:43], v[8:11], v[116:119]
    s_add_u32 m0, s61, 88576
    v_mfma_f32_16x16x32_bf16 v[104:107], v[40:43], v[64:67], v[104:107]
    v_mfma_f32_16x16x32_bf16 v[100:103], v[40:43], v[60:63], v[100:103]
    ds_read_b64_tr_b16 v[40:41], v12 offset:34240
    v_mfma_f32_16x16x32_bf16 v[132:135], v[28:31], v[60:63], v[132:135]
    ds_read_b64_tr_b16 v[42:43], v12 offset:35648
    s_waitcnt lgkmcnt(2)
    v_cmp_ne_u32 vcc, s62, v15
    s_cbranch_vccnz L_f_sp3_2
L_f_sb3_2:
    v_mfma_f32_16x16x32_bf16 v[136:139], v[28:31], v[64:67], v[136:139]
    buffer_load_dwordx4 v164, s[40:43], s63 offen offset:0 lds
    v_mfma_f32_16x16x32_bf16 v[148:151], v[28:31], v[8:11], v[148:151]
    buffer_load_dwordx4 v165, s[40:43], s63 offen offset:1024 lds
    v_mfma_f32_16x16x32_bf16 v[152:155], v[28:31], v[20:23], v[152:155]
    buffer_load_dwordx4 v166, s[40:43], s63 offen offset:2048 lds
    s_add_u32 s63, s63, 88064
    s_waitcnt vmcnt(6) lgkmcnt(0)
    ds_write_b8 v16, v14 offset:16
    v_mfma_f32_16x16x32_bf16 v[96:99], v[32:35], v[20:23], v[96:99]
    ds_read_b64_tr_b16 v[28:29], v12 offset:45568
    ds_read_b64_tr_b16 v[30:31], v12 offset:46976
    v_mfma_f32_16x16x32_bf16 v[92:95], v[32:35], v[8:11], v[92:95]
    ds_read_b128 v[52:55], v3 offset:12288
    v_mfma_f32_16x16x32_bf16 v[80:83], v[32:35], v[64:67], v[80:83]
    ds_read_b128 v[56:59], v3 offset:14336
    v_mfma_f32_16x16x32_bf16 v[76:79], v[32:35], v[60:63], v[76:79]
    ds_read_b64_tr_b16 v[32:33], v12 offset:45600
    v_mfma_f32_16x16x32_bf16 v[108:111], v[36:39], v[60:63], v[108:111]
    ds_read_b64_tr_b16 v[34:35], v12 offset:47008
    ds_read_b32 v15, v17 offset:16
    v_mfma_f32_16x16x32_bf16 v[112:115], v[36:39], v[64:67], v[112:115]
    s_add_u32 m0, s61, 99968
    v_mfma_f32_16x16x32_bf16 v[124:127], v[36:39], v[8:11], v[124:127]
    v_mfma_f32_16x16x32_bf16 v[128:131], v[36:39], v[20:23], v[128:131]
    ds_read_b64_tr_b16 v[36:37], v12 offset:45632
    v_mfma_f32_16x16x32_bf16 v[160:163], v[40:43], v[20:23], v[160:163]
    ds_read_b64_tr_b16 v[38:39], v12 offset:47040
    s_waitcnt lgkmcnt(2)
    v_cmp_ne_u32 vcc, s62, v15
    s_cbranch_vccnz L_f_sp3_3
L_f_sb3_3:
    v_mfma_f32_16x16x32_bf16 v[156:159], v[40:43], v[8:11], v[156:159]
    buffer_load_dwordx4 v164, s[36:39], s63 offen offset:0 lds
    v_mfma_f32_16x16x32_bf16 v[144:147], v[40:43], v[64:67], v[144:147]
    buffer_load_dwordx4 v165, s[36:39], s63 offen offset:1024 lds
    v_mfma_f32_16x16x32_bf16 v[140:143], v[40:43], v[60:63], v[140:143]
    buffer_load_dwordx4 v166, s[36:39], s63 offen offset:2048 lds
    s_waitcnt vmcnt(6) lgkmcnt(0)
    ds_write_b8 v16, v14 offset:20
    v_mfma_f32_16x16x32_bf16 v[68:71], v[28:31], v[44:47], v[68:71]
    ds_read_b64_tr_b16 v[40:41], v12 offset:0
    ds_read_b64_tr_b16 v[42:43], v12 offset:1408
    v_mfma_f32_16x16x32_bf16 v[72:75], v[28:31], v[48:51], v[72:75]
    ds_read_b128 v[60:63], v13 offset:8192
    v_mfma_f32_16x16x32_bf16 v[84:87], v[28:31], v[52:55], v[84:87]
    ds_read_b128 v[64:67], v13 offset:10240
    v_mfma_f32_16x16x32_bf16 v[88:91], v[28:31], v[56:59], v[88:91]
    ds_read_b64_tr_b16 v[28:29], v12 offset:32
    v_mfma_f32_16x16x32_bf16 v[120:123], v[32:35], v[56:59], v[120:123]
    ds_read_b64_tr_b16 v[30:31], v12 offset:1440
    ds_read_b32 v15, v17 offset:20
    v_mfma_f32_16x16x32_bf16 v[116:119], v[32:35], v[52:55], v[116:119]
    s_add_u32 m0, s61, 111360
    v_mfma_f32_16x16x32_bf16 v[104:107], v[32:35], v[48:51], v[104:107]
    v_mfma_f32_16x16x32_bf16 v[100:103], v[32:35], v[44:47], v[100:103]
    ds_read_b64_tr_b16 v[32:33], v12 offset:64
    v_mfma_f32_16x16x32_bf16 v[132:135], v[36:39], v[44:47], v[132:135]
    ds_read_b64_tr_b16 v[34:35], v12 offset:1472
    s_waitcnt lgkmcnt(2)
    v_cmp_ne_u32 vcc, s62, v15
    s_cbranch_vccnz L_f_sp3_4
L_f_sb3_4:
    v_mfma_f32_16x16x32_bf16 v[136:139], v[36:39], v[48:51], v[136:139]
    buffer_load_dwordx4 v164, s[40:43], s63 offen offset:0 lds
    v_mfma_f32_16x16x32_bf16 v[148:151], v[36:39], v[52:55], v[148:151]
    buffer_load_dwordx4 v165, s[40:43], s63 offen offset:1024 lds
    v_mfma_f32_16x16x32_bf16 v[152:155], v[36:39], v[56:59], v[152:155]
    buffer_load_dwordx4 v166, s[40:43], s63 offen offset:2048 lds
    s_add_u32 s63, s63, 88064
    s_waitcnt vmcnt(6) lgkmcnt(0)
    ds_write_b8 v16, v14 offset:24
    v_mfma_f32_16x16x32_bf16 v[96:99], v[40:43], v[56:59], v[96:99]
    ds_read_b64_tr_b16 v[36:37], v12 offset:11392
    ds_read_b64_tr_b16 v[38:39], v12 offset:12800
    v_mfma_f32_16x16x32_bf16 v[92:95], v[40:43], v[52:55], v[92:95]
    ds_read_b128 v[8:11], v13 offset:12288
    v_mfma_f32_16x16x32_bf16 v[80:83], v[40:43], v[48:51], v[80:83]
    ds_read_b128 v[20:23], v13 offset:14336
    v_mfma_f32_16x16x32_bf16 v[76:79], v[40:43], v[44:47], v[76:79]
    ds_read_b64_tr_b16 v[40:41], v12 offset:11424
    v_mfma_f32_16x16x32_bf16 v[108:111], v[28:31], v[44:47], v[108:111]
    ds_read_b64_tr_b16 v[42:43], v12 offset:12832
    ds_read_b32 v15, v17 offset:24
    v_mfma_f32_16x16x32_bf16 v[112:115], v[28:31], v[48:51], v[112:115]
    s_add_u32 m0, s61, 65792
    v_mfma_f32_16x16x32_bf16 v[124:127], v[28:31], v[52:55], v[124:127]
    v_mfma_f32_16x16x32_bf16 v[128:131], v[28:31], v[56:59], v[128:131]
    ds_read_b64_tr_b16 v[28:29], v12 offset:11456
    v_mfma_f32_16x16x32_bf16 v[160:163], v[32:35], v[56:59], v[160:163]
    ds_read_b64_tr_b16 v[30:31], v12 offset:12864
    s_waitcnt lgkmcnt(2)
    v_cmp_ne_u32 vcc, s62, v15
    s_cbranch_vccnz L_f_sp3_5
L_f_sb3_5:
    v_mfma_f32_16x16x32_bf16 v[156:159], v[32:35], v[52:55], v[156:159]
    buffer_load_dwordx4 v164, s[36:39], s63 offen offset:0 lds
    v_mfma_f32_16x16x32_bf16 v[144:147], v[32:35], v[48:51], v[144:147]
    buffer_load_dwordx4 v165, s[36:39], s63 offen offset:1024 lds
    v_mfma_f32_16x16x32_bf16 v[140:143], v[32:35], v[44:47], v[140:143]
    buffer_load_dwordx4 v166, s[36:39], s63 offen offset:2048 lds
    s_waitcnt vmcnt(6) lgkmcnt(0)
    ds_write_b8 v16, v14 offset:28
    v_mfma_f32_16x16x32_bf16 v[68:71], v[36:39], v[60:63], v[68:71]
    ds_read_b64_tr_b16 v[32:33], v12 offset:22784
    ds_read_b64_tr_b16 v[34:35], v12 offset:24192
    v_mfma_f32_16x16x32_bf16 v[72:75], v[36:39], v[64:67], v[72:75]
    ds_read_b128 v[44:47], v3 offset:16384
    v_mfma_f32_16x16x32_bf16 v[84:87], v[36:39], v[8:11], v[84:87]
    ds_read_b128 v[48:51], v3 offset:18432
    v_mfma_f32_16x16x32_bf16 v[88:91], v[36:39], v[20:23], v[88:91]
    ds_read_b64_tr_b16 v[36:37], v12 offset:22816
    v_mfma_f32_16x16x32_bf16 v[120:123], v[40:43], v[20:23], v[120:123]
    ds_read_b64_tr_b16 v[38:39], v12 offset:24224
    ds_read_b32 v15, v17 offset:28
    v_mfma_f32_16x16x32_bf16 v[116:119], v[40:43], v[8:11], v[116:119]
    s_add_u32 m0, s61, 77184
    v_mfma_f32_16x16x32_bf16 v[104:107], v[40:43], v[64:67], v[104:107]
    v_mfma_f32_16x16x32_bf16 v[100:103], v[40:43], v[60:63], v[100:103]
    ds_read_b64_tr_b16 v[40:41], v12 offset:22848
    v_mfma_f32_16x16x32_bf16 v[132:135], v[28:31], v[60:63], v[132:135]
    ds_read_b64_tr_b16 v[42:43], v12 offset:24256
    s_waitcnt lgkmcnt(2)
    v_cmp_ne_u32 vcc, s62, v15
    s_cbranch_vccnz L_f_sp3_6
L_f_sb3_6:
    v_mfma_f32_16x16x32_bf16 v[136:139], v[28:31], v[64:67], v[136:139]
    buffer_load_dwordx4 v164, s[40:43], s63 offen offset:0 lds
    v_mfma_f32_16x16x32_bf16 v[148:151], v[28:31], v[8:11], v[148:151]
    buffer_load_dwordx4 v165, s[40:43], s63 offen offset:1024 lds
    v_mfma_f32_16x16x32_bf16 v[152:155], v[28:31], v[20:23], v[152:155]
    buffer_load_dwordx4 v166, s[40:43], s63 offen offset:2048 lds
    s_add_u32 s63, s63, 88064
    s_waitcnt vmcnt(6) lgkmcnt(0)
    ds_write_b8 v16, v14 offset:32
    v_mfma_f32_16x16x32_bf16 v[96:99], v[32:35], v[20:23], v[96:99]
    ds_read_b64_tr_b16 v[28:29], v12 offset:34176
    ds_read_b64_tr_b16 v[30:31], v12 offset:35584
    v_mfma_f32_16x16x32_bf16 v[92:95], v[32:35], v[8:11], v[92:95]
    ds_read_b128 v[52:55], v3 offset:20480
    v_mfma_f32_16x16x32_bf16 v[80:83], v[32:35], v[64:67], v[80:83]
    ds_read_b128 v[56:59], v3 offset:22528
    v_mfma_f32_16x16x32_bf16 v[76:79], v[32:35], v[60:63], v[76:79]
    ds_read_b64_tr_b16 v[32:33], v12 offset:34208
    v_mfma_f32_16x16x32_bf16 v[108:111], v[36:39], v[60:63], v[108:111]
    ds_read_b64_tr_b16 v[34:35], v12 offset:35616
    ds_read_b32 v15, v17 offset:32
    v_mfma_f32_16x16x32_bf16 v[112:115], v[36:39], v[64:67], v[112:115]
    s_add_u32 m0, s61, 88576
    v_mfma_f32_16x16x32_bf16 v[124:127], v[36:39], v[8:11], v[124:127]
    v_mfma_f32_16x16x32_bf16 v[128:131], v[36:39], v[20:23], v[128:131]
    ds_read_b64_tr_b16 v[36:37], v12 offset:34240
    v_mfma_f32_16x16x32_bf16 v[160:163], v[40:43], v[20:23], v[160:163]
    ds_read_b64_tr_b16 v[38:39], v12 offset:35648
    s_waitcnt lgkmcnt(2)
    v_cmp_ne_u32 vcc, s62, v15
    s_cbranch_vccnz L_f_sp3_7
L_f_sb3_7:
    v_mfma_f32_16x16x32_bf16 v[156:159], v[40:43], v[8:11], v[156:159]
    buffer_load_dwordx4 v164, s[36:39], s63 offen offset:0 lds
    v_mfma_f32_16x16x32_bf16 v[144:147], v[40:43], v[64:67], v[144:147]
    buffer_load_dwordx4 v165, s[36:39], s63 offen offset:1024 lds
    v_mfma_f32_16x16x32_bf16 v[140:143], v[40:43], v[60:63], v[140:143]
    buffer_load_dwordx4 v166, s[36:39], s63 offen offset:2048 lds
    s_waitcnt vmcnt(6) lgkmcnt(0)
    ds_write_b8 v16, v14 offset:36
    v_mfma_f32_16x16x32_bf16 v[68:71], v[28:31], v[44:47], v[68:71]
    ds_read_b64_tr_b16 v[40:41], v12 offset:45568
    ds_read_b64_tr_b16 v[42:43], v12 offset:46976
    v_mfma_f32_16x16x32_bf16 v[72:75], v[28:31], v[48:51], v[72:75]
    ds_read_b128 v[60:63], v13 offset:16384
    v_mfma_f32_16x16x32_bf16 v[84:87], v[28:31], v[52:55], v[84:87]
    ds_read_b128 v[64:67], v13 offset:18432
    v_mfma_f32_16x16x32_bf16 v[88:91], v[28:31], v[56:59], v[88:91]
    ds_read_b64_tr_b16 v[28:29], v12 offset:45600
    v_mfma_f32_16x16x32_bf16 v[120:123], v[32:35], v[56:59], v[120:123]
    ds_read_b64_tr_b16 v[30:31], v12 offset:47008
    ds_read_b32 v15, v17 offset:36
    v_mfma_f32_16x16x32_bf16 v[116:119], v[32:35], v[52:55], v[116:119]
    s_add_u32 m0, s61, 99968
    v_mfma_f32_16x16x32_bf16 v[104:107], v[32:35], v[48:51], v[104:107]
    v_mfma_f32_16x16x32_bf16 v[100:103], v[32:35], v[44:47], v[100:103]
    ds_read_b64_tr_b16 v[32:33], v12 offset:45632
    v_mfma_f32_16x16x32_bf16 v[132:135], v[36:39], v[44:47], v[132:135]
    ds_read_b64_tr_b16 v[34:35], v12 offset:47040
    s_waitcnt lgkmcnt(2)
    v_cmp_ne_u32 vcc, s62, v15
    s_cbranch_vccnz L_f_sp3_8
L_f_sb3_8:
    v_mfma_f32_16x16x32_bf16 v[136:139], v[36:39], v[48:51], v[136:139]
    buffer_load_dwordx4 v164, s[40:43], s63 offen offset:0 lds
    v_mfma_f32_16x16x32_bf16 v[148:151], v[36:39], v[52:55], v[148:151]
    buffer_load_dwordx4 v165, s[40:43], s63 offen offset:1024 lds
    v_mfma_f32_16x16x32_bf16 v[152:155], v[36:39], v[56:59], v[152:155]
    buffer_load_dwordx4 v166, s[40:43], s63 offen offset:2048 lds
    s_add_u32 s63, s63, 88064
    s_waitcnt vmcnt(6) lgkmcnt(0)
    ds_write_b8 v16, v14 offset:40
    v_mfma_f32_16x16x32_bf16 v[96:99], v[40:43], v[56:59], v[96:99]
    ds_read_b64_tr_b16 v[36:37], v12 offset:0
    ds_read_b64_tr_b16 v[38:39], v12 offset:1408
    v_mfma_f32_16x16x32_bf16 v[92:95], v[40:43], v[52:55], v[92:95]
    ds_read_b128 v[8:11], v13 offset:20480
    v_mfma_f32_16x16x32_bf16 v[80:83], v[40:43], v[48:51], v[80:83]
    ds_read_b128 v[20:23], v13 offset:22528
    v_mfma_f32_16x16x32_bf16 v[76:79], v[40:43], v[44:47], v[76:79]
    ds_read_b64_tr_b16 v[40:41], v12 offset:32
    v_mfma_f32_16x16x32_bf16 v[108:111], v[28:31], v[44:47], v[108:111]
    ds_read_b64_tr_b16 v[42:43], v12 offset:1440
    ds_read_b32 v15, v17 offset:40
    v_mfma_f32_16x16x32_bf16 v[112:115], v[28:31], v[48:51], v[112:115]
    s_add_u32 m0, s61, 111360
    v_mfma_f32_16x16x32_bf16 v[124:127], v[28:31], v[52:55], v[124:127]
    v_mfma_f32_16x16x32_bf16 v[128:131], v[28:31], v[56:59], v[128:131]
    ds_read_b64_tr_b16 v[28:29], v12 offset:64
    v_mfma_f32_16x16x32_bf16 v[160:163], v[32:35], v[56:59], v[160:163]
    ds_read_b64_tr_b16 v[30:31], v12 offset:1472
    s_waitcnt lgkmcnt(2)
    v_cmp_ne_u32 vcc, s62, v15
    s_cbranch_vccnz L_f_sp3_9
L_f_sb3_9:
    v_mfma_f32_16x16x32_bf16 v[156:159], v[32:35], v[52:55], v[156:159]
    buffer_load_dwordx4 v164, s[36:39], s63 offen offset:0 lds
    v_mfma_f32_16x16x32_bf16 v[144:147], v[32:35], v[48:51], v[144:147]
    buffer_load_dwordx4 v165, s[36:39], s63 offen offset:1024 lds
    v_mfma_f32_16x16x32_bf16 v[140:143], v[32:35], v[44:47], v[140:143]
    buffer_load_dwordx4 v166, s[36:39], s63 offen offset:2048 lds
    s_waitcnt vmcnt(6) lgkmcnt(0)
    ds_write_b8 v16, v14 offset:44
    v_and_b32 v24, 65567, v25
L_f_gate3:
    ds_read_b32 v15, v24
    s_waitcnt lgkmcnt(0)
    v_cmp_gt_u32 vcc, 2, v15
    s_cbranch_vccz L_f_gok3
    s_sleep 2
    s_branch L_f_gate3
L_f_gok3:
    s_mov_b32 exec_lo, 0x0
    s_mov_b32 exec_hi, 0x7f7f7f7f
    s_cmp_eq_u32 s17, 1
    s_cbranch_scc1 L_pu2
    buffer_load_dword v27, v26, s[36:39], s70 offen
    s_branch L_pd2
L_pu2:
    buffer_load_dword v27, v26, s[40:43], s70 offen
L_pd2:
    s_mov_b64 exec, -1
    v_mfma_f32_16x16x32_bf16 v[68:71], v[36:39], v[60:63], v[68:71]
    ds_read_b64_tr_b16 v[32:33], v12 offset:11392
    ds_read_b64_tr_b16 v[34:35], v12 offset:12800
    v_mfma_f32_16x16x32_bf16 v[72:75], v[36:39], v[64:67], v[72:75]
    ds_read_b128 v[44:47], v3 offset:24576
    v_mfma_f32_16x16x32_bf16 v[84:87], v[36:39], v[8:11], v[84:87]
    ds_read_b128 v[48:51], v3 offset:26624
    v_mfma_f32_16x16x32_bf16 v[88:91], v[36:39], v[20:23], v[88:91]
    ds_read_b64_tr_b16 v[36:37], v12 offset:11424
    v_mfma_f32_16x16x32_bf16 v[120:123], v[40:43], v[20:23], v[120:123]
    ds_read_b64_tr_b16 v[38:39], v12 offset:12832
    ds_read_b32 v15, v17 offset:44
    v_mfma_f32_16x16x32_bf16 v[116:119], v[40:43], v[8:11], v[116:119]
    s_add_u32 m0, s61, 65792
    v_mfma_f32_16x16x32_bf16 v[104:107], v[40:43], v[64:67], v[104:107]
    v_mfma_f32_16x16x32_bf16 v[100:103], v[40:43], v[60:63], v[100:103]
    ds_read_b64_tr_b16 v[40:41], v12 offset:11456
    v_mfma_f32_16x16x32_bf16 v[132:135], v[28:31], v[60:63], v[132:135]
    ds_read_b64_tr_b16 v[42:43], v12 offset:12864
    s_waitcnt lgkmcnt(2)
    v_cmp_ne_u32 vcc, s62, v15
    s_cbranch_vccnz L_f_sp3_10
L_f_sb3_10:
    v_mfma_f32_16x16x32_bf16 v[136:139], v[28:31], v[64:67], v[136:139]
    buffer_load_dwordx4 v164, s[40:43], s63 offen offset:0 lds
    v_mfma_f32_16x16x32_bf16 v[148:151], v[28:31], v[8:11], v[148:151]
    buffer_load_dwordx4 v165, s[40:43], s63 offen offset:1024 lds
    v_mfma_f32_16x16x32_bf16 v[152:155], v[28:31], v[20:23], v[152:155]
    buffer_load_dwordx4 v166, s[40:43], s63 offen offset:2048 lds
    s_add_u32 s63, s63, 88064
    s_waitcnt vmcnt(6) lgkmcnt(0)
    ds_write_b8 v16, v14 offset:48
    v_mfma_f32_16x16x32_bf16 v[96:99], v[32:35], v[20:23], v[96:99]
    ds_read_b64_tr_b16 v[28:29], v12 offset:22784
    ds_read_b64_tr_b16 v[30:31], v12 offset:24192
    v_mfma_f32_16x16x32_bf16 v[92:95], v[32:35], v[8:11], v[92:95]
    ds_read_b128 v[52:55], v3 offset:28672
    v_mfma_f32_16x16x32_bf16 v[80:83], v[32:35], v[64:67], v[80:83]
    ds_read_b128 v[56:59], v3 offset:30720
    v_mfma_f32_16x16x32_bf16 v[76:79], v[32:35], v[60:63], v[76:79]
    ds_read_b64_tr_b16 v[32:33], v12 offset:22816
    v_mfma_f32_16x16x32_bf16 v[108:111], v[36:39], v[60:63], v[108:111]
    ds_read_b64_tr_b16 v[34:35], v12 offset:24224
    ds_read_b32 v15, v17 offset:48
    v_mfma_f32_16x16x32_bf16 v[112:115], v[36:39], v[64:67], v[112:115]
    s_add_u32 m0, s61, 77184
    v_mfma_f32_16x16x32_bf16 v[124:127], v[36:39], v[8:11], v[124:127]
    v_mfma_f32_16x16x32_bf16 v[128:131], v[36:39], v[20:23], v[128:131]
    ds_read_b64_tr_b16 v[36:37], v12 offset:22848
    v_mfma_f32_16x16x32_bf16 v[160:163], v[40:43], v[20:23], v[160:163]
    ds_read_b64_tr_b16 v[38:39], v12 offset:24256
    s_waitcnt lgkmcnt(2)
    v_cmp_ne_u32 vcc, s62, v15
    s_cbranch_vccnz L_f_sp3_11
L_f_sb3_11:
    v_mfma_f32_16x16x32_bf16 v[156:159], v[40:43], v[8:11], v[156:159]
    buffer_load_dwordx4 v164, s[36:39], s63 offen offset:0 lds
    v_mfma_f32_16x16x32_bf16 v[144:147], v[40:43], v[64:67], v[144:147]
    buffer_load_dwordx4 v165, s[36:39], s63 offen offset:1024 lds
    v_mfma_f32_16x16x32_bf16 v[140:143], v[40:43], v[60:63], v[140:143]
    buffer_load_dwordx4 v166, s[36:39], s63 offen offset:2048 lds
    s_waitcnt vmcnt(6) lgkmcnt(0)
    ds_write_b8 v16, v14 offset:52
    v_mfma_f32_16x16x32_bf16 v[68:71], v[28:31], v[44:47], v[68:71]
    ds_read_b64_tr_b16 v[40:41], v12 offset:34176
    ds_read_b64_tr_b16 v[42:43], v12 offset:35584
    v_mfma_f32_16x16x32_bf16 v[72:75], v[28:31], v[48:51], v[72:75]
    ds_read_b128 v[60:63], v13 offset:24576
    v_mfma_f32_16x16x32_bf16 v[84:87], v[28:31], v[52:55], v[84:87]
    ds_read_b128 v[64:67], v13 offset:26624
    v_mfma_f32_16x16x32_bf16 v[88:91], v[28:31], v[56:59], v[88:91]
    ds_read_b64_tr_b16 v[28:29], v12 offset:34208
    v_mfma_f32_16x16x32_bf16 v[120:123], v[32:35], v[56:59], v[120:123]
    ds_read_b64_tr_b16 v[30:31], v12 offset:35616
    ds_read_b32 v15, v17 offset:52
    v_mfma_f32_16x16x32_bf16 v[116:119], v[32:35], v[52:55], v[116:119]
    s_add_u32 m0, s61, 88576
    v_mfma_f32_16x16x32_bf16 v[104:107], v[32:35], v[48:51], v[104:107]
    v_mfma_f32_16x16x32_bf16 v[100:103], v[32:35], v[44:47], v[100:103]
    ds_read_b64_tr_b16 v[32:33], v12 offset:34240
    v_mfma_f32_16x16x32_bf16 v[132:135], v[36:39], v[44:47], v[132:135]
    ds_read_b64_tr_b16 v[34:35], v12 offset:35648
    s_waitcnt lgkmcnt(2)
    v_cmp_ne_u32 vcc, s62, v15
    s_cbranch_vccnz L_f_sp3_12
L_f_sb3_12:
    v_mfma_f32_16x16x32_bf16 v[136:139], v[36:39], v[48:51], v[136:139]
    buffer_load_dwordx4 v164, s[40:43], s63 offen offset:0 lds
    v_mfma_f32_16x16x32_bf16 v[148:151], v[36:39], v[52:55], v[148:151]
    buffer_load_dwordx4 v165, s[40:43], s63 offen offset:1024 lds
    v_mfma_f32_16x16x32_bf16 v[152:155], v[36:39], v[56:59], v[152:155]
    buffer_load_dwordx4 v166, s[40:43], s63 offen offset:2048 lds
    s_add_u32 s63, s63, 88064
    s_waitcnt vmcnt(6) lgkmcnt(0)
    ds_write_b8 v16, v14 offset:56
    s_bitcmp1_b32 s2, 3
    s_cbranch_scc1 L_f_np3_12
    buffer_load_dword v167, v18, s[44:47], s64 offen
    s_add_u32 s64, s64, 8192
L_f_np3_12:
    v_mfma_f32_16x16x32_bf16 v[96:99], v[40:43], v[56:59], v[96:99]
    ds_read_b64_tr_b16 v[36:37], v12 offset:45568
    ds_read_b64_tr_b16 v[38:39], v12 offset:46976
    v_mfma_f32_16x16x32_bf16 v[92:95], v[40:43], v[52:55], v[92:95]
    ds_read_b128 v[8:11], v13 offset:28672
    v_mfma_f32_16x16x32_bf16 v[80:83], v[40:43], v[48:51], v[80:83]
    ds_read_b128 v[20:23], v13 offset:30720
    v_mfma_f32_16x16x32_bf16 v[76:79], v[40:43], v[44:47], v[76:79]
    ds_read_b64_tr_b16 v[40:41], v12 offset:45600
    v_mfma_f32_16x16x32_bf16 v[108:111], v[28:31], v[44:47], v[108:111]
    ds_read_b64_tr_b16 v[42:43], v12 offset:47008
    ds_read_b32 v15, v17 offset:56
    v_mfma_f32_16x16x32_bf16 v[112:115], v[28:31], v[48:51], v[112:115]
    s_add_u32 m0, s61, 99968
    v_mfma_f32_16x16x32_bf16 v[124:127], v[28:31], v[52:55], v[124:127]
    v_mfma_f32_16x16x32_bf16 v[128:131], v[28:31], v[56:59], v[128:131]
    ds_read_b64_tr_b16 v[28:29], v12 offset:45632
    v_mfma_f32_16x16x32_bf16 v[160:163], v[32:35], v[56:59], v[160:163]
    ds_read_b64_tr_b16 v[30:31], v12 offset:47040
    s_waitcnt lgkmcnt(2)
    v_cmp_ne_u32 vcc, s62, v15
    s_cbranch_vccnz L_f_sp3_13
L_f_sb3_13:
    v_mfma_f32_16x16x32_bf16 v[156:159], v[32:35], v[52:55], v[156:159]
    buffer_load_dwordx4 v164, s[36:39], s63 offen offset:0 lds
    v_mfma_f32_16x16x32_bf16 v[144:147], v[32:35], v[48:51], v[144:147]
    buffer_load_dwordx4 v165, s[36:39], s63 offen offset:1024 lds
    v_mfma_f32_16x16x32_bf16 v[140:143], v[32:35], v[44:47], v[140:143]
    buffer_load_dwordx4 v166, s[36:39], s63 offen offset:2048 lds
    s_waitcnt vmcnt(6) lgkmcnt(0)
    ds_write_b8 v16, v14 offset:60
    v_mfma_f32_16x16x32_bf16 v[68:71], v[36:39], v[60:63], v[68:71]
    ds_read_b64_tr_b16 v[32:33], v12 offset:0
    ds_read_b64_tr_b16 v[34:35], v12 offset:1408
    v_mfma_f32_16x16x32_bf16 v[72:75], v[36:39], v[64:67], v[72:75]
    ds_read_b128 v[44:47], v3 offset:32768
    v_mfma_f32_16x16x32_bf16 v[84:87], v[36:39], v[8:11], v[84:87]
    ds_read_b128 v[48:51], v3 offset:34816
    v_mfma_f32_16x16x32_bf16 v[88:91], v[36:39], v[20:23], v[88:91]
    ds_read_b64_tr_b16 v[36:37], v12 offset:32
    v_mfma_f32_16x16x32_bf16 v[120:123], v[40:43], v[20:23], v[120:123]
    ds_read_b64_tr_b16 v[38:39], v12 offset:1440
    ds_read_b32 v15, v17 offset:60
    v_mfma_f32_16x16x32_bf16 v[116:119], v[40:43], v[8:11], v[116:119]
    s_add_u32 m0, s61, 111360
    v_mfma_f32_16x16x32_bf16 v[104:107], v[40:43], v[64:67], v[104:107]
    v_mfma_f32_16x16x32_bf16 v[100:103], v[40:43], v[60:63], v[100:103]
    ds_read_b64_tr_b16 v[40:41], v12 offset:64
    v_mfma_f32_16x16x32_bf16 v[132:135], v[28:31], v[60:63], v[132:135]
    ds_read_b64_tr_b16 v[42:43], v12 offset:1472
    s_waitcnt lgkmcnt(2)
    v_cmp_ne_u32 vcc, s62, v15
    s_cbranch_vccnz L_f_sp3_14
L_f_sb3_14:
    v_mfma_f32_16x16x32_bf16 v[136:139], v[28:31], v[64:67], v[136:139]
    buffer_load_dwordx4 v164, s[40:43], s63 offen offset:0 lds
    v_mfma_f32_16x16x32_bf16 v[148:151], v[28:31], v[8:11], v[148:151]
    buffer_load_dwordx4 v165, s[40:43], s63 offen offset:1024 lds
    v_mfma_f32_16x16x32_bf16 v[152:155], v[28:31], v[20:23], v[152:155]
    buffer_load_dwordx4 v166, s[40:43], s63 offen offset:2048 lds
    s_add_u32 s63, s63, 88064
    s_waitcnt vmcnt(6) lgkmcnt(0)
    ds_write_b8 v16, v14 offset:64
    v_mfma_f32_16x16x32_bf16 v[96:99], v[32:35], v[20:23], v[96:99]
    ds_read_b64_tr_b16 v[28:29], v12 offset:11392
    ds_read_b64_tr_b16 v[30:31], v12 offset:12800
    v_mfma_f32_16x16x32_bf16 v[92:95], v[32:35], v[8:11], v[92:95]
    ds_read_b128 v[52:55], v3 offset:36864
    v_mfma_f32_16x16x32_bf16 v[80:83], v[32:35], v[64:67], v[80:83]
    ds_read_b128 v[56:59], v3 offset:38912
    v_mfma_f32_16x16x32_bf16 v[76:79], v[32:35], v[60:63], v[76:79]
    ds_read_b64_tr_b16 v[32:33], v12 offset:11424
    v_mfma_f32_16x16x32_bf16 v[108:111], v[36:39], v[60:63], v[108:111]
    ds_read_b64_tr_b16 v[34:35], v12 offset:12832
    ds_read_b32 v15, v17 offset:64
    v_mfma_f32_16x16x32_bf16 v[112:115], v[36:39], v[64:67], v[112:115]
    s_add_u32 m0, s61, 65792
    v_mfma_f32_16x16x32_bf16 v[124:127], v[36:39], v[8:11], v[124:127]
    v_mfma_f32_16x16x32_bf16 v[128:131], v[36:39], v[20:23], v[128:131]
    ds_read_b64_tr_b16 v[36:37], v12 offset:11456
    v_mfma_f32_16x16x32_bf16 v[160:163], v[40:43], v[20:23], v[160:163]
    ds_read_b64_tr_b16 v[38:39], v12 offset:12864
    s_waitcnt lgkmcnt(2)
    v_cmp_ne_u32 vcc, s62, v15
    s_cbranch_vccnz L_f_sp3_15
L_f_sb3_15:
    v_mfma_f32_16x16x32_bf16 v[156:159], v[40:43], v[8:11], v[156:159]
    buffer_load_dwordx4 v164, s[36:39], s63 offen offset:0 lds
    v_mfma_f32_16x16x32_bf16 v[144:147], v[40:43], v[64:67], v[144:147]
    buffer_load_dwordx4 v165, s[36:39], s63 offen offset:1024 lds
    v_mfma_f32_16x16x32_bf16 v[140:143], v[40:43], v[60:63], v[140:143]
    buffer_load_dwordx4 v166, s[36:39], s63 offen offset:2048 lds
    s_waitcnt vmcnt(6) lgkmcnt(0)
    ds_write_b8 v16, v14 offset:68
    v_mfma_f32_16x16x32_bf16 v[68:71], v[28:31], v[44:47], v[68:71]
    ds_read_b64_tr_b16 v[40:41], v12 offset:22784
    ds_read_b64_tr_b16 v[42:43], v12 offset:24192
    v_mfma_f32_16x16x32_bf16 v[72:75], v[28:31], v[48:51], v[72:75]
    ds_read_b128 v[60:63], v13 offset:32768
    v_mfma_f32_16x16x32_bf16 v[84:87], v[28:31], v[52:55], v[84:87]
    ds_read_b128 v[64:67], v13 offset:34816
    v_mfma_f32_16x16x32_bf16 v[88:91], v[28:31], v[56:59], v[88:91]
    ds_read_b64_tr_b16 v[28:29], v12 offset:22816
    v_mfma_f32_16x16x32_bf16 v[120:123], v[32:35], v[56:59], v[120:123]
    ds_read_b64_tr_b16 v[30:31], v12 offset:24224
    ds_read_b32 v15, v17 offset:68
    v_mfma_f32_16x16x32_bf16 v[116:119], v[32:35], v[52:55], v[116:119]
    s_add_u32 m0, s61, 77184
    v_mfma_f32_16x16x32_bf16 v[104:107], v[32:35], v[48:51], v[104:107]
    v_mfma_f32_16x16x32_bf16 v[100:103], v[32:35], v[44:47], v[100:103]
    ds_read_b64_tr_b16 v[32:33], v12 offset:22848
    v_mfma_f32_16x16x32_bf16 v[132:135], v[36:39], v[44:47], v[132:135]
    ds_read_b64_tr_b16 v[34:35], v12 offset:24256
    s_waitcnt lgkmcnt(2)
    v_cmp_ne_u32 vcc, s62, v15
    s_cbranch_vccnz L_f_sp3_16
L_f_sb3_16:
    v_mfma_f32_16x16x32_bf16 v[136:139], v[36:39], v[48:51], v[136:139]
    buffer_load_dwordx4 v164, s[40:43], s63 offen offset:0 lds
    v_mfma_f32_16x16x32_bf16 v[148:151], v[36:39], v[52:55], v[148:151]
    buffer_load_dwordx4 v165, s[40:43], s63 offen offset:1024 lds
    v_mfma_f32_16x16x32_bf16 v[152:155], v[36:39], v[56:59], v[152:155]
    buffer_load_dwordx4 v166, s[40:43], s63 offen offset:2048 lds
    s_add_u32 s63, s63, 88064
    s_waitcnt vmcnt(6) lgkmcnt(0)
    ds_write_b8 v16, v14 offset:72
    s_bitcmp1_b32 s2, 3
    s_cbranch_scc0 L_f_np3_16
    buffer_load_dword v167, v18, s[44:47], s64 offen
    s_add_u32 s64, s64, 8192
L_f_np3_16:
    v_mfma_f32_16x16x32_bf16 v[96:99], v[40:43], v[56:59], v[96:99]
    ds_read_b64_tr_b16 v[36:37], v12 offset:34176
    ds_read_b64_tr_b16 v[38:39], v12 offset:35584
    v_mfma_f32_16x16x32_bf16 v[92:95], v[40:43], v[52:55], v[92:95]
    ds_read_b128 v[8:11], v13 offset:36864
    v_mfma_f32_16x16x32_bf16 v[80:83], v[40:43], v[48:51], v[80:83]
    ds_read_b128 v[20:23], v13 offset:38912
    v_mfma_f32_16x16x32_bf16 v[76:79], v[40:43], v[44:47], v[76:79]
    ds_read_b64_tr_b16 v[40:41], v12 offset:34208
    v_mfma_f32_16x16x32_bf16 v[108:111], v[28:31], v[44:47], v[108:111]
    ds_read_b64_tr_b16 v[42:43], v12 offset:35616
    ds_read_b32 v15, v17 offset:72
    v_mfma_f32_16x16x32_bf16 v[112:115], v[28:31], v[48:51], v[112:115]
    s_add_u32 m0, s61, 88576
    v_mfma_f32_16x16x32_bf16 v[124:127], v[28:31], v[52:55], v[124:127]
    v_mfma_f32_16x16x32_bf16 v[128:131], v[28:31], v[56:59], v[128:131]
    ds_read_b64_tr_b16 v[28:29], v12 offset:34240
    v_mfma_f32_16x16x32_bf16 v[160:163], v[32:35], v[56:59], v[160:163]
    ds_read_b64_tr_b16 v[30:31], v12 offset:35648
    s_waitcnt lgkmcnt(2)
    v_cmp_ne_u32 vcc, s62, v15
    s_cbranch_vccnz L_f_sp3_17
L_f_sb3_17:
    v_mfma_f32_16x16x32_bf16 v[156:159], v[32:35], v[52:55], v[156:159]
    buffer_load_dwordx4 v164, s[36:39], s63 offen offset:0 lds
    v_mfma_f32_16x16x32_bf16 v[144:147], v[32:35], v[48:51], v[144:147]
    buffer_load_dwordx4 v165, s[36:39], s63 offen offset:1024 lds
    v_mfma_f32_16x16x32_bf16 v[140:143], v[32:35], v[44:47], v[140:143]
    buffer_load_dwordx4 v166, s[36:39], s63 offen offset:2048 lds
    s_waitcnt vmcnt(6) lgkmcnt(0)
    ds_write_b8 v16, v14 offset:76
    v_mfma_f32_16x16x32_bf16 v[68:71], v[36:39], v[60:63], v[68:71]
    ds_read_b64_tr_b16 v[32:33], v12 offset:45568
    ds_read_b64_tr_b16 v[34:35], v12 offset:46976
    v_mfma_f32_16x16x32_bf16 v[72:75], v[36:39], v[64:67], v[72:75]
    ds_read_b128 v[44:47], v3 offset:40960
    v_mfma_f32_16x16x32_bf16 v[84:87], v[36:39], v[8:11], v[84:87]
    ds_read_b128 v[48:51], v3 offset:43008
    v_mfma_f32_16x16x32_bf16 v[88:91], v[36:39], v[20:23], v[88:91]
    ds_read_b64_tr_b16 v[36:37], v12 offset:45600
    v_mfma_f32_16x16x32_bf16 v[120:123], v[40:43], v[20:23], v[120:123]
    ds_read_b64_tr_b16 v[38:39], v12 offset:47008
    ds_read_b32 v15, v17 offset:76
    v_mfma_f32_16x16x32_bf16 v[116:119], v[40:43], v[8:11], v[116:119]
    s_add_u32 m0, s61, 99968
    v_mfma_f32_16x16x32_bf16 v[104:107], v[40:43], v[64:67], v[104:107]
    v_mfma_f32_16x16x32_bf16 v[100:103], v[40:43], v[60:63], v[100:103]
    ds_read_b64_tr_b16 v[40:41], v12 offset:45632
    v_mfma_f32_16x16x32_bf16 v[132:135], v[28:31], v[60:63], v[132:135]
    ds_read_b64_tr_b16 v[42:43], v12 offset:47040
    s_waitcnt lgkmcnt(2)
    v_cmp_ne_u32 vcc, s62, v15
    s_cbranch_vccnz L_f_sp3_18
L_f_sb3_18:
    v_mfma_f32_16x16x32_bf16 v[136:139], v[28:31], v[64:67], v[136:139]
    buffer_load_dwordx4 v164, s[40:43], s63 offen offset:0 lds
    v_mfma_f32_16x16x32_bf16 v[148:151], v[28:31], v[8:11], v[148:151]
    buffer_load_dwordx4 v165, s[40:43], s63 offen offset:1024 lds
    v_mfma_f32_16x16x32_bf16 v[152:155], v[28:31], v[20:23], v[152:155]
    buffer_load_dwordx4 v166, s[40:43], s63 offen offset:2048 lds
    s_add_u32 s63, s63, 88064
    s_waitcnt vmcnt(6) lgkmcnt(0)
    ds_write_b8 v16, v14 offset:80
    v_mfma_f32_16x16x32_bf16 v[96:99], v[32:35], v[20:23], v[96:99]
    ds_read_b64_tr_b16 v[28:29], v12 offset:0
    ds_read_b64_tr_b16 v[30:31], v12 offset:1408
    v_mfma_f32_16x16x32_bf16 v[92:95], v[32:35], v[8:11], v[92:95]
    ds_read_b128 v[52:55], v3 offset:45056
    v_mfma_f32_16x16x32_bf16 v[80:83], v[32:35], v[64:67], v[80:83]
    ds_read_b128 v[56:59], v3 offset:47104
    v_mfma_f32_16x16x32_bf16 v[76:79], v[32:35], v[60:63], v[76:79]
    ds_read_b64_tr_b16 v[32:33], v12 offset:32
    v_mfma_f32_16x16x32_bf16 v[108:111], v[36:39], v[60:63], v[108:111]
    ds_read_b64_tr_b16 v[34:35], v12 offset:1440
    ds_read_b32 v15, v17 offset:80
    v_mfma_f32_16x16x32_bf16 v[112:115], v[36:39], v[64:67], v[112:115]
    s_add_u32 m0, s61, 111360
    v_mfma_f32_16x16x32_bf16 v[124:127], v[36:39], v[8:11], v[124:127]
    v_mfma_f32_16x16x32_bf16 v[128:131], v[36:39], v[20:23], v[128:131]
    ds_read_b64_tr_b16 v[36:37], v12 offset:64
    v_mfma_f32_16x16x32_bf16 v[160:163], v[40:43], v[20:23], v[160:163]
    ds_read_b64_tr_b16 v[38:39], v12 offset:1472
    s_waitcnt lgkmcnt(2)
    v_cmp_ne_u32 vcc, s62, v15
    s_cbranch_vccnz L_f_sp3_19
L_f_sb3_19:
    v_mfma_f32_16x16x32_bf16 v[156:159], v[40:43], v[8:11], v[156:159]
    buffer_load_dwordx4 v164, s[36:39], s63 offen offset:0 lds
    v_mfma_f32_16x16x32_bf16 v[144:147], v[40:43], v[64:67], v[144:147]
    buffer_load_dwordx4 v165, s[36:39], s63 offen offset:1024 lds
    v_mfma_f32_16x16x32_bf16 v[140:143], v[40:43], v[60:63], v[140:143]
    buffer_load_dwordx4 v166, s[36:39], s63 offen offset:2048 lds
    s_waitcnt vmcnt(6) lgkmcnt(0)
    ds_write_b8 v16, v14 offset:84
    v_mfma_f32_16x16x32_bf16 v[68:71], v[28:31], v[44:47], v[68:71]
    ds_read_b64_tr_b16 v[40:41], v12 offset:11392
    ds_read_b64_tr_b16 v[42:43], v12 offset:12800
    v_mfma_f32_16x16x32_bf16 v[72:75], v[28:31], v[48:51], v[72:75]
    ds_read_b128 v[60:63], v13 offset:40960
    v_mfma_f32_16x16x32_bf16 v[84:87], v[28:31], v[52:55], v[84:87]
    ds_read_b128 v[64:67], v13 offset:43008
    v_mfma_f32_16x16x32_bf16 v[88:91], v[28:31], v[56:59], v[88:91]
    ds_read_b64_tr_b16 v[28:29], v12 offset:11424
    v_mfma_f32_16x16x32_bf16 v[120:123], v[32:35], v[56:59], v[120:123]
    ds_read_b64_tr_b16 v[30:31], v12 offset:12832
    ds_read_b32 v15, v17 offset:84
    v_mfma_f32_16x16x32_bf16 v[116:119], v[32:35], v[52:55], v[116:119]
    s_add_u32 m0, s61, 65792
    v_mfma_f32_16x16x32_bf16 v[104:107], v[32:35], v[48:51], v[104:107]
    v_mfma_f32_16x16x32_bf16 v[100:103], v[32:35], v[44:47], v[100:103]
    ds_read_b64_tr_b16 v[32:33], v12 offset:11456
    v_mfma_f32_16x16x32_bf16 v[132:135], v[36:39], v[44:47], v[132:135]
    ds_read_b64_tr_b16 v[34:35], v12 offset:12864
    s_waitcnt lgkmcnt(2)
    v_cmp_ne_u32 vcc, s62, v15
    s_cbranch_vccnz L_f_sp3_20
L_f_sb3_20:
    v_mfma_f32_16x16x32_bf16 v[136:139], v[36:39], v[48:51], v[136:139]
    buffer_load_dwordx4 v164, s[40:43], s63 offen offset:0 lds
    v_mfma_f32_16x16x32_bf16 v[148:151], v[36:39], v[52:55], v[148:151]
    buffer_load_dwordx4 v165, s[40:43], s63 offen offset:1024 lds
    v_mfma_f32_16x16x32_bf16 v[152:155], v[36:39], v[56:59], v[152:155]
    buffer_load_dwordx4 v166, s[40:43], s63 offen offset:2048 lds
    s_add_u32 s63, s63, 88064
    s_waitcnt vmcnt(6) lgkmcnt(0)
    ds_write_b8 v16, v14 offset:88
    s_bitcmp1_b32 s2, 3
    s_cbranch_scc1 L_f_np3_20
    s_mov_b64 exec, 0x3fffff
    buffer_load_dword v167, v18, s[44:47], s64 offen
    s_mov_b32 exec_lo, -1
    buffer_load_dword v167, v18, s[48:51], s65 offen
    s_mov_b32 exec_hi, -1
L_f_np3_20:
    v_mfma_f32_16x16x32_bf16 v[96:99], v[40:43], v[56:59], v[96:99]
    ds_read_b64_tr_b16 v[36:37], v12 offset:22784
    ds_read_b64_tr_b16 v[38:39], v12 offset:24192
    v_mfma_f32_16x16x32_bf16 v[92:95], v[40:43], v[52:55], v[92:95]
    ds_read_b128 v[8:11], v13 offset:45056
    v_mfma_f32_16x16x32_bf16 v[80:83], v[40:43], v[48:51], v[80:83]
    ds_read_b128 v[20:23], v13 offset:47104
    v_mfma_f32_16x16x32_bf16 v[76:79], v[40:43], v[44:47], v[76:79]
    ds_read_b64_tr_b16 v[40:41], v12 offset:22816
    v_mfma_f32_16x16x32_bf16 v[108:111], v[28:31], v[44:47], v[108:111]
    ds_read_b64_tr_b16 v[42:43], v12 offset:24224
    ds_read_b32 v15, v17 offset:88
    v_mfma_f32_16x16x32_bf16 v[112:115], v[28:31], v[48:51], v[112:115]
    s_add_u32 m0, s61, 77184
    v_mfma_f32_16x16x32_bf16 v[124:127], v[28:31], v[52:55], v[124:127]
    v_mfma_f32_16x16x32_bf16 v[128:131], v[28:31], v[56:59], v[128:131]
    ds_read_b64_tr_b16 v[28:29], v12 offset:22848
    v_mfma_f32_16x16x32_bf16 v[160:163], v[32:35], v[56:59], v[160:163]
    ds_read_b64_tr_b16 v[30:31], v12 offset:24256
    s_waitcnt lgkmcnt(2)
    v_cmp_ne_u32 vcc, s62, v15
    s_cbranch_vccnz L_f_sp3_21
L_f_sb3_21:
    v_mfma_f32_16x16x32_bf16 v[156:159], v[32:35], v[52:55], v[156:159]
    buffer_load_dwordx4 v164, s[36:39], s63 offen offset:0 lds
    v_mfma_f32_16x16x32_bf16 v[144:147], v[32:35], v[48:51], v[144:147]
    buffer_load_dwordx4 v165, s[36:39], s63 offen offset:1024 lds
    v_mfma_f32_16x16x32_bf16 v[140:143], v[32:35], v[44:47], v[140:143]
    buffer_load_dwordx4 v166, s[36:39], s63 offen offset:2048 lds
    s_waitcnt vmcnt(6) lgkmcnt(0)
    ds_write_b8 v16, v14 offset:92
    v_mfma_f32_16x16x32_bf16 v[68:71], v[36:39], v[60:63], v[68:71]
    ds_read_b64_tr_b16 v[32:33], v12 offset:34176
    ds_read_b64_tr_b16 v[34:35], v12 offset:35584
    v_mfma_f32_16x16x32_bf16 v[72:75], v[36:39], v[64:67], v[72:75]
    ds_read_b128 v[44:47], v3 offset:49152
    v_mfma_f32_16x16x32_bf16 v[84:87], v[36:39], v[8:11], v[84:87]
    ds_read_b128 v[48:51], v3 offset:51200
    v_mfma_f32_16x16x32_bf16 v[88:91], v[36:39], v[20:23], v[88:91]
    ds_read_b64_tr_b16 v[36:37], v12 offset:34208
    v_mfma_f32_16x16x32_bf16 v[120:123], v[40:43], v[20:23], v[120:123]
    ds_read_b64_tr_b16 v[38:39], v12 offset:35616
    ds_read_b32 v15, v17 offset:92
    v_mfma_f32_16x16x32_bf16 v[116:119], v[40:43], v[8:11], v[116:119]
    s_add_u32 m0, s61, 88576
    v_mfma_f32_16x16x32_bf16 v[104:107], v[40:43], v[64:67], v[104:107]
    v_mfma_f32_16x16x32_bf16 v[100:103], v[40:43], v[60:63], v[100:103]
    ds_read_b64_tr_b16 v[40:41], v12 offset:34240
    v_mfma_f32_16x16x32_bf16 v[132:135], v[28:31], v[60:63], v[132:135]
    ds_read_b64_tr_b16 v[42:43], v12 offset:35648
    s_waitcnt lgkmcnt(2)
    v_cmp_ne_u32 vcc, s62, v15
    s_cbranch_vccnz L_f_sp3_22
L_f_sb3_22:
    v_mfma_f32_16x16x32_bf16 v[136:139], v[28:31], v[64:67], v[136:139]
    buffer_load_dwordx4 v164, s[40:43], s63 offen offset:0 lds
    v_mfma_f32_16x16x32_bf16 v[148:151], v[28:31], v[8:11], v[148:151]
    buffer_load_dwordx4 v165, s[40:43], s63 offen offset:1024 lds
    v_mfma_f32_16x16x32_bf16 v[152:155], v[28:31], v[20:23], v[152:155]
    buffer_load_dwordx4 v166, s[40:43], s63 offen offset:2048 lds
    s_add_u32 s63, s63, 88064
    s_waitcnt vmcnt(6) lgkmcnt(0)
    ds_write_b8 v16, v14 offset:96
    v_mfma_f32_16x16x32_bf16 v[96:99], v[32:35], v[20:23], v[96:99]
    ds_read_b64_tr_b16 v[28:29], v12 offset:45568
    ds_read_b64_tr_b16 v[30:31], v12 offset:46976
    v_mfma_f32_16x16x32_bf16 v[92:95], v[32:35], v[8:11], v[92:95]
    ds_read_b128 v[52:55], v3 offset:53248
    v_mfma_f32_16x16x32_bf16 v[80:83], v[32:35], v[64:67], v[80:83]
    ds_read_b128 v[56:59], v3 offset:55296
    v_mfma_f32_16x16x32_bf16 v[76:79], v[32:35], v[60:63], v[76:79]
    ds_read_b64_tr_b16 v[32:33], v12 offset:45600
    v_mfma_f32_16x16x32_bf16 v[108:111], v[36:39], v[60:63], v[108:111]
    ds_read_b64_tr_b16 v[34:35], v12 offset:47008
    ds_read_b32 v15, v17 offset:96
    v_mfma_f32_16x16x32_bf16 v[112:115], v[36:39], v[64:67], v[112:115]
    s_add_u32 m0, s61, 99968
    v_mfma_f32_16x16x32_bf16 v[124:127], v[36:39], v[8:11], v[124:127]
    v_mfma_f32_16x16x32_bf16 v[128:131], v[36:39], v[20:23], v[128:131]
    ds_read_b64_tr_b16 v[36:37], v12 offset:45632
    v_mfma_f32_16x16x32_bf16 v[160:163], v[40:43], v[20:23], v[160:163]
    ds_read_b64_tr_b16 v[38:39], v12 offset:47040
    s_waitcnt lgkmcnt(2)
    v_cmp_ne_u32 vcc, s62, v15
    s_cbranch_vccnz L_f_sp3_23
L_f_sb3_23:
    v_mfma_f32_16x16x32_bf16 v[156:159], v[40:43], v[8:11], v[156:159]
    buffer_load_dwordx4 v164, s[36:39], s63 offen offset:0 lds
    v_mfma_f32_16x16x32_bf16 v[144:147], v[40:43], v[64:67], v[144:147]
    buffer_load_dwordx4 v165, s[36:39], s63 offen offset:1024 lds
    v_mfma_f32_16x16x32_bf16 v[140:143], v[40:43], v[60:63], v[140:143]
    buffer_load_dwordx4 v166, s[36:39], s63 offen offset:2048 lds
    s_waitcnt vmcnt(6) lgkmcnt(0)
    ds_write_b8 v16, v14 offset:100
    v_mfma_f32_16x16x32_bf16 v[68:71], v[28:31], v[44:47], v[68:71]
    ds_read_b64_tr_b16 v[40:41], v12 offset:0
    ds_read_b64_tr_b16 v[42:43], v12 offset:1408
    v_mfma_f32_16x16x32_bf16 v[72:75], v[28:31], v[48:51], v[72:75]
    ds_read_b128 v[60:63], v13 offset:49152
    v_mfma_f32_16x16x32_bf16 v[84:87], v[28:31], v[52:55], v[84:87]
    ds_read_b128 v[64:67], v13 offset:51200
    v_mfma_f32_16x16x32_bf16 v[88:91], v[28:31], v[56:59], v[88:91]
    ds_read_b64_tr_b16 v[28:29], v12 offset:32
    v_mfma_f32_16x16x32_bf16 v[120:123], v[32:35], v[56:59], v[120:123]
    ds_read_b64_tr_b16 v[30:31], v12 offset:1440
    ds_read_b32 v15, v17 offset:100
    v_mfma_f32_16x16x32_bf16 v[116:119], v[32:35], v[52:55], v[116:119]
    s_add_u32 m0, s61, 111360
    v_mfma_f32_16x16x32_bf16 v[104:107], v[32:35], v[48:51], v[104:107]
    v_mfma_f32_16x16x32_bf16 v[100:103], v[32:35], v[44:47], v[100:103]
    ds_read_b64_tr_b16 v[32:33], v12 offset:64
    v_mfma_f32_16x16x32_bf16 v[132:135], v[36:39], v[44:47], v[132:135]
    ds_read_b64_tr_b16 v[34:35], v12 offset:1472
    s_waitcnt lgkmcnt(2)
    v_cmp_ne_u32 vcc, s62, v15
    s_cbranch_vccnz L_f_sp3_24
L_f_sb3_24:
    v_mfma_f32_16x16x32_bf16 v[136:139], v[36:39], v[48:51], v[136:139]
    buffer_load_dwordx4 v164, s[40:43], s63 offen offset:0 lds
    v_mfma_f32_16x16x32_bf16 v[148:151], v[36:39], v[52:55], v[148:151]
    buffer_load_dwordx4 v165, s[40:43], s63 offen offset:1024 lds
    v_mfma_f32_16x16x32_bf16 v[152:155], v[36:39], v[56:59], v[152:155]
    buffer_load_dwordx4 v166, s[40:43], s63 offen offset:2048 lds
    s_add_u32 s63, s63, 88064
    s_waitcnt vmcnt(6) lgkmcnt(0)
    ds_write_b8 v16, v14 offset:104
    s_bitcmp1_b32 s2, 3
    s_cbranch_scc0 L_f_np3_24
    s_mov_b64 exec, 0x3fffff
    buffer_load_dword v167, v18, s[44:47], s64 offen
    s_mov_b32 exec_lo, -1
    buffer_load_dword v167, v18, s[48:51], s65 offen
    s_mov_b32 exec_hi, -1
L_f_np3_24:
    v_mfma_f32_16x16x32_bf16 v[96:99], v[40:43], v[56:59], v[96:99]
    ds_read_b64_tr_b16 v[36:37], v12 offset:11392
    ds_read_b64_tr_b16 v[38:39], v12 offset:12800
    v_mfma_f32_16x16x32_bf16 v[92:95], v[40:43], v[52:55], v[92:95]
    ds_read_b128 v[8:11], v13 offset:53248
    v_mfma_f32_16x16x32_bf16 v[80:83], v[40:43], v[48:51], v[80:83]
    ds_read_b128 v[20:23], v13 offset:55296
    v_mfma_f32_16x16x32_bf16 v[76:79], v[40:43], v[44:47], v[76:79]
    ds_read_b64_tr_b16 v[40:41], v12 offset:11424
    v_mfma_f32_16x16x32_bf16 v[108:111], v[28:31], v[44:47], v[108:111]
    ds_read_b64_tr_b16 v[42:43], v12 offset:12832
    ds_read_b32 v15, v17 offset:104
    v_mfma_f32_16x16x32_bf16 v[112:115], v[28:31], v[48:51], v[112:115]
    s_add_u32 m0, s61, 65792
    v_mfma_f32_16x16x32_bf16 v[124:127], v[28:31], v[52:55], v[124:127]
    v_mfma_f32_16x16x32_bf16 v[128:131], v[28:31], v[56:59], v[128:131]
    ds_read_b64_tr_b16 v[28:29], v12 offset:11456
    v_mfma_f32_16x16x32_bf16 v[160:163], v[32:35], v[56:59], v[160:163]
    ds_read_b64_tr_b16 v[30:31], v12 offset:12864
    s_waitcnt lgkmcnt(2)
    v_cmp_ne_u32 vcc, s62, v15
    s_cbranch_vccnz L_f_sp3_25
L_f_sb3_25:
    v_mfma_f32_16x16x32_bf16 v[156:159], v[32:35], v[52:55], v[156:159]
    buffer_load_dwordx4 v164, s[36:39], s63 offen offset:0 lds
    v_mfma_f32_16x16x32_bf16 v[144:147], v[32:35], v[48:51], v[144:147]
    buffer_load_dwordx4 v165, s[36:39], s63 offen offset:1024 lds
    v_mfma_f32_16x16x32_bf16 v[140:143], v[32:35], v[44:47], v[140:143]
    buffer_load_dwordx4 v166, s[36:39], s63 offen offset:2048 lds
    s_waitcnt vmcnt(6) lgkmcnt(0)
    ds_write_b8 v16, v14 offset:108
    v_mfma_f32_16x16x32_bf16 v[68:71], v[36:39], v[60:63], v[68:71]
    ds_read_b64_tr_b16 v[32:33], v12 offset:22784
    ds_read_b64_tr_b16 v[34:35], v12 offset:24192
    v_mfma_f32_16x16x32_bf16 v[72:75], v[36:39], v[64:67], v[72:75]
    ds_read_b128 v[44:47], v3 offset:57344
    v_mfma_f32_16x16x32_bf16 v[84:87], v[36:39], v[8:11], v[84:87]
    ds_read_b128 v[48:51], v3 offset:59392
    v_mfma_f32_16x16x32_bf16 v[88:91], v[36:39], v[20:23], v[88:91]
    ds_read_b64_tr_b16 v[36:37], v12 offset:22816
    v_mfma_f32_16x16x32_bf16 v[120:123], v[40:43], v[20:23], v[120:123]
    ds_read_b64_tr_b16 v[38:39], v12 offset:24224
    ds_read_b32 v15, v17 offset:108
    v_mfma_f32_16x16x32_bf16 v[116:119], v[40:43], v[8:11], v[116:119]
    s_add_u32 m0, s61, 77184
    v_mfma_f32_16x16x32_bf16 v[104:107], v[40:43], v[64:67], v[104:107]
    v_mfma_f32_16x16x32_bf16 v[100:103], v[40:43], v[60:63], v[100:103]
    ds_read_b64_tr_b16 v[40:41], v12 offset:22848
    v_mfma_f32_16x16x32_bf16 v[132:135], v[28:31], v[60:63], v[132:135]
    ds_read_b64_tr_b16 v[42:43], v12 offset:24256
    s_waitcnt lgkmcnt(2)
    v_cmp_ne_u32 vcc, s62, v15
    s_cbranch_vccnz L_f_sp3_26
L_f_sb3_26:
    v_mfma_f32_16x16x32_bf16 v[136:139], v[28:31], v[64:67], v[136:139]
    buffer_load_dwordx4 v164, s[40:43], s63 offen offset:0 lds
    v_mfma_f32_16x16x32_bf16 v[148:151], v[28:31], v[8:11], v[148:151]
    buffer_load_dwordx4 v165, s[40:43], s63 offen offset:1024 lds
    v_mfma_f32_16x16x32_bf16 v[152:155], v[28:31], v[20:23], v[152:155]
    buffer_load_dwordx4 v166, s[40:43], s63 offen offset:2048 lds
    s_waitcnt vmcnt(6) lgkmcnt(0)
    ds_write_b8 v16, v14 offset:112
    v_mfma_f32_16x16x32_bf16 v[96:99], v[32:35], v[20:23], v[96:99]
    ds_read_b64_tr_b16 v[28:29], v12 offset:34176
    ds_read_b64_tr_b16 v[30:31], v12 offset:35584
    v_mfma_f32_16x16x32_bf16 v[92:95], v[32:35], v[8:11], v[92:95]
    ds_read_b128 v[52:55], v3 offset:61440
    v_mfma_f32_16x16x32_bf16 v[80:83], v[32:35], v[64:67], v[80:83]
    ds_read_b128 v[56:59], v3 offset:63488
    v_mfma_f32_16x16x32_bf16 v[76:79], v[32:35], v[60:63], v[76:79]
    ds_read_b64_tr_b16 v[32:33], v12 offset:34208
    v_mfma_f32_16x16x32_bf16 v[108:111], v[36:39], v[60:63], v[108:111]
    ds_read_b64_tr_b16 v[34:35], v12 offset:35616
    ds_read_b32 v15, v17 offset:112
    v_mfma_f32_16x16x32_bf16 v[112:115], v[36:39], v[64:67], v[112:115]
    s_add_u32 m0, s15, 0
    s_nop 0
    buffer_load_dwordx4 v4, s[44:47], s72 offen lds
    buffer_load_dwordx4 v5, s[44:47], s72 offen offset:1024 lds
    s_add_u32 s72, s72, 16384
    s_cmp_eq_u32 s72, s13
    s_cselect_b32 s72, s12, s72
    v_mfma_f32_16x16x32_bf16 v[124:127], v[36:39], v[8:11], v[124:127]
    v_mfma_f32_16x16x32_bf16 v[128:131], v[36:39], v[20:23], v[128:131]
    ds_read_b64_tr_b16 v[36:37], v12 offset:34240
    v_mfma_f32_16x16x32_bf16 v[160:163], v[40:43], v[20:23], v[160:163]
    ds_read_b64_tr_b16 v[38:39], v12 offset:35648
    s_waitcnt lgkmcnt(2)
    v_cmp_ne_u32 vcc, s62, v15
    s_cbranch_vccnz L_f_sp3_27
L_f_sb3_27:
    v_mfma_f32_16x16x32_bf16 v[156:159], v[40:43], v[8:11], v[156:159]
    v_mfma_f32_16x16x32_bf16 v[144:147], v[40:43], v[64:67], v[144:147]
    v_mfma_f32_16x16x32_bf16 v[140:143], v[40:43], v[60:63], v[140:143]
    s_waitcnt vmcnt(5) lgkmcnt(0)
    ds_write_b8 v16, v14 offset:116
    v_mfma_f32_16x16x32_bf16 v[68:71], v[28:31], v[44:47], v[68:71]
    ds_read_b64_tr_b16 v[40:41], v12 offset:45568
    ds_read_b64_tr_b16 v[42:43], v12 offset:46976
    v_mfma_f32_16x16x32_bf16 v[72:75], v[28:31], v[48:51], v[72:75]
    ds_read_b128 v[60:63], v13 offset:57344
    v_mfma_f32_16x16x32_bf16 v[84:87], v[28:31], v[52:55], v[84:87]
    ds_read_b128 v[64:67], v13 offset:59392
    v_mfma_f32_16x16x32_bf16 v[88:91], v[28:31], v[56:59], v[88:91]
    ds_read_b64_tr_b16 v[28:29], v12 offset:45600
    v_mfma_f32_16x16x32_bf16 v[120:123], v[32:35], v[56:59], v[120:123]
    ds_read_b64_tr_b16 v[30:31], v12 offset:47008
    ds_read_b32 v15, v17 offset:116
    v_mfma_f32_16x16x32_bf16 v[116:119], v[32:35], v[52:55], v[116:119]
    s_add_u32 m0, s15, 8192
    s_nop 0
    buffer_load_dwordx4 v4, s[44:47], s72 offen lds
    buffer_load_dwordx4 v5, s[44:47], s72 offen offset:1024 lds
    s_add_u32 s72, s72, 16384
    s_cmp_eq_u32 s72, s13
    s_cselect_b32 s72, s12, s72
    v_mfma_f32_16x16x32_bf16 v[104:107], v[32:35], v[48:51], v[104:107]
    v_mfma_f32_16x16x32_bf16 v[100:103], v[32:35], v[44:47], v[100:103]
    ds_read_b64_tr_b16 v[32:33], v12 offset:45632
    v_mfma_f32_16x16x32_bf16 v[132:135], v[36:39], v[44:47], v[132:135]
    ds_read_b64_tr_b16 v[34:35], v12 offset:47040
    s_add_u32 m0, s15, 16384
    s_nop 0
    buffer_load_dwordx4 v4, s[44:47], s72 offen lds
    buffer_load_dwordx4 v5, s[44:47], s72 offen offset:1024 lds
    s_add_u32 s72, s72, 16384
    s_cmp_eq_u32 s72, s13
    s_cselect_b32 s72, s12, s72
    s_waitcnt lgkmcnt(2)
    v_cmp_ne_u32 vcc, s62, v15
    s_cbranch_vccnz L_f_sp3_28
L_f_sb3_28:
    v_mfma_f32_16x16x32_bf16 v[136:139], v[36:39], v[48:51], v[136:139]
    v_mfma_f32_16x16x32_bf16 v[148:151], v[36:39], v[52:55], v[148:151]
    v_mfma_f32_16x16x32_bf16 v[152:155], v[36:39], v[56:59], v[152:155]
    s_waitcnt vmcnt(6) lgkmcnt(0)
    ds_write_b8 v16, v14 offset:120
    v_mfma_f32_16x16x32_bf16 v[96:99], v[40:43], v[56:59], v[96:99]
    ds_read_b64_tr_b16 v[36:37], v12 offset:0
    ds_read_b64_tr_b16 v[38:39], v12 offset:1408
    v_mfma_f32_16x16x32_bf16 v[92:95], v[40:43], v[52:55], v[92:95]
    ds_read_b128 v[8:11], v13 offset:61440
    v_mfma_f32_16x16x32_bf16 v[80:83], v[40:43], v[48:51], v[80:83]
    ds_read_b128 v[20:23], v13 offset:63488
    v_mfma_f32_16x16x32_bf16 v[76:79], v[40:43], v[44:47], v[76:79]
    ds_read_b64_tr_b16 v[40:41], v12 offset:32
    v_mfma_f32_16x16x32_bf16 v[108:111], v[28:31], v[44:47], v[108:111]
    ds_read_b64_tr_b16 v[42:43], v12 offset:1440
    ds_read_b32 v15, v17 offset:120
    v_mfma_f32_16x16x32_bf16 v[112:115], v[28:31], v[48:51], v[112:115]
    s_add_u32 m0, s15, 24576
    s_nop 0
    buffer_load_dwordx4 v4, s[44:47], s72 offen lds
    buffer_load_dwordx4 v5, s[44:47], s72 offen offset:1024 lds
    s_add_u32 s72, s72, 16384
    s_cmp_eq_u32 s72, s13
    s_cselect_b32 s72, s12, s72
    v_mfma_f32_16x16x32_bf16 v[124:127], v[28:31], v[52:55], v[124:127]
    v_mfma_f32_16x16x32_bf16 v[128:131], v[28:31], v[56:59], v[128:131]
    ds_read_b64_tr_b16 v[28:29], v12 offset:64
    v_mfma_f32_16x16x32_bf16 v[160:163], v[32:35], v[56:59], v[160:163]
    ds_read_b64_tr_b16 v[30:31], v12 offset:1472
    s_add_u32 m0, s15, 32768
    s_nop 0
    buffer_load_dwordx4 v4, s[44:47], s72 offen lds
    buffer_load_dwordx4 v5, s[44:47], s72 offen offset:1024 lds
    s_add_u32 s72, s72, 16384
    s_cmp_eq_u32 s72, s13
    s_cselect_b32 s72, s12, s72
    s_waitcnt lgkmcnt(2)
    v_cmp_ne_u32 vcc, s62, v15
    s_cbranch_vccnz L_f_sp3_29
L_f_sb3_29:
    v_mfma_f32_16x16x32_bf16 v[156:159], v[32:35], v[52:55], v[156:159]
    v_mfma_f32_16x16x32_bf16 v[144:147], v[32:35], v[48:51], v[144:147]
    v_mfma_f32_16x16x32_bf16 v[140:143], v[32:35], v[44:47], v[140:143]
    s_waitcnt vmcnt(10) lgkmcnt(0)
    ds_write_b8 v16, v14 offset:124
    v_mfma_f32_16x16x32_bf16 v[68:71], v[36:39], v[60:63], v[68:71]
    ds_read_b64_tr_b16 v[32:33], v12 offset:11392
    ds_read_b64_tr_b16 v[34:35], v12 offset:12800
    v_mfma_f32_16x16x32_bf16 v[72:75], v[36:39], v[64:67], v[72:75]
    v_mfma_f32_16x16x32_bf16 v[84:87], v[36:39], v[8:11], v[84:87]
    v_mfma_f32_16x16x32_bf16 v[88:91], v[36:39], v[20:23], v[88:91]
    ds_read_b64_tr_b16 v[36:37], v12 offset:11424
    v_mfma_f32_16x16x32_bf16 v[120:123], v[40:43], v[20:23], v[120:123]
    ds_read_b64_tr_b16 v[38:39], v12 offset:12832
    ds_read_b32 v15, v17 offset:124
    v_mfma_f32_16x16x32_bf16 v[116:119], v[40:43], v[8:11], v[116:119]
    s_add_u32 m0, s15, 40960
    s_nop 0
    buffer_load_dwordx4 v4, s[44:47], s72 offen lds
    buffer_load_dwordx4 v5, s[44:47], s72 offen offset:1024 lds
    s_add_u32 s72, s72, 16384
    s_cmp_eq_u32 s72, s13
    s_cselect_b32 s72, s12, s72
    v_mfma_f32_16x16x32_bf16 v[104:107], v[40:43], v[64:67], v[104:107]
    v_mfma_f32_16x16x32_bf16 v[100:103], v[40:43], v[60:63], v[100:103]
    ds_read_b64_tr_b16 v[40:41], v12 offset:11456
    v_mfma_f32_16x16x32_bf16 v[132:135], v[28:31], v[60:63], v[132:135]
    ds_read_b64_tr_b16 v[42:43], v12 offset:12864
    s_waitcnt lgkmcnt(2)
    v_cmp_ne_u32 vcc, s62, v15
    s_cbranch_vccnz L_f_sp3_30
L_f_sb3_30:
    v_mfma_f32_16x16x32_bf16 v[136:139], v[28:31], v[64:67], v[136:139]
    v_mfma_f32_16x16x32_bf16 v[148:151], v[28:31], v[8:11], v[148:151]
    v_mfma_f32_16x16x32_bf16 v[152:155], v[28:31], v[20:23], v[152:155]
    s_waitcnt vmcnt(12) lgkmcnt(0)
    ds_write_b8 v16, v14 offset:128
    v_mfma_f32_16x16x32_bf16 v[96:99], v[32:35], v[20:23], v[96:99]
    v_mfma_f32_16x16x32_bf16 v[92:95], v[32:35], v[8:11], v[92:95]
    v_mfma_f32_16x16x32_bf16 v[80:83], v[32:35], v[64:67], v[80:83]
    v_mfma_f32_16x16x32_bf16 v[76:79], v[32:35], v[60:63], v[76:79]
    v_mfma_f32_16x16x32_bf16 v[108:111], v[36:39], v[60:63], v[108:111]
    ds_read_b32 v15, v17 offset:128
    v_mfma_f32_16x16x32_bf16 v[112:115], v[36:39], v[64:67], v[112:115]
    s_add_u32 m0, s15, 49152
    s_nop 0
    buffer_load_dwordx4 v4, s[44:47], s72 offen lds
    buffer_load_dwordx4 v5, s[44:47], s72 offen offset:1024 lds
    s_add_u32 s72, s72, 16384
    s_cmp_eq_u32 s72, s13
    s_cselect_b32 s72, s12, s72
    v_mfma_f32_16x16x32_bf16 v[124:127], v[36:39], v[8:11], v[124:127]
    v_mfma_f32_16x16x32_bf16 v[128:131], v[36:39], v[20:23], v[128:131]
    v_mfma_f32_16x16x32_bf16 v[160:163], v[40:43], v[20:23], v[160:163]
    s_waitcnt lgkmcnt(0)
    v_cmp_ne_u32 vcc, s62, v15
    s_cbranch_vccnz L_f_sp3_31
L_f_sb3_31:
    v_mfma_f32_16x16x32_bf16 v[156:159], v[40:43], v[8:11], v[156:159]
    v_mfma_f32_16x16x32_bf16 v[144:147], v[40:43], v[64:67], v[144:147]
    v_mfma_f32_16x16x32_bf16 v[140:143], v[40:43], v[60:63], v[140:143]
    s_branch L_f_done
L_f3:
    v_mfma_f32_16x16x32_bf16 v[68:71], v[28:31], v[44:47], 0
    ds_read_b64_tr_b16 v[36:37], v12 offset:11392
    ds_read_b64_tr_b16 v[38:39], v12 offset:12800
    v_mfma_f32_16x16x32_bf16 v[72:75], v[28:31], v[48:51], 0
    ds_read_b128 v[60:63], v13 offset:0
    v_mfma_f32_16x16x32_bf16 v[84:87], v[28:31], v[52:55], 0
    ds_read_b128 v[64:67], v13 offset:2048
    v_mfma_f32_16x16x32_bf16 v[88:91], v[28:31], v[56:59], 0
    ds_read_b64_tr_b16 v[40:41], v12 offset:11424
    v_mfma_f32_16x16x32_bf16 v[120:123], v[32:35], v[56:59], 0
    ds_read_b64_tr_b16 v[42:43], v12 offset:12832
    ds_read_b32 v15, v17 offset:4
    v_mfma_f32_16x16x32_bf16 v[116:119], v[32:35], v[52:55], 0
    s_add_u32 m0, s61, 65792
    v_mfma_f32_16x16x32_bf16 v[104:107], v[32:35], v[48:51], 0
    v_mfma_f32_16x16x32_bf16 v[100:103], v[32:35], v[44:47], 0
    s_waitcnt lgkmcnt(0)
    v_cmp_ne_u32 vcc, s62, v15
    s_cbranch_vccnz L_f_sp2_0
L_f_sb2_0:
    buffer_load_dwordx4 v164, s[40:43], s63 offen offset:0 lds
    buffer_load_dwordx4 v165, s[40:43], s63 offen offset:1024 lds
    buffer_load_dwordx4 v166, s[40:43], s63 offen offset:2048 lds
    s_add_u32 s63, s63, 88064
    s_waitcnt vmcnt(6) lgkmcnt(0)
    ds_write_b8 v16, v14 offset:8
    v_mfma_f32_16x16x32_bf16 v[76:79], v[36:39], v[44:47], 0
    ds_read_b64_tr_b16 v[28:29], v12 offset:22784
    ds_read_b64_tr_b16 v[30:31], v12 offset:24192
    v_mfma_f32_16x16x32_bf16 v[80:83], v[36:39], v[48:51], 0
    ds_read_b128 v[8:11], v13 offset:4096
    v_mfma_f32_16x16x32_bf16 v[92:95], v[36:39], v[52:55], 0
    ds_read_b128 v[20:23], v13 offset:6144
    v_mfma_f32_16x16x32_bf16 v[96:99], v[36:39], v[56:59], 0
    ds_read_b64_tr_b16 v[32:33], v12 offset:22816
    v_mfma_f32_16x16x32_bf16 v[128:131], v[40:43], v[56:59], 0
    ds_read_b64_tr_b16 v[34:35], v12 offset:24224
    ds_read_b32 v15, v17 offset:8
    v_mfma_f32_16x16x32_bf16 v[124:127], v[40:43], v[52:55], 0
    s_add_u32 m0, s61, 77184
    v_mfma_f32_16x16x32_bf16 v[112:115], v[40:43], v[48:51], 0
    v_mfma_f32_16x16x32_bf16 v[108:111], v[40:43], v[44:47], 0
    s_waitcnt lgkmcnt(0)
    v_cmp_ne_u32 vcc, s62, v15
    s_cbranch_vccnz L_f_sp2_1
L_f_sb2_1:
    buffer_load_dwordx4 v164, s[36:39], s63 offen offset:0 lds
    buffer_load_dwordx4 v165, s[36:39], s63 offen offset:1024 lds
    buffer_load_dwordx4 v166, s[36:39], s63 offen offset:2048 lds
    s_waitcnt vmcnt(6) lgkmcnt(0)
    ds_write_b8 v16, v14 offset:12
    v_mfma_f32_16x16x32_bf16 v[68:71], v[28:31], v[60:63], v[68:71]
    ds_read_b64_tr_b16 v[36:37], v12 offset:34176
    ds_read_b64_tr_b16 v[38:39], v12 offset:35584
    v_mfma_f32_16x16x32_bf16 v[72:75], v[28:31], v[64:67], v[72:75]
    ds_read_b128 v[44:47], v3 offset:8192
    v_mfma_f32_16x16x32_bf16 v[84:87], v[28:31], v[8:11], v[84:87]
    ds_read_b128 v[48:51], v3 offset:10240
    v_mfma_f32_16x16x32_bf16 v[88:91], v[28:31], v[20:23], v[88:91]
    ds_read_b64_tr_b16 v[40:41], v12 offset:34208
    v_mfma_f32_16x16x32_bf16 v[120:123], v[32:35], v[20:23], v[120:123]
    ds_read_b64_tr_b16 v[42:43], v12 offset:35616
    ds_read_b32 v15, v17 offset:12
    v_mfma_f32_16x16x32_bf16 v[116:119], v[32:35], v[8:11], v[116:119]
    s_add_u32 m0, s61, 88576
    v_mfma_f32_16x16x32_bf16 v[104:107], v[32:35], v[64:67], v[104:107]
    v_mfma_f32_16x16x32_bf16 v[100:103], v[32:35], v[60:63], v[100:103]
    s_waitcnt lgkmcnt(0)
    v_cmp_ne_u32 vcc, s62, v15
    s_cbranch_vccnz L_f_sp2_2
L_f_sb2_2:
    buffer_load_dwordx4 v164, s[40:43], s63 offen offset:0 lds
    buffer_load_dwordx4 v165, s[40:43], s63 offen offset:1024 lds
    buffer_load_dwordx4 v166, s[40:43], s63 offen offset:2048 lds
    s_add_u32 s63, s63, 88064
    s_waitcnt vmcnt(6) lgkmcnt(0)
    ds_write_b8 v16, v14 offset:16
    v_mfma_f32_16x16x32_bf16 v[76:79], v[36:39], v[60:63], v[76:79]
    ds_read_b64_tr_b16 v[28:29], v12 offset:45568
    ds_read_b64_tr_b16 v[30:31], v12 offset:46976
    v_mfma_f32_16x16x32_bf16 v[80:83], v[36:39], v[64:67], v[80:83]
    ds_read_b128 v[52:55], v3 offset:12288
    v_mfma_f32_16x16x32_bf16 v[92:95], v[36:39], v[8:11], v[92:95]
    ds_read_b128 v[56:59], v3 offset:14336
    v_mfma_f32_16x16x32_bf16 v[96:99], v[36:39], v[20:23], v[96:99]
    ds_read_b64_tr_b16 v[32:33], v12 offset:45600
    v_mfma_f32_16x16x32_bf16 v[128:131], v[40:43], v[20:23], v[128:131]
    ds_read_b64_tr_b16 v[34:35], v12 offset:47008
    ds_read_b32 v15, v17 offset:16
    v_mfma_f32_16x16x32_bf16 v[124:127], v[40:43], v[8:11], v[124:127]
    s_add_u32 m0, s61, 99968
    v_mfma_f32_16x16x32_bf16 v[112:115], v[40:43], v[64:67], v[112:115]
    v_mfma_f32_16x16x32_bf16 v[108:111], v[40:43], v[60:63], v[108:111]
    s_waitcnt lgkmcnt(0)
    v_cmp_ne_u32 vcc, s62, v15
    s_cbranch_vccnz L_f_sp2_3
L_f_sb2_3:
    buffer_load_dwordx4 v164, s[36:39], s63 offen offset:0 lds
    buffer_load_dwordx4 v165, s[36:39], s63 offen offset:1024 lds
    buffer_load_dwordx4 v166, s[36:39], s63 offen offset:2048 lds
    s_waitcnt vmcnt(6) lgkmcnt(0)
    ds_write_b8 v16, v14 offset:20
    v_mfma_f32_16x16x32_bf16 v[68:71], v[28:31], v[44:47], v[68:71]
    ds_read_b64_tr_b16 v[36:37], v12 offset:0
    ds_read_b64_tr_b16 v[38:39], v12 offset:1408
    v_mfma_f32_16x16x32_bf16 v[72:75], v[28:31], v[48:51], v[72:75]
    ds_read_b128 v[60:63], v13 offset:8192
    v_mfma_f32_16x16x32_bf16 v[84:87], v[28:31], v[52:55], v[84:87]
    ds_read_b128 v[64:67], v13 offset:10240
    v_mfma_f32_16x16x32_bf16 v[88:91], v[28:31], v[56:59], v[88:91]
    ds_read_b64_tr_b16 v[40:41], v12 offset:32
    v_mfma_f32_16x16x32_bf16 v[120:123], v[32:35], v[56:59], v[120:123]
    ds_read_b64_tr_b16 v[42:43], v12 offset:1440
    ds_read_b32 v15, v17 offset:20
    v_mfma_f32_16x16x32_bf16 v[116:119], v[32:35], v[52:55], v[116:119]
    s_add_u32 m0, s61, 111360
    v_mfma_f32_16x16x32_bf16 v[104:107], v[32:35], v[48:51], v[104:107]
    v_mfma_f32_16x16x32_bf16 v[100:103], v[32:35], v[44:47], v[100:103]
    s_waitcnt lgkmcnt(0)
    v_cmp_ne_u32 vcc, s62, v15
    s_cbranch_vccnz L_f_sp2_4
L_f_sb2_4:
    buffer_load_dwordx4 v164, s[40:43], s63 offen offset:0 lds
    buffer_load_dwordx4 v165, s[40:43], s63 offen offset:1024 lds
    buffer_load_dwordx4 v166, s[40:43], s63 offen offset:2048 lds
    s_add_u32 s63, s63, 88064
    s_waitcnt vmcnt(6) lgkmcnt(0)
    ds_write_b8 v16, v14 offset:24
    v_mfma_f32_16x16x32_bf16 v[76:79], v[36:39], v[44:47], v[76:79]
    ds_read_b64_tr_b16 v[28:29], v12 offset:11392
    ds_read_b64_tr_b16 v[30:31], v12 offset:12800
    v_mfma_f32_16x16x32_bf16 v[80:83], v[36:39], v[48:51], v[80:83]
    ds_read_b128 v[8:11], v13 offset:12288
    v_mfma_f32_16x16x32_bf16 v[92:95], v[36:39], v[52:55], v[92:95]
    ds_read_b128 v[20:23], v13 offset:14336
    v_mfma_f32_16x16x32_bf16 v[96:99], v[36:39], v[56:59], v[96:99]
    ds_read_b64_tr_b16 v[32:33], v12 offset:11424
    v_mfma_f32_16x16x32_bf16 v[128:131], v[40:43], v[56:59], v[128:131]
    ds_read_b64_tr_b16 v[34:35], v12 offset:12832
    ds_read_b32 v15, v17 offset:24
    v_mfma_f32_16x16x32_bf16 v[124:127], v[40:43], v[52:55], v[124:127]
    s_add_u32 m0, s61, 65792
    v_mfma_f32_16x16x32_bf16 v[112:115], v[40:43], v[48:51], v[112:115]
    v_mfma_f32_16x16x32_bf16 v[108:111], v[40:43], v[44:47], v[108:111]
    s_waitcnt lgkmcnt(0)
    v_cmp_ne_u32 vcc, s62, v15
    s_cbranch_vccnz L_f_sp2_5
L_f_sb2_5:
    buffer_load_dwordx4 v164, s[36:39], s63 offen offset:0 lds
    buffer_load_dwordx4 v165, s[36:39], s63 offen offset:1024 lds
    buffer_load_dwordx4 v166, s[36:39], s63 offen offset:2048 lds
    s_waitcnt vmcnt(6) lgkmcnt(0)
    ds_write_b8 v16, v14 offset:28
    v_mfma_f32_16x16x32_bf16 v[68:71], v[28:31], v[60:63], v[68:71]
    ds_read_b64_tr_b16 v[36:37], v12 offset:22784
    ds_read_b64_tr_b16 v[38:39], v12 offset:24192
    v_mfma_f32_16x16x32_bf16 v[72:75], v[28:31], v[64:67], v[72:75]
    ds_read_b128 v[44:47], v3 offset:16384
    v_mfma_f32_16x16x32_bf16 v[84:87], v[28:31], v[8:11], v[84:87]
    ds_read_b128 v[48:51], v3 offset:18432
    v_mfma_f32_16x16x32_bf16 v[88:91], v[28:31], v[20:23], v[88:91]
    ds_read_b64_tr_b16 v[40:41], v12 offset:22816
    v_mfma_f32_16x16x32_bf16 v[120:123], v[32:35], v[20:23], v[120:123]
    ds_read_b64_tr_b16 v[42:43], v12 offset:24224
    ds_read_b32 v15, v17 offset:28
    v_mfma_f32_16x16x32_bf16 v[116:119], v[32:35], v[8:11], v[116:119]
    s_add_u32 m0, s61, 77184
    v_mfma_f32_16x16x32_bf16 v[104:107], v[32:35], v[64:67], v[104:107]
    v_mfma_f32_16x16x32_bf16 v[100:103], v[32:35], v[60:63], v[100:103]
    s_waitcnt lgkmcnt(0)
    v_cmp_ne_u32 vcc, s62, v15
    s_cbranch_vccnz L_f_sp2_6
L_f_sb2_6:
    buffer_load_dwordx4 v164, s[40:43], s63 offen offset:0 lds
    buffer_load_dwordx4 v165, s[40:43], s63 offen offset:1024 lds
    buffer_load_dwordx4 v166, s[40:43], s63 offen offset:2048 lds
    s_add_u32 s63, s63, 88064
    s_waitcnt vmcnt(6) lgkmcnt(0)
    ds_write_b8 v16, v14 offset:32
    v_mfma_f32_16x16x32_bf16 v[76:79], v[36:39], v[60:63], v[76:79]
    ds_read_b64_tr_b16 v[28:29], v12 offset:34176
    ds_read_b64_tr_b16 v[30:31], v12 offset:35584
    v_mfma_f32_16x16x32_bf16 v[80:83], v[36:39], v[64:67], v[80:83]
    ds_read_b128 v[52:55], v3 offset:20480
    v_mfma_f32_16x16x32_bf16 v[92:95], v[36:39], v[8:11], v[92:95]
    ds_read_b128 v[56:59], v3 offset:22528
    v_mfma_f32_16x16x32_bf16 v[96:99], v[36:39], v[20:23], v[96:99]
    ds_read_b64_tr_b16 v[32:33], v12 offset:34208
    v_mfma_f32_16x16x32_bf16 v[128:131], v[40:43], v[20:23], v[128:131]
    ds_read_b64_tr_b16 v[34:35], v12 offset:35616
    ds_read_b32 v15, v17 offset:32
    v_mfma_f32_16x16x32_bf16 v[124:127], v[40:43], v[8:11], v[124:127]
    s_add_u32 m0, s61, 88576
    v_mfma_f32_16x16x32_bf16 v[112:115], v[40:43], v[64:67], v[112:115]
    v_mfma_f32_16x16x32_bf16 v[108:111], v[40:43], v[60:63], v[108:111]
    s_waitcnt lgkmcnt(0)
    v_cmp_ne_u32 vcc, s62, v15
    s_cbranch_vccnz L_f_sp2_7
L_f_sb2_7:
    buffer_load_dwordx4 v164, s[36:39], s63 offen offset:0 lds
    buffer_load_dwordx4 v165, s[36:39], s63 offen offset:1024 lds
    buffer_load_dwordx4 v166, s[36:39], s63 offen offset:2048 lds
    s_waitcnt vmcnt(6) lgkmcnt(0)
    ds_write_b8 v16, v14 offset:36
    v_mfma_f32_16x16x32_bf16 v[68:71], v[28:31], v[44:47], v[68:71]
    ds_read_b64_tr_b16 v[36:37], v12 offset:45568
    ds_read_b64_tr_b16 v[38:39], v12 offset:46976
    v_mfma_f32_16x16x32_bf16 v[72:75], v[28:31], v[48:51], v[72:75]
    ds_read_b128 v[60:63], v13 offset:16384
    v_mfma_f32_16x16x32_bf16 v[84:87], v[28:31], v[52:55], v[84:87]
    ds_read_b128 v[64:67], v13 offset:18432
    v_mfma_f32_16x16x32_bf16 v[88:91], v[28:31], v[56:59], v[88:91]
    ds_read_b64_tr_b16 v[40:41], v12 offset:45600
    v_mfma_f32_16x16x32_bf16 v[120:123], v[32:35], v[56:59], v[120:123]
    ds_read_b64_tr_b16 v[42:43], v12 offset:47008
    ds_read_b32 v15, v17 offset:36
    v_mfma_f32_16x16x32_bf16 v[116:119], v[32:35], v[52:55], v[116:119]
    s_add_u32 m0, s61, 99968
    v_mfma_f32_16x16x32_bf16 v[104:107], v[32:35], v[48:51], v[104:107]
    v_mfma_f32_16x16x32_bf16 v[100:103], v[32:35], v[44:47], v[100:103]
    s_waitcnt lgkmcnt(0)
    v_cmp_ne_u32 vcc, s62, v15
    s_cbranch_vccnz L_f_sp2_8
L_f_sb2_8:
    buffer_load_dwordx4 v164, s[40:43], s63 offen offset:0 lds
    buffer_load_dwordx4 v165, s[40:43], s63 offen offset:1024 lds
    buffer_load_dwordx4 v166, s[40:43], s63 offen offset:2048 lds
    s_add_u32 s63, s63, 88064
    s_waitcnt vmcnt(6) lgkmcnt(0)
    ds_write_b8 v16, v14 offset:40
    v_mfma_f32_16x16x32_bf16 v[76:79], v[36:39], v[44:47], v[76:79]
    ds_read_b64_tr_b16 v[28:29], v12 offset:0
    ds_read_b64_tr_b16 v[30:31], v12 offset:1408
    v_mfma_f32_16x16x32_bf16 v[80:83], v[36:39], v[48:51], v[80:83]
    ds_read_b128 v[8:11], v13 offset:20480
    v_mfma_f32_16x16x32_bf16 v[92:95], v[36:39], v[52:55], v[92:95]
    ds_read_b128 v[20:23], v13 offset:22528
    v_mfma_f32_16x16x32_bf16 v[96:99], v[36:39], v[56:59], v[96:99]
    ds_read_b64_tr_b16 v[32:33], v12 offset:32
    v_mfma_f32_16x16x32_bf16 v[128:131], v[40:43], v[56:59], v[128:131]
    ds_read_b64_tr_b16 v[34:35], v12 offset:1440
    ds_read_b32 v15, v17 offset:40
    v_mfma_f32_16x16x32_bf16 v[124:127], v[40:43], v[52:55], v[124:127]
    s_add_u32 m0, s61, 111360
    v_mfma_f32_16x16x32_bf16 v[112:115], v[40:43], v[48:51], v[112:115]
    v_mfma_f32_16x16x32_bf16 v[108:111], v[40:43], v[44:47], v[108:111]
    s_waitcnt lgkmcnt(0)
    v_cmp_ne_u32 vcc, s62, v15
    s_cbranch_vccnz L_f_sp2_9
L_f_sb2_9:
    buffer_load_dwordx4 v164, s[36:39], s63 offen offset:0 lds
    buffer_load_dwordx4 v165, s[36:39], s63 offen offset:1024 lds
    buffer_load_dwordx4 v166, s[36:39], s63 offen offset:2048 lds
    s_waitcnt vmcnt(6) lgkmcnt(0)
    ds_write_b8 v16, v14 offset:44
    v_and_b32 v24, 65567, v25
L_f_gate2:
    ds_read_b32 v15, v24
    s_waitcnt lgkmcnt(0)
    v_cmp_gt_u32 vcc, 2, v15
    s_cbranch_vccz L_f_gok2
    s_sleep 2
    s_branch L_f_gate2
L_f_gok2:
    s_mov_b32 exec_lo, 0x0
    s_mov_b32 exec_hi, 0x7f7f7f7f
    s_cmp_eq_u32 s17, 1
    s_cbranch_scc1 L_pu3
    buffer_load_dword v27, v26, s[36:39], s70 offen
    s_branch L_pd3
L_pu3:
    buffer_load_dword v27, v26, s[40:43], s70 offen
L_pd3:
    s_mov_b64 exec, -1
    v_mfma_f32_16x16x32_bf16 v[68:71], v[28:31], v[60:63], v[68:71]
    ds_read_b64_tr_b16 v[36:37], v12 offset:11392
    ds_read_b64_tr_b16 v[38:39], v12 offset:12800
    v_mfma_f32_16x16x32_bf16 v[72:75], v[28:31], v[64:67], v[72:75]
    ds_read_b128 v[44:47], v3 offset:24576
    v_mfma_f32_16x16x32_bf16 v[84:87], v[28:31], v[8:11], v[84:87]
    ds_read_b128 v[48:51], v3 offset:26624
    v_mfma_f32_16x16x32_bf16 v[88:91], v[28:31], v[20:23], v[88:91]
    ds_read_b64_tr_b16 v[40:41], v12 offset:11424
    v_mfma_f32_16x16x32_bf16 v[120:123], v[32:35], v[20:23], v[120:123]
    ds_read_b64_tr_b16 v[42:43], v12 offset:12832
    ds_read_b32 v15, v17 offset:44
    v_mfma_f32_16x16x32_bf16 v[116:119], v[32:35], v[8:11], v[116:119]
    s_add_u32 m0, s61, 65792
    v_mfma_f32_16x16x32_bf16 v[104:107], v[32:35], v[64:67], v[104:107]
    v_mfma_f32_16x16x32_bf16 v[100:103], v[32:35], v[60:63], v[100:103]
    s_waitcnt lgkmcnt(0)
    v_cmp_ne_u32 vcc, s62, v15
    s_cbranch_vccnz L_f_sp2_10
L_f_sb2_10:
    buffer_load_dwordx4 v164, s[40:43], s63 offen offset:0 lds
    buffer_load_dwordx4 v165, s[40:43], s63 offen offset:1024 lds
    buffer_load_dwordx4 v166, s[40:43], s63 offen offset:2048 lds
    s_add_u32 s63, s63, 88064
    s_waitcnt vmcnt(6) lgkmcnt(0)
    ds_write_b8 v16, v14 offset:48
    v_mfma_f32_16x16x32_bf16 v[76:79], v[36:39], v[60:63], v[76:79]
    ds_read_b64_tr_b16 v[28:29], v12 offset:22784
    ds_read_b64_tr_b16 v[30:31], v12 offset:24192
    v_mfma_f32_16x16x32_bf16 v[80:83], v[36:39], v[64:67], v[80:83]
    ds_read_b128 v[52:55], v3 offset:28672
    v_mfma_f32_16x16x32_bf16 v[92:95], v[36:39], v[8:11], v[92:95]
    ds_read_b128 v[56:59], v3 offset:30720
    v_mfma_f32_16x16x32_bf16 v[96:99], v[36:39], v[20:23], v[96:99]
    ds_read_b64_tr_b16 v[32:33], v12 offset:22816
    v_mfma_f32_16x16x32_bf16 v[128:131], v[40:43], v[20:23], v[128:131]
    ds_read_b64_tr_b16 v[34:35], v12 offset:24224
    ds_read_b32 v15, v17 offset:48
    v_mfma_f32_16x16x32_bf16 v[124:127], v[40:43], v[8:11], v[124:127]
    s_add_u32 m0, s61, 77184
    v_mfma_f32_16x16x32_bf16 v[112:115], v[40:43], v[64:67], v[112:115]
    v_mfma_f32_16x16x32_bf16 v[108:111], v[40:43], v[60:63], v[108:111]
    s_waitcnt lgkmcnt(0)
    v_cmp_ne_u32 vcc, s62, v15
    s_cbranch_vccnz L_f_sp2_11
L_f_sb2_11:
    buffer_load_dwordx4 v164, s[36:39], s63 offen offset:0 lds
    buffer_load_dwordx4 v165, s[36:39], s63 offen offset:1024 lds
    buffer_load_dwordx4 v166, s[36:39], s63 offen offset:2048 lds
    s_waitcnt vmcnt(6) lgkmcnt(0)
    ds_write_b8 v16, v14 offset:52
    v_mfma_f32_16x16x32_bf16 v[68:71], v[28:31], v[44:47], v[68:71]
    ds_read_b64_tr_b16 v[36:37], v12 offset:34176
    ds_read_b64_tr_b16 v[38:39], v12 offset:35584
    v_mfma_f32_16x16x32_bf16 v[72:75], v[28:31], v[48:51], v[72:75]
    ds_read_b128 v[60:63], v13 offset:24576
    v_mfma_f32_16x16x32_bf16 v[84:87], v[28:31], v[52:55], v[84:87]
    ds_read_b128 v[64:67], v13 offset:26624
    v_mfma_f32_16x16x32_bf16 v[88:91], v[28:31], v[56:59], v[88:91]
    ds_read_b64_tr_b16 v[40:41], v12 offset:34208
    v_mfma_f32_16x16x32_bf16 v[120:123], v[32:35], v[56:59], v[120:123]
    ds_read_b64_tr_b16 v[42:43], v12 offset:35616
    ds_read_b32 v15, v17 offset:52
    v_mfma_f32_16x16x32_bf16 v[116:119], v[32:35], v[52:55], v[116:119]
    s_add_u32 m0, s61, 88576
    v_mfma_f32_16x16x32_bf16 v[104:107], v[32:35], v[48:51], v[104:107]
    v_mfma_f32_16x16x32_bf16 v[100:103], v[32:35], v[44:47], v[100:103]
    s_waitcnt lgkmcnt(0)
    v_cmp_ne_u32 vcc, s62, v15
    s_cbranch_vccnz L_f_sp2_12
L_f_sb2_12:
    buffer_load_dwordx4 v164, s[40:43], s63 offen offset:0 lds
    buffer_load_dwordx4 v165, s[40:43], s63 offen offset:1024 lds
    buffer_load_dwordx4 v166, s[40:43], s63 offen offset:2048 lds
    s_add_u32 s63, s63, 88064
    s_waitcnt vmcnt(6) lgkmcnt(0)
    ds_write_b8 v16, v14 offset:56
    s_bitcmp1_b32 s2, 3
    s_cbranch_scc1 L_f_np2_12
    buffer_load_dword v167, v18, s[44:47], s64 offen
    s_add_u32 s64, s64, 8192
L_f_np2_12:
    v_mfma_f32_16x16x32_bf16 v[76:79], v[36:39], v[44:47], v[76:79]
    ds_read_b64_tr_b16 v[28:29], v12 offset:45568
    ds_read_b64_tr_b16 v[30:31], v12 offset:46976
    v_mfma_f32_16x16x32_bf16 v[80:83], v[36:39], v[48:51], v[80:83]
    ds_read_b128 v[8:11], v13 offset:28672
    v_mfma_f32_16x16x32_bf16 v[92:95], v[36:39], v[52:55], v[92:95]
    ds_read_b128 v[20:23], v13 offset:30720
    v_mfma_f32_16x16x32_bf16 v[96:99], v[36:39], v[56:59], v[96:99]
    ds_read_b64_tr_b16 v[32:33], v12 offset:45600
    v_mfma_f32_16x16x32_bf16 v[128:131], v[40:43], v[56:59], v[128:131]
    ds_read_b64_tr_b16 v[34:35], v12 offset:47008
    ds_read_b32 v15, v17 offset:56
    v_mfma_f32_16x16x32_bf16 v[124:127], v[40:43], v[52:55], v[124:127]
    s_add_u32 m0, s61, 99968
    v_mfma_f32_16x16x32_bf16 v[112:115], v[40:43], v[48:51], v[112:115]
    v_mfma_f32_16x16x32_bf16 v[108:111], v[40:43], v[44:47], v[108:111]
    s_waitcnt lgkmcnt(0)
    v_cmp_ne_u32 vcc, s62, v15
    s_cbranch_vccnz L_f_sp2_13
L_f_sb2_13:
    buffer_load_dwordx4 v164, s[36:39], s63 offen offset:0 lds
    buffer_load_dwordx4 v165, s[36:39], s63 offen offset:1024 lds
    buffer_load_dwordx4 v166, s[36:39], s63 offen offset:2048 lds
    s_waitcnt vmcnt(6) lgkmcnt(0)
    ds_write_b8 v16, v14 offset:60
    v_mfma_f32_16x16x32_bf16 v[68:71], v[28:31], v[60:63], v[68:71]
    ds_read_b64_tr_b16 v[36:37], v12 offset:0
    ds_read_b64_tr_b16 v[38:39], v12 offset:1408
    v_mfma_f32_16x16x32_bf16 v[72:75], v[28:31], v[64:67], v[72:75]
    ds_read_b128 v[44:47], v3 offset:32768
    v_mfma_f32_16x16x32_bf16 v[84:87], v[28:31], v[8:11], v[84:87]
    ds_read_b128 v[48:51], v3 offset:34816
    v_mfma_f32_16x16x32_bf16 v[88:91], v[28:31], v[20:23], v[88:91]
    ds_read_b64_tr_b16 v[40:41], v12 offset:32
    v_mfma_f32_16x16x32_bf16 v[120:123], v[32:35], v[20:23], v[120:123]
    ds_read_b64_tr_b16 v[42:43], v12 offset:1440
    ds_read_b32 v15, v17 offset:60
    v_mfma_f32_16x16x32_bf16 v[116:119], v[32:35], v[8:11], v[116:119]
    s_add_u32 m0, s61, 111360
    v_mfma_f32_16x16x32_bf16 v[104:107], v[32:35], v[64:67], v[104:107]
    v_mfma_f32_16x16x32_bf16 v[100:103], v[32:35], v[60:63], v[100:103]
    s_waitcnt lgkmcnt(0)
    v_cmp_ne_u32 vcc, s62, v15
    s_cbranch_vccnz L_f_sp2_14
L_f_sb2_14:
    buffer_load_dwordx4 v164, s[40:43], s63 offen offset:0 lds
    buffer_load_dwordx4 v165, s[40:43], s63 offen offset:1024 lds
    buffer_load_dwordx4 v166, s[40:43], s63 offen offset:2048 lds
    s_add_u32 s63, s63, 88064
    s_waitcnt vmcnt(6) lgkmcnt(0)
    ds_write_b8 v16, v14 offset:64
    v_mfma_f32_16x16x32_bf16 v[76:79], v[36:39], v[60:63], v[76:79]
    ds_read_b64_tr_b16 v[28:29], v12 offset:11392
    ds_read_b64_tr_b16 v[30:31], v12 offset:12800
    v_mfma_f32_16x16x32_bf16 v[80:83], v[36:39], v[64:67], v[80:83]
    ds_read_b128 v[52:55], v3 offset:36864
    v_mfma_f32_16x16x32_bf16 v[92:95], v[36:39], v[8:11], v[92:95]
    ds_read_b128 v[56:59], v3 offset:38912
    v_mfma_f32_16x16x32_bf16 v[96:99], v[36:39], v[20:23], v[96:99]
    ds_read_b64_tr_b16 v[32:33], v12 offset:11424
    v_mfma_f32_16x16x32_bf16 v[128:131], v[40:43], v[20:23], v[128:131]
    ds_read_b64_tr_b16 v[34:35], v12 offset:12832
    ds_read_b32 v15, v17 offset:64
    v_mfma_f32_16x16x32_bf16 v[124:127], v[40:43], v[8:11], v[124:127]
    s_add_u32 m0, s61, 65792
    v_mfma_f32_16x16x32_bf16 v[112:115], v[40:43], v[64:67], v[112:115]
    v_mfma_f32_16x16x32_bf16 v[108:111], v[40:43], v[60:63], v[108:111]
    s_waitcnt lgkmcnt(0)
    v_cmp_ne_u32 vcc, s62, v15
    s_cbranch_vccnz L_f_sp2_15
L_f_sb2_15:
    buffer_load_dwordx4 v164, s[36:39], s63 offen offset:0 lds
    buffer_load_dwordx4 v165, s[36:39], s63 offen offset:1024 lds
    buffer_load_dwordx4 v166, s[36:39], s63 offen offset:2048 lds
    s_waitcnt vmcnt(6) lgkmcnt(0)
    ds_write_b8 v16, v14 offset:68
    v_mfma_f32_16x16x32_bf16 v[68:71], v[28:31], v[44:47], v[68:71]
    ds_read_b64_tr_b16 v[36:37], v12 offset:22784
    ds_read_b64_tr_b16 v[38:39], v12 offset:24192
    v_mfma_f32_16x16x32_bf16 v[72:75], v[28:31], v[48:51], v[72:75]
    ds_read_b128 v[60:63], v13 offset:32768
    v_mfma_f32_16x16x32_bf16 v[84:87], v[28:31], v[52:55], v[84:87]
    ds_read_b128 v[64:67], v13 offset:34816
    v_mfma_f32_16x16x32_bf16 v[88:91], v[28:31], v[56:59], v[88:91]
    ds_read_b64_tr_b16 v[40:41], v12 offset:22816
    v_mfma_f32_16x16x32_bf16 v[120:123], v[32:35], v[56:59], v[120:123]
    ds_read_b64_tr_b16 v[42:43], v12 offset:24224
    ds_read_b32 v15, v17 offset:68
    v_mfma_f32_16x16x32_bf16 v[116:119], v[32:35], v[52:55], v[116:119]
    s_add_u32 m0, s61, 77184
    v_mfma_f32_16x16x32_bf16 v[104:107], v[32:35], v[48:51], v[104:107]
    v_mfma_f32_16x16x32_bf16 v[100:103], v[32:35], v[44:47], v[100:103]
    s_waitcnt lgkmcnt(0)
    v_cmp_ne_u32 vcc, s62, v15
    s_cbranch_vccnz L_f_sp2_16
L_f_sb2_16:
    buffer_load_dwordx4 v164, s[40:43], s63 offen offset:0 lds
    buffer_load_dwordx4 v165, s[40:43], s63 offen offset:1024 lds
    buffer_load_dwordx4 v166, s[40:43], s63 offen offset:2048 lds
    s_add_u32 s63, s63, 88064
    s_waitcnt vmcnt(6) lgkmcnt(0)
    ds_write_b8 v16, v14 offset:72
    s_bitcmp1_b32 s2, 3
    s_cbranch_scc0 L_f_np2_16
    buffer_load_dword v167, v18, s[44:47], s64 offen
    s_add_u32 s64, s64, 8192
L_f_np2_16:
    v_mfma_f32_16x16x32_bf16 v[76:79], v[36:39], v[44:47], v[76:79]
    ds_read_b64_tr_b16 v[28:29], v12 offset:34176
    ds_read_b64_tr_b16 v[30:31], v12 offset:35584
    v_mfma_f32_16x16x32_bf16 v[80:83], v[36:39], v[48:51], v[80:83]
    ds_read_b128 v[8:11], v13 offset:36864
    v_mfma_f32_16x16x32_bf16 v[92:95], v[36:39], v[52:55], v[92:95]
    ds_read_b128 v[20:23], v13 offset:38912
    v_mfma_f32_16x16x32_bf16 v[96:99], v[36:39], v[56:59], v[96:99]
    ds_read_b64_tr_b16 v[32:33], v12 offset:34208
    v_mfma_f32_16x16x32_bf16 v[128:131], v[40:43], v[56:59], v[128:131]
    ds_read_b64_tr_b16 v[34:35], v12 offset:35616
    ds_read_b32 v15, v17 offset:72
    v_mfma_f32_16x16x32_bf16 v[124:127], v[40:43], v[52:55], v[124:127]
    s_add_u32 m0, s61, 88576
    v_mfma_f32_16x16x32_bf16 v[112:115], v[40:43], v[48:51], v[112:115]
    v_mfma_f32_16x16x32_bf16 v[108:111], v[40:43], v[44:47], v[108:111]
    s_waitcnt lgkmcnt(0)
    v_cmp_ne_u32 vcc, s62, v15
    s_cbranch_vccnz L_f_sp2_17
L_f_sb2_17:
    buffer_load_dwordx4 v164, s[36:39], s63 offen offset:0 lds
    buffer_load_dwordx4 v165, s[36:39], s63 offen offset:1024 lds
    buffer_load_dwordx4 v166, s[36:39], s63 offen offset:2048 lds
    s_waitcnt vmcnt(6) lgkmcnt(0)
    ds_write_b8 v16, v14 offset:76
    v_mfma_f32_16x16x32_bf16 v[68:71], v[28:31], v[60:63], v[68:71]
    ds_read_b64_tr_b16 v[36:37], v12 offset:45568
    ds_read_b64_tr_b16 v[38:39], v12 offset:46976
    v_mfma_f32_16x16x32_bf16 v[72:75], v[28:31], v[64:67], v[72:75]
    ds_read_b128 v[44:47], v3 offset:40960
    v_mfma_f32_16x16x32_bf16 v[84:87], v[28:31], v[8:11], v[84:87]
    ds_read_b128 v[48:51], v3 offset:43008
    v_mfma_f32_16x16x32_bf16 v[88:91], v[28:31], v[20:23], v[88:91]
    ds_read_b64_tr_b16 v[40:41], v12 offset:45600
    v_mfma_f32_16x16x32_bf16 v[120:123], v[32:35], v[20:23], v[120:123]
    ds_read_b64_tr_b16 v[42:43], v12 offset:47008
    ds_read_b32 v15, v17 offset:76
    v_mfma_f32_16x16x32_bf16 v[116:119], v[32:35], v[8:11], v[116:119]
    s_add_u32 m0, s61, 99968
    v_mfma_f32_16x16x32_bf16 v[104:107], v[32:35], v[64:67], v[104:107]
    v_mfma_f32_16x16x32_bf16 v[100:103], v[32:35], v[60:63], v[100:103]
    s_waitcnt lgkmcnt(0)
    v_cmp_ne_u32 vcc, s62, v15
    s_cbranch_vccnz L_f_sp2_18
L_f_sb2_18:
    buffer_load_dwordx4 v164, s[40:43], s63 offen offset:0 lds
    buffer_load_dwordx4 v165, s[40:43], s63 offen offset:1024 lds
    buffer_load_dwordx4 v166, s[40:43], s63 offen offset:2048 lds
    s_add_u32 s63, s63, 88064
    s_waitcnt vmcnt(6) lgkmcnt(0)
    ds_write_b8 v16, v14 offset:80
    v_mfma_f32_16x16x32_bf16 v[76:79], v[36:39], v[60:63], v[76:79]
    ds_read_b64_tr_b16 v[28:29], v12 offset:0
    ds_read_b64_tr_b16 v[30:31], v12 offset:1408
    v_mfma_f32_16x16x32_bf16 v[80:83], v[36:39], v[64:67], v[80:83]
    ds_read_b128 v[52:55], v3 offset:45056
    v_mfma_f32_16x16x32_bf16 v[92:95], v[36:39], v[8:11], v[92:95]
    ds_read_b128 v[56:59], v3 offset:47104
    v_mfma_f32_16x16x32_bf16 v[96:99], v[36:39], v[20:23], v[96:99]
    ds_read_b64_tr_b16 v[32:33], v12 offset:32
    v_mfma_f32_16x16x32_bf16 v[128:131], v[40:43], v[20:23], v[128:131]
    ds_read_b64_tr_b16 v[34:35], v12 offset:1440
    ds_read_b32 v15, v17 offset:80
    v_mfma_f32_16x16x32_bf16 v[124:127], v[40:43], v[8:11], v[124:127]
    s_add_u32 m0, s61, 111360
    v_mfma_f32_16x16x32_bf16 v[112:115], v[40:43], v[64:67], v[112:115]
    v_mfma_f32_16x16x32_bf16 v[108:111], v[40:43], v[60:63], v[108:111]
    s_waitcnt lgkmcnt(0)
    v_cmp_ne_u32 vcc, s62, v15
    s_cbranch_vccnz L_f_sp2_19
L_f_sb2_19:
    buffer_load_dwordx4 v164, s[36:39], s63 offen offset:0 lds
    buffer_load_dwordx4 v165, s[36:39], s63 offen offset:1024 lds
    buffer_load_dwordx4 v166, s[36:39], s63 offen offset:2048 lds
    s_waitcnt vmcnt(6) lgkmcnt(0)
    ds_write_b8 v16, v14 offset:84
    v_mfma_f32_16x16x32_bf16 v[68:71], v[28:31], v[44:47], v[68:71]
    ds_read_b64_tr_b16 v[36:37], v12 offset:11392
    ds_read_b64_tr_b16 v[38:39], v12 offset:12800
    v_mfma_f32_16x16x32_bf16 v[72:75], v[28:31], v[48:51], v[72:75]
    ds_read_b128 v[60:63], v13 offset:40960
    v_mfma_f32_16x16x32_bf16 v[84:87], v[28:31], v[52:55], v[84:87]
    ds_read_b128 v[64:67], v13 offset:43008
    v_mfma_f32_16x16x32_bf16 v[88:91], v[28:31], v[56:59], v[88:91]
    ds_read_b64_tr_b16 v[40:41], v12 offset:11424
    v_mfma_f32_16x16x32_bf16 v[120:123], v[32:35], v[56:59], v[120:123]
    ds_read_b64_tr_b16 v[42:43], v12 offset:12832
    ds_read_b32 v15, v17 offset:84
    v_mfma_f32_16x16x32_bf16 v[116:119], v[32:35], v[52:55], v[116:119]
    s_add_u32 m0, s61, 65792
    v_mfma_f32_16x16x32_bf16 v[104:107], v[32:35], v[48:51], v[104:107]
    v_mfma_f32_16x16x32_bf16 v[100:103], v[32:35], v[44:47], v[100:103]
    s_waitcnt lgkmcnt(0)
    v_cmp_ne_u32 vcc, s62, v15
    s_cbranch_vccnz L_f_sp2_20
L_f_sb2_20:
    buffer_load_dwordx4 v164, s[40:43], s63 offen offset:0 lds
    buffer_load_dwordx4 v165, s[40:43], s63 offen offset:1024 lds
    buffer_load_dwordx4 v166, s[40:43], s63 offen offset:2048 lds
    s_add_u32 s63, s63, 88064
    s_waitcnt vmcnt(6) lgkmcnt(0)
    ds_write_b8 v16, v14 offset:88
    s_bitcmp1_b32 s2, 3
    s_cbranch_scc1 L_f_np2_20
    s_mov_b64 exec, 0x3fffff
    buffer_load_dword v167, v18, s[44:47], s64 offen
    s_mov_b32 exec_lo, -1
    buffer_load_dword v167, v18, s[48:51], s65 offen
    s_mov_b32 exec_hi, -1
L_f_np2_20:
    v_mfma_f32_16x16x32_bf16 v[76:79], v[36:39], v[44:47], v[76:79]
    ds_read_b64_tr_b16 v[28:29], v12 offset:22784
    ds_read_b64_tr_b16 v[30:31], v12 offset:24192
    v_mfma_f32_16x16x32_bf16 v[80:83], v[36:39], v[48:51], v[80:83]
    ds_read_b128 v[8:11], v13 offset:45056
    v_mfma_f32_16x16x32_bf16 v[92:95], v[36:39], v[52:55], v[92:95]
    ds_read_b128 v[20:23], v13 offset:47104
    v_mfma_f32_16x16x32_bf16 v[96:99], v[36:39], v[56:59], v[96:99]
    ds_read_b64_tr_b16 v[32:33], v12 offset:22816
    v_mfma_f32_16x16x32_bf16 v[128:131], v[40:43], v[56:59], v[128:131]
    ds_read_b64_tr_b16 v[34:35], v12 offset:24224
    ds_read_b32 v15, v17 offset:88
    v_mfma_f32_16x16x32_bf16 v[124:127], v[40:43], v[52:55], v[124:127]
    s_add_u32 m0, s61, 77184
    v_mfma_f32_16x16x32_bf16 v[112:115], v[40:43], v[48:51], v[112:115]
    v_mfma_f32_16x16x32_bf16 v[108:111], v[40:43], v[44:47], v[108:111]
    s_waitcnt lgkmcnt(0)
    v_cmp_ne_u32 vcc, s62, v15
    s_cbranch_vccnz L_f_sp2_21
L_f_sb2_21:
    buffer_load_dwordx4 v164, s[36:39], s63 offen offset:0 lds
    buffer_load_dwordx4 v165, s[36:39], s63 offen offset:1024 lds
    buffer_load_dwordx4 v166, s[36:39], s63 offen offset:2048 lds
    s_waitcnt vmcnt(6) lgkmcnt(0)
    ds_write_b8 v16, v14 offset:92
    v_mfma_f32_16x16x32_bf16 v[68:71], v[28:31], v[60:63], v[68:71]
    ds_read_b64_tr_b16 v[36:37], v12 offset:34176
    ds_read_b64_tr_b16 v[38:39], v12 offset:35584
    v_mfma_f32_16x16x32_bf16 v[72:75], v[28:31], v[64:67], v[72:75]
    ds_read_b128 v[44:47], v3 offset:49152
    v_mfma_f32_16x16x32_bf16 v[84:87], v[28:31], v[8:11], v[84:87]
    ds_read_b128 v[48:51], v3 offset:51200
    v_mfma_f32_16x16x32_bf16 v[88:91], v[28:31], v[20:23], v[88:91]
    ds_read_b64_tr_b16 v[40:41], v12 offset:34208
    v_mfma_f32_16x16x32_bf16 v[120:123], v[32:35], v[20:23], v[120:123]
    ds_read_b64_tr_b16 v[42:43], v12 offset:35616
    ds_read_b32 v15, v17 offset:92
    v_mfma_f32_16x16x32_bf16 v[116:119], v[32:35], v[8:11], v[116:119]
    s_add_u32 m0, s61, 88576
    v_mfma_f32_16x16x32_bf16 v[104:107], v[32:35], v[64:67], v[104:107]
    v_mfma_f32_16x16x32_bf16 v[100:103], v[32:35], v[60:63], v[100:103]
    s_waitcnt lgkmcnt(0)
    v_cmp_ne_u32 vcc, s62, v15
    s_cbranch_vccnz L_f_sp2_22
L_f_sb2_22:
    buffer_load_dwordx4 v164, s[40:43], s63 offen offset:0 lds
    buffer_load_dwordx4 v165, s[40:43], s63 offen offset:1024 lds
    buffer_load_dwordx4 v166, s[40:43], s63 offen offset:2048 lds
    s_add_u32 s63, s63, 88064
    s_waitcnt vmcnt(6) lgkmcnt(0)
    ds_write_b8 v16, v14 offset:96
    v_mfma_f32_16x16x32_bf16 v[76:79], v[36:39], v[60:63], v[76:79]
    ds_read_b64_tr_b16 v[28:29], v12 offset:45568
    ds_read_b64_tr_b16 v[30:31], v12 offset:46976
    v_mfma_f32_16x16x32_bf16 v[80:83], v[36:39], v[64:67], v[80:83]
    ds_read_b128 v[52:55], v3 offset:53248
    v_mfma_f32_16x16x32_bf16 v[92:95], v[36:39], v[8:11], v[92:95]
    ds_read_b128 v[56:59], v3 offset:55296
    v_mfma_f32_16x16x32_bf16 v[96:99], v[36:39], v[20:23], v[96:99]
    ds_read_b64_tr_b16 v[32:33], v12 offset:45600
    v_mfma_f32_16x16x32_bf16 v[128:131], v[40:43], v[20:23], v[128:131]
    ds_read_b64_tr_b16 v[34:35], v12 offset:47008
    ds_read_b32 v15, v17 offset:96
    v_mfma_f32_16x16x32_bf16 v[124:127], v[40:43], v[8:11], v[124:127]
    s_add_u32 m0, s61, 99968
    v_mfma_f32_16x16x32_bf16 v[112:115], v[40:43], v[64:67], v[112:115]
    v_mfma_f32_16x16x32_bf16 v[108:111], v[40:43], v[60:63], v[108:111]
    s_waitcnt lgkmcnt(0)
    v_cmp_ne_u32 vcc, s62, v15
    s_cbranch_vccnz L_f_sp2_23
L_f_sb2_23:
    buffer_load_dwordx4 v164, s[36:39], s63 offen offset:0 lds
    buffer_load_dwordx4 v165, s[36:39], s63 offen offset:1024 lds
    buffer_load_dwordx4 v166, s[36:39], s63 offen offset:2048 lds
    s_waitcnt vmcnt(6) lgkmcnt(0)
    ds_write_b8 v16, v14 offset:100
    v_mfma_f32_16x16x32_bf16 v[68:71], v[28:31], v[44:47], v[68:71]
    ds_read_b64_tr_b16 v[36:37], v12 offset:0
    ds_read_b64_tr_b16 v[38:39], v12 offset:1408
    v_mfma_f32_16x16x32_bf16 v[72:75], v[28:31], v[48:51], v[72:75]
    ds_read_b128 v[60:63], v13 offset:49152
    v_mfma_f32_16x16x32_bf16 v[84:87], v[28:31], v[52:55], v[84:87]
    ds_read_b128 v[64:67], v13 offset:51200
    v_mfma_f32_16x16x32_bf16 v[88:91], v[28:31], v[56:59], v[88:91]
    ds_read_b64_tr_b16 v[40:41], v12 offset:32
    v_mfma_f32_16x16x32_bf16 v[120:123], v[32:35], v[56:59], v[120:123]
    ds_read_b64_tr_b16 v[42:43], v12 offset:1440
    ds_read_b32 v15, v17 offset:100
    v_mfma_f32_16x16x32_bf16 v[116:119], v[32:35], v[52:55], v[116:119]
    s_add_u32 m0, s61, 111360
    v_mfma_f32_16x16x32_bf16 v[104:107], v[32:35], v[48:51], v[104:107]
    v_mfma_f32_16x16x32_bf16 v[100:103], v[32:35], v[44:47], v[100:103]
    s_waitcnt lgkmcnt(0)
    v_cmp_ne_u32 vcc, s62, v15
    s_cbranch_vccnz L_f_sp2_24
L_f_sb2_24:
    buffer_load_dwordx4 v164, s[40:43], s63 offen offset:0 lds
    buffer_load_dwordx4 v165, s[40:43], s63 offen offset:1024 lds
    buffer_load_dwordx4 v166, s[40:43], s63 offen offset:2048 lds
    s_add_u32 s63, s63, 88064
    s_waitcnt vmcnt(6) lgkmcnt(0)
    ds_write_b8 v16, v14 offset:104
    s_bitcmp1_b32 s2, 3
    s_cbranch_scc0 L_f_np2_24
    s_mov_b64 exec, 0x3fffff
    buffer_load_dword v167, v18, s[44:47], s64 offen
    s_mov_b32 exec_lo, -1
    buffer_load_dword v167, v18, s[48:51], s65 offen
    s_mov_b32 exec_hi, -1
L_f_np2_24:
    v_mfma_f32_16x16x32_bf16 v[76:79], v[36:39], v[44:47], v[76:79]
    ds_read_b64_tr_b16 v[28:29], v12 offset:11392
    ds_read_b64_tr_b16 v[30:31], v12 offset:12800
    v_mfma_f32_16x16x32_bf16 v[80:83], v[36:39], v[48:51], v[80:83]
    ds_read_b128 v[8:11], v13 offset:53248
    v_mfma_f32_16x16x32_bf16 v[92:95], v[36:39], v[52:55], v[92:95]
    ds_read_b128 v[20:23], v13 offset:55296
    v_mfma_f32_16x16x32_bf16 v[96:99], v[36:39], v[56:59], v[96:99]
    ds_read_b64_tr_b16 v[32:33], v12 offset:11424
    v_mfma_f32_16x16x32_bf16 v[128:131], v[40:43], v[56:59], v[128:131]
    ds_read_b64_tr_b16 v[34:35], v12 offset:12832
    ds_read_b32 v15, v17 offset:104
    v_mfma_f32_16x16x32_bf16 v[124:127], v[40:43], v[52:55], v[124:127]
    s_add_u32 m0, s61, 65792
    v_mfma_f32_16x16x32_bf16 v[112:115], v[40:43], v[48:51], v[112:115]
    v_mfma_f32_16x16x32_bf16 v[108:111], v[40:43], v[44:47], v[108:111]
    s_waitcnt lgkmcnt(0)
    v_cmp_ne_u32 vcc, s62, v15
    s_cbranch_vccnz L_f_sp2_25
L_f_sb2_25:
    buffer_load_dwordx4 v164, s[36:39], s63 offen offset:0 lds
    buffer_load_dwordx4 v165, s[36:39], s63 offen offset:1024 lds
    buffer_load_dwordx4 v166, s[36:39], s63 offen offset:2048 lds
    s_waitcnt vmcnt(6) lgkmcnt(0)
    ds_write_b8 v16, v14 offset:108
    v_mfma_f32_16x16x32_bf16 v[68:71], v[28:31], v[60:63], v[68:71]
    ds_read_b64_tr_b16 v[36:37], v12 offset:22784
    ds_read_b64_tr_b16 v[38:39], v12 offset:24192
    v_mfma_f32_16x16x32_bf16 v[72:75], v[28:31], v[64:67], v[72:75]
    ds_read_b128 v[44:47], v3 offset:57344
    v_mfma_f32_16x16x32_bf16 v[84:87], v[28:31], v[8:11], v[84:87]
    ds_read_b128 v[48:51], v3 offset:59392
    v_mfma_f32_16x16x32_bf16 v[88:91], v[28:31], v[20:23], v[88:91]
    ds_read_b64_tr_b16 v[40:41], v12 offset:22816
    v_mfma_f32_16x16x32_bf16 v[120:123], v[32:35], v[20:23], v[120:123]
    ds_read_b64_tr_b16 v[42:43], v12 offset:24224
    ds_read_b32 v15, v17 offset:108
    v_mfma_f32_16x16x32_bf16 v[116:119], v[32:35], v[8:11], v[116:119]
    s_add_u32 m0, s61, 77184
    v_mfma_f32_16x16x32_bf16 v[104:107], v[32:35], v[64:67], v[104:107]
    v_mfma_f32_16x16x32_bf16 v[100:103], v[32:35], v[60:63], v[100:103]
    s_waitcnt lgkmcnt(0)
    v_cmp_ne_u32 vcc, s62, v15
    s_cbranch_vccnz L_f_sp2_26
L_f_sb2_26:
    buffer_load_dwordx4 v164, s[40:43], s63 offen offset:0 lds
    buffer_load_dwordx4 v165, s[40:43], s63 offen offset:1024 lds
    buffer_load_dwordx4 v166, s[40:43], s63 offen offset:2048 lds
    s_waitcnt vmcnt(6) lgkmcnt(0)
    ds_write_b8 v16, v14 offset:112
    v_mfma_f32_16x16x32_bf16 v[76:79], v[36:39], v[60:63], v[76:79]
    ds_read_b64_tr_b16 v[28:29], v12 offset:34176
    ds_read_b64_tr_b16 v[30:31], v12 offset:35584
    v_mfma_f32_16x16x32_bf16 v[80:83], v[36:39], v[64:67], v[80:83]
    ds_read_b128 v[52:55], v3 offset:61440
    v_mfma_f32_16x16x32_bf16 v[92:95], v[36:39], v[8:11], v[92:95]
    ds_read_b128 v[56:59], v3 offset:63488
    v_mfma_f32_16x16x32_bf16 v[96:99], v[36:39], v[20:23], v[96:99]
    ds_read_b64_tr_b16 v[32:33], v12 offset:34208
    v_mfma_f32_16x16x32_bf16 v[128:131], v[40:43], v[20:23], v[128:131]
    ds_read_b64_tr_b16 v[34:35], v12 offset:35616
    ds_read_b32 v15, v17 offset:112
    v_mfma_f32_16x16x32_bf16 v[124:127], v[40:43], v[8:11], v[124:127]
    s_add_u32 m0, s15, 0
    s_nop 0
    buffer_load_dwordx4 v4, s[44:47], s72 offen lds
    buffer_load_dwordx4 v5, s[44:47], s72 offen offset:1024 lds
    s_add_u32 s72, s72, 16384
    s_cmp_eq_u32 s72, s13
    s_cselect_b32 s72, s12, s72
    v_mfma_f32_16x16x32_bf16 v[112:115], v[40:43], v[64:67], v[112:115]
    v_mfma_f32_16x16x32_bf16 v[108:111], v[40:43], v[60:63], v[108:111]
    s_waitcnt lgkmcnt(0)
    v_cmp_ne_u32 vcc, s62, v15
    s_cbranch_vccnz L_f_sp2_27
L_f_sb2_27:
    s_waitcnt vmcnt(5) lgkmcnt(0)
    ds_write_b8 v16, v14 offset:116
    v_mfma_f32_16x16x32_bf16 v[68:71], v[28:31], v[44:47], v[68:71]
    ds_read_b64_tr_b16 v[36:37], v12 offset:45568
    ds_read_b64_tr_b16 v[38:39], v12 offset:46976
    v_mfma_f32_16x16x32_bf16 v[72:75], v[28:31], v[48:51], v[72:75]
    ds_read_b128 v[60:63], v13 offset:57344
    v_mfma_f32_16x16x32_bf16 v[84:87], v[28:31], v[52:55], v[84:87]
    ds_read_b128 v[64:67], v13 offset:59392
    v_mfma_f32_16x16x32_bf16 v[88:91], v[28:31], v[56:59], v[88:91]
    ds_read_b64_tr_b16 v[40:41], v12 offset:45600
    v_mfma_f32_16x16x32_bf16 v[120:123], v[32:35], v[56:59], v[120:123]
    ds_read_b64_tr_b16 v[42:43], v12 offset:47008
    ds_read_b32 v15, v17 offset:116
    v_mfma_f32_16x16x32_bf16 v[116:119], v[32:35], v[52:55], v[116:119]
    s_add_u32 m0, s15, 8192
    s_nop 0
    buffer_load_dwordx4 v4, s[44:47], s72 offen lds
    buffer_load_dwordx4 v5, s[44:47], s72 offen offset:1024 lds
    s_add_u32 s72, s72, 16384
    s_cmp_eq_u32 s72, s13
    s_cselect_b32 s72, s12, s72
    v_mfma_f32_16x16x32_bf16 v[104:107], v[32:35], v[48:51], v[104:107]
    v_mfma_f32_16x16x32_bf16 v[100:103], v[32:35], v[44:47], v[100:103]
    s_add_u32 m0, s15, 16384
    s_nop 0
    buffer_load_dwordx4 v4, s[44:47], s72 offen lds
    buffer_load_dwordx4 v5, s[44:47], s72 offen offset:1024 lds
    s_add_u32 s72, s72, 16384
    s_cmp_eq_u32 s72, s13
    s_cselect_b32 s72, s12, s72
    s_waitcnt lgkmcnt(0)
    v_cmp_ne_u32 vcc, s62, v15
    s_cbranch_vccnz L_f_sp2_28
L_f_sb2_28:
    s_waitcnt vmcnt(6) lgkmcnt(0)
    ds_write_b8 v16, v14 offset:120
    v_mfma_f32_16x16x32_bf16 v[76:79], v[36:39], v[44:47], v[76:79]
    ds_read_b64_tr_b16 v[28:29], v12 offset:0
    ds_read_b64_tr_b16 v[30:31], v12 offset:1408
    v_mfma_f32_16x16x32_bf16 v[80:83], v[36:39], v[48:51], v[80:83]
    ds_read_b128 v[8:11], v13 offset:61440
    v_mfma_f32_16x16x32_bf16 v[92:95], v[36:39], v[52:55], v[92:95]
    ds_read_b128 v[20:23], v13 offset:63488
    v_mfma_f32_16x16x32_bf16 v[96:99], v[36:39], v[56:59], v[96:99]
    ds_read_b64_tr_b16 v[32:33], v12 offset:32
    v_mfma_f32_16x16x32_bf16 v[128:131], v[40:43], v[56:59], v[128:131]
    ds_read_b64_tr_b16 v[34:35], v12 offset:1440
    ds_read_b32 v15, v17 offset:120
    v_mfma_f32_16x16x32_bf16 v[124:127], v[40:43], v[52:55], v[124:127]
    s_add_u32 m0, s15, 24576
    s_nop 0
    buffer_load_dwordx4 v4, s[44:47], s72 offen lds
    buffer_load_dwordx4 v5, s[44:47], s72 offen offset:1024 lds
    s_add_u32 s72, s72, 16384
    s_cmp_eq_u32 s72, s13
    s_cselect_b32 s72, s12, s72
    v_mfma_f32_16x16x32_bf16 v[112:115], v[40:43], v[48:51], v[112:115]
    v_mfma_f32_16x16x32_bf16 v[108:111], v[40:43], v[44:47], v[108:111]
    s_add_u32 m0, s15, 32768
    s_nop 0
    buffer_load_dwordx4 v4, s[44:47], s72 offen lds
    buffer_load_dwordx4 v5, s[44:47], s72 offen offset:1024 lds
    s_add_u32 s72, s72, 16384
    s_cmp_eq_u32 s72, s13
    s_cselect_b32 s72, s12, s72
    s_waitcnt lgkmcnt(0)
    v_cmp_ne_u32 vcc, s62, v15
    s_cbranch_vccnz L_f_sp2_29
L_f_sb2_29:
    s_waitcnt vmcnt(10) lgkmcnt(0)
    ds_write_b8 v16, v14 offset:124
    v_mfma_f32_16x16x32_bf16 v[68:71], v[28:31], v[60:63], v[68:71]
    ds_read_b64_tr_b16 v[36:37], v12 offset:11392
    ds_read_b64_tr_b16 v[38:39], v12 offset:12800
    v_mfma_f32_16x16x32_bf16 v[72:75], v[28:31], v[64:67], v[72:75]
    v_mfma_f32_16x16x32_bf16 v[84:87], v[28:31], v[8:11], v[84:87]
    v_mfma_f32_16x16x32_bf16 v[88:91], v[28:31], v[20:23], v[88:91]
    ds_read_b64_tr_b16 v[40:41], v12 offset:11424
    v_mfma_f32_16x16x32_bf16 v[120:123], v[32:35], v[20:23], v[120:123]
    ds_read_b64_tr_b16 v[42:43], v12 offset:12832
    ds_read_b32 v15, v17 offset:124
    v_mfma_f32_16x16x32_bf16 v[116:119], v[32:35], v[8:11], v[116:119]
    s_add_u32 m0, s15, 40960
    s_nop 0
    buffer_load_dwordx4 v4, s[44:47], s72 offen lds
    buffer_load_dwordx4 v5, s[44:47], s72 offen offset:1024 lds
    s_add_u32 s72, s72, 16384
    s_cmp_eq_u32 s72, s13
    s_cselect_b32 s72, s12, s72
    v_mfma_f32_16x16x32_bf16 v[104:107], v[32:35], v[64:67], v[104:107]
    v_mfma_f32_16x16x32_bf16 v[100:103], v[32:35], v[60:63], v[100:103]
    s_waitcnt lgkmcnt(0)
    v_cmp_ne_u32 vcc, s62, v15
    s_cbranch_vccnz L_f_sp2_30
L_f_sb2_30:
    s_waitcnt vmcnt(12) lgkmcnt(0)
    ds_write_b8 v16, v14 offset:128
    v_mfma_f32_16x16x32_bf16 v[76:79], v[36:39], v[60:63], v[76:79]
    v_mfma_f32_16x16x32_bf16 v[80:83], v[36:39], v[64:67], v[80:83]
    v_mfma_f32_16x16x32_bf16 v[92:95], v[36:39], v[8:11], v[92:95]
    v_mfma_f32_16x16x32_bf16 v[96:99], v[36:39], v[20:23], v[96:99]
    v_mfma_f32_16x16x32_bf16 v[128:131], v[40:43], v[20:23], v[128:131]
    ds_read_b32 v15, v17 offset:128
    v_mfma_f32_16x16x32_bf16 v[124:127], v[40:43], v[8:11], v[124:127]
    s_add_u32 m0, s15, 49152
    s_nop 0
    buffer_load_dwordx4 v4, s[44:47], s72 offen lds
    buffer_load_dwordx4 v5, s[44:47], s72 offen offset:1024 lds
    s_add_u32 s72, s72, 16384
    s_cmp_eq_u32 s72, s13
    s_cselect_b32 s72, s12, s72
    v_mfma_f32_16x16x32_bf16 v[112:115], v[40:43], v[64:67], v[112:115]
    v_mfma_f32_16x16x32_bf16 v[108:111], v[40:43], v[60:63], v[108:111]
    s_waitcnt lgkmcnt(0)
    v_cmp_ne_u32 vcc, s62, v15
    s_cbranch_vccnz L_f_sp2_31
L_f_sb2_31:
    s_branch L_f_done
L_f_sp3_0:
    ds_read_b32 v15, v17 offset:4
    s_waitcnt lgkmcnt(0)
    v_cmp_ne_u32 vcc, s62, v15
    s_cbranch_vccnz L_f_sp3_0
    s_branch L_f_sb3_0
L_f_sp3_1:
    ds_read_b32 v15, v17 offset:8
    s_waitcnt lgkmcnt(0)
    v_cmp_ne_u32 vcc, s62, v15
    s_cbranch_vccnz L_f_sp3_1
    s_branch L_f_sb3_1
L_f_sp3_2:
    ds_read_b32 v15, v17 offset:12
    s_waitcnt lgkmcnt(0)
    v_cmp_ne_u32 vcc, s62, v15
    s_cbranch_vccnz L_f_sp3_2
    s_branch L_f_sb3_2
L_f_sp3_3:
    ds_read_b32 v15, v17 offset:16
    s_waitcnt lgkmcnt(0)
    v_cmp_ne_u32 vcc, s62, v15
    s_cbranch_vccnz L_f_sp3_3
    s_branch L_f_sb3_3
L_f_sp3_4:
    ds_read_b32 v15, v17 offset:20
    s_waitcnt lgkmcnt(0)
    v_cmp_ne_u32 vcc, s62, v15
    s_cbranch_vccnz L_f_sp3_4
    s_branch L_f_sb3_4
L_f_sp3_5:
    ds_read_b32 v15, v17 offset:24
    s_waitcnt lgkmcnt(0)
    v_cmp_ne_u32 vcc, s62, v15
    s_cbranch_vccnz L_f_sp3_5
    s_branch L_f_sb3_5
L_f_sp3_6:
    ds_read_b32 v15, v17 offset:28
    s_waitcnt lgkmcnt(0)
    v_cmp_ne_u32 vcc, s62, v15
    s_cbranch_vccnz L_f_sp3_6
    s_branch L_f_sb3_6
L_f_sp3_7:
    ds_read_b32 v15, v17 offset:32
    s_waitcnt lgkmcnt(0)
    v_cmp_ne_u32 vcc, s62, v15
    s_cbranch_vccnz L_f_sp3_7
    s_branch L_f_sb3_7
L_f_sp3_8:
    ds_read_b32 v15, v17 offset:36
    s_waitcnt lgkmcnt(0)
    v_cmp_ne_u32 vcc, s62, v15
    s_cbranch_vccnz L_f_sp3_8
    s_branch L_f_sb3_8
L_f_sp3_9:
    ds_read_b32 v15, v17 offset:40
    s_waitcnt lgkmcnt(0)
    v_cmp_ne_u32 vcc, s62, v15
    s_cbranch_vccnz L_f_sp3_9
    s_branch L_f_sb3_9
L_f_sp3_10:
    ds_read_b32 v15, v17 offset:44
    s_waitcnt lgkmcnt(0)
    v_cmp_ne_u32 vcc, s62, v15
    s_cbranch_vccnz L_f_sp3_10
    s_branch L_f_sb3_10
L_f_sp3_11:
    ds_read_b32 v15, v17 offset:48
    s_waitcnt lgkmcnt(0)
    v_cmp_ne_u32 vcc, s62, v15
    s_cbranch_vccnz L_f_sp3_11
    s_branch L_f_sb3_11
L_f_sp3_12:
    ds_read_b32 v15, v17 offset:52
    s_waitcnt lgkmcnt(0)
    v_cmp_ne_u32 vcc, s62, v15
    s_cbranch_vccnz L_f_sp3_12
    s_branch L_f_sb3_12
L_f_sp3_13:
    ds_read_b32 v15, v17 offset:56
    s_waitcnt lgkmcnt(0)
    v_cmp_ne_u32 vcc, s62, v15
    s_cbranch_vccnz L_f_sp3_13
    s_branch L_f_sb3_13
L_f_sp3_14:
    ds_read_b32 v15, v17 offset:60
    s_waitcnt lgkmcnt(0)
    v_cmp_ne_u32 vcc, s62, v15
    s_cbranch_vccnz L_f_sp3_14
    s_branch L_f_sb3_14
L_f_sp3_15:
    ds_read_b32 v15, v17 offset:64
    s_waitcnt lgkmcnt(0)
    v_cmp_ne_u32 vcc, s62, v15
    s_cbranch_vccnz L_f_sp3_15
    s_branch L_f_sb3_15
L_f_sp3_16:
    ds_read_b32 v15, v17 offset:68
    s_waitcnt lgkmcnt(0)
    v_cmp_ne_u32 vcc, s62, v15
    s_cbranch_vccnz L_f_sp3_16
    s_branch L_f_sb3_16
L_f_sp3_17:
    ds_read_b32 v15, v17 offset:72
    s_waitcnt lgkmcnt(0)
    v_cmp_ne_u32 vcc, s62, v15
    s_cbranch_vccnz L_f_sp3_17
    s_branch L_f_sb3_17
L_f_sp3_18:
    ds_read_b32 v15, v17 offset:76
    s_waitcnt lgkmcnt(0)
    v_cmp_ne_u32 vcc, s62, v15
    s_cbranch_vccnz L_f_sp3_18
    s_branch L_f_sb3_18
L_f_sp3_19:
    ds_read_b32 v15, v17 offset:80
    s_waitcnt lgkmcnt(0)
    v_cmp_ne_u32 vcc, s62, v15
    s_cbranch_vccnz L_f_sp3_19
    s_branch L_f_sb3_19
L_f_sp3_20:
    ds_read_b32 v15, v17 offset:84
    s_waitcnt lgkmcnt(0)
    v_cmp_ne_u32 vcc, s62, v15
    s_cbranch_vccnz L_f_sp3_20
    s_branch L_f_sb3_20
L_f_sp3_21:
    ds_read_b32 v15, v17 offset:88
    s_waitcnt lgkmcnt(0)
    v_cmp_ne_u32 vcc, s62, v15
    s_cbranch_vccnz L_f_sp3_21
    s_branch L_f_sb3_21
L_f_sp3_22:
    ds_read_b32 v15, v17 offset:92
    s_waitcnt lgkmcnt(0)
    v_cmp_ne_u32 vcc, s62, v15
    s_cbranch_vccnz L_f_sp3_22
    s_branch L_f_sb3_22
L_f_sp3_23:
    ds_read_b32 v15, v17 offset:96
    s_waitcnt lgkmcnt(0)
    v_cmp_ne_u32 vcc, s62, v15
    s_cbranch_vccnz L_f_sp3_23
    s_branch L_f_sb3_23
L_f_sp3_24:
    ds_read_b32 v15, v17 offset:100
    s_waitcnt lgkmcnt(0)
    v_cmp_ne_u32 vcc, s62, v15
    s_cbranch_vccnz L_f_sp3_24
    s_branch L_f_sb3_24
L_f_sp3_25:
    ds_read_b32 v15, v17 offset:104
    s_waitcnt lgkmcnt(0)
    v_cmp_ne_u32 vcc, s62, v15
    s_cbranch_vccnz L_f_sp3_25
    s_branch L_f_sb3_25
L_f_sp3_26:
    ds_read_b32 v15, v17 offset:108
    s_waitcnt lgkmcnt(0)
    v_cmp_ne_u32 vcc, s62, v15
    s_cbranch_vccnz L_f_sp3_26
    s_branch L_f_sb3_26
L_f_sp3_27:
    ds_read_b32 v15, v17 offset:112
    s_waitcnt lgkmcnt(0)
    v_cmp_ne_u32 vcc, s62, v15
    s_cbranch_vccnz L_f_sp3_27
    s_branch L_f_sb3_27
L_f_sp3_28:
    ds_read_b32 v15, v17 offset:116
    s_waitcnt lgkmcnt(0)
    v_cmp_ne_u32 vcc, s62, v15
    s_cbranch_vccnz L_f_sp3_28
    s_branch L_f_sb3_28
L_f_sp3_29:
    ds_read_b32 v15, v17 offset:120
    s_waitcnt lgkmcnt(0)
    v_cmp_ne_u32 vcc, s62, v15
    s_cbranch_vccnz L_f_sp3_29
    s_branch L_f_sb3_29
L_f_sp3_30:
    ds_read_b32 v15, v17 offset:124
    s_waitcnt lgkmcnt(0)
    v_cmp_ne_u32 vcc, s62, v15
    s_cbranch_vccnz L_f_sp3_30
    s_branch L_f_sb3_30
L_f_sp3_31:
    ds_read_b32 v15, v17 offset:128
    s_waitcnt lgkmcnt(0)
    v_cmp_ne_u32 vcc, s62, v15
    s_cbranch_vccnz L_f_sp3_31
    s_branch L_f_sb3_31
L_f_sp2_0:
    ds_read_b32 v15, v17 offset:4
    s_waitcnt lgkmcnt(0)
    v_cmp_ne_u32 vcc, s62, v15
    s_cbranch_vccnz L_f_sp2_0
    s_branch L_f_sb2_0
L_f_sp2_1:
    ds_read_b32 v15, v17 offset:8
    s_waitcnt lgkmcnt(0)
    v_cmp_ne_u32 vcc, s62, v15
    s_cbranch_vccnz L_f_sp2_1
    s_branch L_f_sb2_1
L_f_sp2_2:
    ds_read_b32 v15, v17 offset:12
    s_waitcnt lgkmcnt(0)
    v_cmp_ne_u32 vcc, s62, v15
    s_cbranch_vccnz L_f_sp2_2
    s_branch L_f_sb2_2
L_f_sp2_3:
    ds_read_b32 v15, v17 offset:16
    s_waitcnt lgkmcnt(0)
    v_cmp_ne_u32 vcc, s62, v15
    s_cbranch_vccnz L_f_sp2_3
    s_branch L_f_sb2_3
L_f_sp2_4:
    ds_read_b32 v15, v17 offset:20
    s_waitcnt lgkmcnt(0)
    v_cmp_ne_u32 vcc, s62, v15
    s_cbranch_vccnz L_f_sp2_4
    s_branch L_f_sb2_4
L_f_sp2_5:
    ds_read_b32 v15, v17 offset:24
    s_waitcnt lgkmcnt(0)
    v_cmp_ne_u32 vcc, s62, v15
    s_cbranch_vccnz L_f_sp2_5
    s_branch L_f_sb2_5
L_f_sp2_6:
    ds_read_b32 v15, v17 offset:28
    s_waitcnt lgkmcnt(0)
    v_cmp_ne_u32 vcc, s62, v15
    s_cbranch_vccnz L_f_sp2_6
    s_branch L_f_sb2_6
L_f_sp2_7:
    ds_read_b32 v15, v17 offset:32
    s_waitcnt lgkmcnt(0)
    v_cmp_ne_u32 vcc, s62, v15
    s_cbranch_vccnz L_f_sp2_7
    s_branch L_f_sb2_7
L_f_sp2_8:
    ds_read_b32 v15, v17 offset:36
    s_waitcnt lgkmcnt(0)
    v_cmp_ne_u32 vcc, s62, v15
    s_cbranch_vccnz L_f_sp2_8
    s_branch L_f_sb2_8
L_f_sp2_9:
    ds_read_b32 v15, v17 offset:40
    s_waitcnt lgkmcnt(0)
    v_cmp_ne_u32 vcc, s62, v15
    s_cbranch_vccnz L_f_sp2_9
    s_branch L_f_sb2_9
L_f_sp2_10:
    ds_read_b32 v15, v17 offset:44
    s_waitcnt lgkmcnt(0)
    v_cmp_ne_u32 vcc, s62, v15
    s_cbranch_vccnz L_f_sp2_10
    s_branch L_f_sb2_10
L_f_sp2_11:
    ds_read_b32 v15, v17 offset:48
    s_waitcnt lgkmcnt(0)
    v_cmp_ne_u32 vcc, s62, v15
    s_cbranch_vccnz L_f_sp2_11
    s_branch L_f_sb2_11
L_f_sp2_12:
    ds_read_b32 v15, v17 offset:52
    s_waitcnt lgkmcnt(0)
    v_cmp_ne_u32 vcc, s62, v15
    s_cbranch_vccnz L_f_sp2_12
    s_branch L_f_sb2_12
L_f_sp2_13:
    ds_read_b32 v15, v17 offset:56
    s_waitcnt lgkmcnt(0)
    v_cmp_ne_u32 vcc, s62, v15
    s_cbranch_vccnz L_f_sp2_13
    s_branch L_f_sb2_13
L_f_sp2_14:
    ds_read_b32 v15, v17 offset:60
    s_waitcnt lgkmcnt(0)
    v_cmp_ne_u32 vcc, s62, v15
    s_cbranch_vccnz L_f_sp2_14
    s_branch L_f_sb2_14
L_f_sp2_15:
    ds_read_b32 v15, v17 offset:64
    s_waitcnt lgkmcnt(0)
    v_cmp_ne_u32 vcc, s62, v15
    s_cbranch_vccnz L_f_sp2_15
    s_branch L_f_sb2_15
L_f_sp2_16:
    ds_read_b32 v15, v17 offset:68
    s_waitcnt lgkmcnt(0)
    v_cmp_ne_u32 vcc, s62, v15
    s_cbranch_vccnz L_f_sp2_16
    s_branch L_f_sb2_16
L_f_sp2_17:
    ds_read_b32 v15, v17 offset:72
    s_waitcnt lgkmcnt(0)
    v_cmp_ne_u32 vcc, s62, v15
    s_cbranch_vccnz L_f_sp2_17
    s_branch L_f_sb2_17
L_f_sp2_18:
    ds_read_b32 v15, v17 offset:76
    s_waitcnt lgkmcnt(0)
    v_cmp_ne_u32 vcc, s62, v15
    s_cbranch_vccnz L_f_sp2_18
    s_branch L_f_sb2_18
L_f_sp2_19:
    ds_read_b32 v15, v17 offset:80
    s_waitcnt lgkmcnt(0)
    v_cmp_ne_u32 vcc, s62, v15
    s_cbranch_vccnz L_f_sp2_19
    s_branch L_f_sb2_19
L_f_sp2_20:
    ds_read_b32 v15, v17 offset:84
    s_waitcnt lgkmcnt(0)
    v_cmp_ne_u32 vcc, s62, v15
    s_cbranch_vccnz L_f_sp2_20
    s_branch L_f_sb2_20
L_f_sp2_21:
    ds_read_b32 v15, v17 offset:88
    s_waitcnt lgkmcnt(0)
    v_cmp_ne_u32 vcc, s62, v15
    s_cbranch_vccnz L_f_sp2_21
    s_branch L_f_sb2_21
L_f_sp2_22:
    ds_read_b32 v15, v17 offset:92
    s_waitcnt lgkmcnt(0)
    v_cmp_ne_u32 vcc, s62, v15
    s_cbranch_vccnz L_f_sp2_22
    s_branch L_f_sb2_22
L_f_sp2_23:
    ds_read_b32 v15, v17 offset:96
    s_waitcnt lgkmcnt(0)
    v_cmp_ne_u32 vcc, s62, v15
    s_cbranch_vccnz L_f_sp2_23
    s_branch L_f_sb2_23
L_f_sp2_24:
    ds_read_b32 v15, v17 offset:100
    s_waitcnt lgkmcnt(0)
    v_cmp_ne_u32 vcc, s62, v15
    s_cbranch_vccnz L_f_sp2_24
    s_branch L_f_sb2_24
L_f_sp2_25:
    ds_read_b32 v15, v17 offset:104
    s_waitcnt lgkmcnt(0)
    v_cmp_ne_u32 vcc, s62, v15
    s_cbranch_vccnz L_f_sp2_25
    s_branch L_f_sb2_25
L_f_sp2_26:
    ds_read_b32 v15, v17 offset:108
    s_waitcnt lgkmcnt(0)
    v_cmp_ne_u32 vcc, s62, v15
    s_cbranch_vccnz L_f_sp2_26
    s_branch L_f_sb2_26
L_f_sp2_27:
    ds_read_b32 v15, v17 offset:112
    s_waitcnt lgkmcnt(0)
    v_cmp_ne_u32 vcc, s62, v15
    s_cbranch_vccnz L_f_sp2_27
    s_branch L_f_sb2_27
L_f_sp2_28:
    ds_read_b32 v15, v17 offset:116
    s_waitcnt lgkmcnt(0)
    v_cmp_ne_u32 vcc, s62, v15
    s_cbranch_vccnz L_f_sp2_28
    s_branch L_f_sb2_28
L_f_sp2_29:
    ds_read_b32 v15, v17 offset:120
    s_waitcnt lgkmcnt(0)
    v_cmp_ne_u32 vcc, s62, v15
    s_cbranch_vccnz L_f_sp2_29
    s_branch L_f_sb2_29
L_f_sp2_30:
    ds_read_b32 v15, v17 offset:124
    s_waitcnt lgkmcnt(0)
    v_cmp_ne_u32 vcc, s62, v15
    s_cbranch_vccnz L_f_sp2_30
    s_branch L_f_sb2_30
L_f_sp2_31:
    ds_read_b32 v15, v17 offset:128
    s_waitcnt lgkmcnt(0)
    v_cmp_ne_u32 vcc, s62, v15
    s_cbranch_vccnz L_f_sp2_31
    s_branch L_f_sb2_31
L_f_done:
    s_setprio 3
    v_add_u32 v10, s15, v19
    v_xor_b32 v11, 64, v10
    s_mul_i32 s8, s17, 120832
    v_add_u32 v3, s8, v2
    s_sub_u32 s8, 120832, s8
    v_add_u32 v9, s8, v2
    s_lshl_b32 s64, s7, 14
    v_and_b32 v164, 31, v1
    v_lshlrev_b32 v164, 10, v164
    v_lshrrev_b32 v165, 5, v1
    v_lshl_add_u32 v8, v165, 4, v164
    buffer_load_dwordx4 v[36:39], v8, s[24:27], s75 offen
    buffer_load_dwordx4 v[40:43], v8, s[24:27], s75 offen offset:32
    s_lshl_b32 s8, s4, 1
    s_mul_i32 s8, s8, 118
    s_add_u32 s8, s8, s60
    s_lshl_b32 s8, s8, 10
    s_add_u32 s8, s8, 8421376
    s_add_u32 s9, s8, 120832
    s_mov_b32 s10, 0xc09d30fc
    s_mov_b32 s11, 0x3e60ec05
    v_fma_f32 v28, -v68, v68, s10
    v_fma_f32 v29, -v69, v69, s10
    v_fma_f32 v30, -v70, v70, s10
    v_fma_f32 v31, -v71, v71, s10
    s_add_u32 m0, s15, 57344
    v_fma_f32 v32, -v72, v72, s10
    buffer_load_dwordx4 v4, s[44:47], s72 offen lds
    v_fma_f32 v33, -v73, v73, s10
    v_fma_f32 v34, -v74, v74, s10
    v_fma_f32 v35, -v75, v75, s10
    v_mul_f32 v28, v28, v68
    buffer_load_dwordx4 v5, s[44:47], s72 offen offset:1024 lds
    s_add_u32 s72, s72, 16384
    s_cmp_eq_u32 s72, s13
    s_cselect_b32 s72, s12, s72
    s_mov_b32 s70, s72
    s_mov_b32 s72, s73
    v_mul_f32 v29, v29, v69
    v_mul_f32 v30, v30, v70
    v_mul_f32 v31, v31, v71
    v_mul_f32 v32, v32, v72
    v_mul_f32 v33, v33, v73
    v_mul_f32 v34, v34, v74
    v_mul_f32 v35, v35, v75
    v_exp_f32 v28, v28
    v_exp_f32 v29, v29
    v_exp_f32 v30, v30
    v_exp_f32 v31, v31
    v_exp_f32 v32, v32
    v_exp_f32 v33, v33
    v_exp_f32 v34, v34
    v_exp_f32 v35, v35
    v_mul_f32 v68, v68, v76
    v_mul_f32 v69, v69, v77
    v_mul_f32 v70, v70, v78
    v_mul_f32 v71, v71, v79
    v_mul_f32 v72, v72, v80
    v_mul_f32 v73, v73, v81
    v_mul_f32 v74, v74, v82
    v_mul_f32 v75, v75, v83
    s_add_u32 m0, s16, 0
    v_fma_f32 v28, v28, s11, s11
    buffer_load_dwordx4 v4, s[44:47], s72 offen lds
    v_fma_f32 v29, v29, s11, s11
    v_fma_f32 v30, v30, s11, s11
    v_fma_f32 v31, v31, s11, s11
    v_fma_f32 v32, v32, s11, s11
    buffer_load_dwordx4 v5, s[44:47], s72 offen offset:1024 lds
    s_add_u32 s72, s72, 16384
    s_cmp_eq_u32 s72, s13
    s_cselect_b32 s72, s12, s72
    v_fma_f32 v33, v33, s11, s11
    v_fma_f32 v34, v34, s11, s11
    v_fma_f32 v35, v35, s11, s11
    v_rcp_f32 v28, v28
    v_rcp_f32 v29, v29
    v_rcp_f32 v30, v30
    v_rcp_f32 v31, v31
    v_rcp_f32 v32, v32
    v_rcp_f32 v33, v33
    v_rcp_f32 v34, v34
    v_rcp_f32 v35, v35
    s_nop 0
    v_mul_f32 v68, v68, v28
    v_mul_f32 v69, v69, v29
    v_mul_f32 v70, v70, v30
    v_mul_f32 v71, v71, v31
    v_mul_f32 v72, v72, v32
    v_mul_f32 v73, v73, v33
    v_mul_f32 v74, v74, v34
    v_mul_f32 v75, v75, v35
    v_cvt_pk_bf16_f32 v76, v68, v69
    v_cvt_pk_bf16_f32 v78, v72, v73
    v_cvt_pk_bf16_f32 v77, v70, v71
    v_cvt_pk_bf16_f32 v79, v74, v75
    s_nop 0
    v_permlane16_swap_b32 v76, v78
    v_permlane16_swap_b32 v77, v79
    s_nop 0
    buffer_store_dwordx4 v[76:79], v2, s[32:35], s8 offen offset:0 sc1
    v_fma_f32 v28, -v84, v84, s10
    v_fma_f32 v29, -v85, v85, s10
    v_fma_f32 v30, -v86, v86, s10
    v_fma_f32 v31, -v87, v87, s10
    s_add_u32 m0, s16, 2048
    v_fma_f32 v32, -v88, v88, s10
    buffer_load_dwordx4 v4, s[44:47], s72 offen lds
    v_fma_f32 v33, -v89, v89, s10
    v_fma_f32 v34, -v90, v90, s10
    v_fma_f32 v35, -v91, v91, s10
    v_mul_f32 v28, v28, v84
    buffer_load_dwordx4 v5, s[44:47], s72 offen offset:1024 lds
    s_add_u32 s72, s72, 16384
    s_cmp_eq_u32 s72, s13
    s_cselect_b32 s72, s12, s72
    v_mul_f32 v29, v29, v85
    v_mul_f32 v30, v30, v86
    v_mul_f32 v31, v31, v87
    v_mul_f32 v32, v32, v88
    v_mul_f32 v33, v33, v89
    v_mul_f32 v34, v34, v90
    v_mul_f32 v35, v35, v91
    v_exp_f32 v28, v28
    v_exp_f32 v29, v29
    v_exp_f32 v30, v30
    v_exp_f32 v31, v31
    v_exp_f32 v32, v32
    v_exp_f32 v33, v33
    v_exp_f32 v34, v34
    v_exp_f32 v35, v35
    v_mul_f32 v84, v84, v92
    v_mul_f32 v85, v85, v93
    v_mul_f32 v86, v86, v94
    v_mul_f32 v87, v87, v95
    v_mul_f32 v88, v88, v96
    v_mul_f32 v89, v89, v97
    v_mul_f32 v90, v90, v98
    v_mul_f32 v91, v91, v99
    s_add_u32 m0, s16, 4096
    v_fma_f32 v28, v28, s11, s11
    buffer_load_dwordx4 v4, s[44:47], s72 offen lds
    v_fma_f32 v29, v29, s11, s11
    v_fma_f32 v30, v30, s11, s11
    v_fma_f32 v31, v31, s11, s11
    v_fma_f32 v32, v32, s11, s11
    buffer_load_dwordx4 v5, s[44:47], s72 offen offset:1024 lds
    s_add_u32 s72, s72, 16384
    s_cmp_eq_u32 s72, s13
    s_cselect_b32 s72, s12, s72
    v_fma_f32 v33, v33, s11, s11
    v_fma_f32 v34, v34, s11, s11
    v_fma_f32 v35, v35, s11, s11
    v_rcp_f32 v28, v28
    v_rcp_f32 v29, v29
    v_rcp_f32 v30, v30
    v_rcp_f32 v31, v31
    v_rcp_f32 v32, v32
    v_rcp_f32 v33, v33
    v_rcp_f32 v34, v34
    v_rcp_f32 v35, v35
    s_nop 0
    v_mul_f32 v84, v84, v28
    v_mul_f32 v85, v85, v29
    v_mul_f32 v86, v86, v30
    v_mul_f32 v87, v87, v31
    v_mul_f32 v88, v88, v32
    v_mul_f32 v89, v89, v33
    v_mul_f32 v90, v90, v34
    v_mul_f32 v91, v91, v35
    v_cvt_pk_bf16_f32 v92, v84, v85
    v_cvt_pk_bf16_f32 v94, v88, v89
    v_cvt_pk_bf16_f32 v93, v86, v87
    v_cvt_pk_bf16_f32 v95, v90, v91
    s_nop 0
    v_permlane16_swap_b32 v92, v94
    v_permlane16_swap_b32 v93, v95
    s_nop 0
    buffer_store_dwordx4 v[92:95], v2, s[32:35], s9 offen offset:0 sc1
    v_fma_f32 v28, -v100, v100, s10
    v_fma_f32 v29, -v101, v101, s10
    v_fma_f32 v30, -v102, v102, s10
    v_fma_f32 v31, -v103, v103, s10
    s_add_u32 m0, s16, 6144
    v_fma_f32 v32, -v104, v104, s10
    buffer_load_dwordx4 v4, s[44:47], s72 offen lds
    v_fma_f32 v33, -v105, v105, s10
    v_fma_f32 v34, -v106, v106, s10
    v_fma_f32 v35, -v107, v107, s10
    v_mul_f32 v28, v28, v100
    buffer_load_dwordx4 v5, s[44:47], s72 offen offset:1024 lds
    s_add_u32 s72, s72, 16384
    s_cmp_eq_u32 s72, s13
    s_cselect_b32 s72, s12, s72
    v_mul_f32 v29, v29, v101
    v_mul_f32 v30, v30, v102
    v_mul_f32 v31, v31, v103
    v_mul_f32 v32, v32, v104
    v_mul_f32 v33, v33, v105
    v_mul_f32 v34, v34, v106
    v_mul_f32 v35, v35, v107
    v_exp_f32 v28, v28
    v_exp_f32 v29, v29
    v_exp_f32 v30, v30
    v_exp_f32 v31, v31
    v_exp_f32 v32, v32
    v_exp_f32 v33, v33
    v_exp_f32 v34, v34
    v_exp_f32 v35, v35
    v_mul_f32 v100, v100, v108
    v_mul_f32 v101, v101, v109
    v_mul_f32 v102, v102, v110
    v_mul_f32 v103, v103, v111
    v_mul_f32 v104, v104, v112
    v_mul_f32 v105, v105, v113
    v_mul_f32 v106, v106, v114
    v_mul_f32 v107, v107, v115
    s_add_u32 m0, s16, 8192
    v_fma_f32 v28, v28, s11, s11
    buffer_load_dwordx4 v4, s[44:47], s72 offen lds
    v_fma_f32 v29, v29, s11, s11
    v_fma_f32 v30, v30, s11, s11
    v_fma_f32 v31, v31, s11, s11
    v_fma_f32 v32, v32, s11, s11
    buffer_load_dwordx4 v5, s[44:47], s72 offen offset:1024 lds
    s_add_u32 s72, s72, 16384
    s_cmp_eq_u32 s72, s13
    s_cselect_b32 s72, s12, s72
    v_fma_f32 v33, v33, s11, s11
    v_fma_f32 v34, v34, s11, s11
    v_fma_f32 v35, v35, s11, s11
    v_rcp_f32 v28, v28
    v_rcp_f32 v29, v29
    v_rcp_f32 v30, v30
    v_rcp_f32 v31, v31
    v_rcp_f32 v32, v32
    v_rcp_f32 v33, v33
    v_rcp_f32 v34, v34
    v_rcp_f32 v35, v35
    s_nop 0
    v_mul_f32 v100, v100, v28
    v_mul_f32 v101, v101, v29
    v_mul_f32 v102, v102, v30
    v_mul_f32 v103, v103, v31
    v_mul_f32 v104, v104, v32
    v_mul_f32 v105, v105, v33
    v_mul_f32 v106, v106, v34
    v_mul_f32 v107, v107, v35
    v_cvt_pk_bf16_f32 v108, v100, v101
    v_cvt_pk_bf16_f32 v110, v104, v105
    v_cvt_pk_bf16_f32 v109, v102, v103
    v_cvt_pk_bf16_f32 v111, v106, v107
    s_nop 0
    v_permlane16_swap_b32 v108, v110
    v_permlane16_swap_b32 v109, v111
    s_nop 0
    buffer_store_dwordx4 v[108:111], v2, s[32:35], s8 offen offset:1024 sc1
    v_fma_f32 v28, -v116, v116, s10
    v_fma_f32 v29, -v117, v117, s10
    v_fma_f32 v30, -v118, v118, s10
    v_fma_f32 v31, -v119, v119, s10
    s_add_u32 m0, s16, 10240
    v_fma_f32 v32, -v120, v120, s10
    buffer_load_dwordx4 v4, s[44:47], s72 offen lds
    v_fma_f32 v33, -v121, v121, s10
    v_fma_f32 v34, -v122, v122, s10
    v_fma_f32 v35, -v123, v123, s10
    v_mul_f32 v28, v28, v116
    buffer_load_dwordx4 v5, s[44:47], s72 offen offset:1024 lds
    s_mov_b32 s72, s70
    v_mul_f32 v29, v29, v117
    v_mul_f32 v30, v30, v118
    v_mul_f32 v31, v31, v119
    v_mul_f32 v32, v32, v120
    v_mul_f32 v33, v33, v121
    v_mul_f32 v34, v34, v122
    v_mul_f32 v35, v35, v123
    v_exp_f32 v28, v28
    v_exp_f32 v29, v29
    v_exp_f32 v30, v30
    v_exp_f32 v31, v31
    v_exp_f32 v32, v32
    v_exp_f32 v33, v33
    v_exp_f32 v34, v34
    v_exp_f32 v35, v35
    v_mul_f32 v116, v116, v124
    v_mul_f32 v117, v117, v125
    v_mul_f32 v118, v118, v126
    v_mul_f32 v119, v119, v127
    v_mul_f32 v120, v120, v128
    v_mul_f32 v121, v121, v129
    v_mul_f32 v122, v122, v130
    v_mul_f32 v123, v123, v131
    v_fma_f32 v28, v28, s11, s11
    v_fma_f32 v29, v29, s11, s11
    v_fma_f32 v30, v30, s11, s11
    v_fma_f32 v31, v31, s11, s11
    v_fma_f32 v32, v32, s11, s11
    v_fma_f32 v33, v33, s11, s11
    v_fma_f32 v34, v34, s11, s11
    v_fma_f32 v35, v35, s11, s11
    v_rcp_f32 v28, v28
    v_rcp_f32 v29, v29
    v_rcp_f32 v30, v30
    v_rcp_f32 v31, v31
    v_rcp_f32 v32, v32
    v_rcp_f32 v33, v33
    v_rcp_f32 v34, v34
    v_rcp_f32 v35, v35
    s_nop 0
    v_mul_f32 v116, v116, v28
    v_mul_f32 v117, v117, v29
    v_mul_f32 v118, v118, v30
    v_mul_f32 v119, v119, v31
    v_mul_f32 v120, v120, v32
    v_mul_f32 v121, v121, v33
    v_mul_f32 v122, v122, v34
    v_mul_f32 v123, v123, v35
    v_cvt_pk_bf16_f32 v124, v116, v117
    v_cvt_pk_bf16_f32 v126, v120, v121
    v_cvt_pk_bf16_f32 v125, v118, v119
    v_cvt_pk_bf16_f32 v127, v122, v123
    s_nop 0
    v_permlane16_swap_b32 v124, v126
    v_permlane16_swap_b32 v125, v127
    s_nop 0
    buffer_store_dwordx4 v[124:127], v2, s[32:35], s9 offen offset:1024 sc1
    s_cmp_eq_u32 s7, 3
    s_cbranch_scc1 L_f_g3
    v_fma_f32 v28, -v132, v132, s10
    v_fma_f32 v29, -v133, v133, s10
    v_fma_f32 v30, -v134, v134, s10
    v_fma_f32 v31, -v135, v135, s10
    v_fma_f32 v32, -v136, v136, s10
    v_fma_f32 v33, -v137, v137, s10
    v_fma_f32 v34, -v138, v138, s10
    v_fma_f32 v35, -v139, v139, s10
    v_mul_f32 v28, v28, v132
    v_mul_f32 v29, v29, v133
    v_mul_f32 v30, v30, v134
    v_mul_f32 v31, v31, v135
    v_mul_f32 v32, v32, v136
    v_mul_f32 v33, v33, v137
    v_mul_f32 v34, v34, v138
    v_mul_f32 v35, v35, v139
    v_exp_f32 v28, v28
    v_exp_f32 v29, v29
    v_exp_f32 v30, v30
    v_exp_f32 v31, v31
    v_exp_f32 v32, v32
    v_exp_f32 v33, v33
    v_exp_f32 v34, v34
    v_exp_f32 v35, v35
    v_mul_f32 v132, v132, v140
    v_mul_f32 v133, v133, v141
    v_mul_f32 v134, v134, v142
    v_mul_f32 v135, v135, v143
    v_mul_f32 v136, v136, v144
    v_mul_f32 v137, v137, v145
    v_mul_f32 v138, v138, v146
    v_mul_f32 v139, v139, v147
    v_fma_f32 v28, v28, s11, s11
    v_fma_f32 v29, v29, s11, s11
    v_fma_f32 v30, v30, s11, s11
    v_fma_f32 v31, v31, s11, s11
    v_fma_f32 v32, v32, s11, s11
    v_fma_f32 v33, v33, s11, s11
    v_fma_f32 v34, v34, s11, s11
    v_fma_f32 v35, v35, s11, s11
    v_rcp_f32 v28, v28
    v_rcp_f32 v29, v29
    v_rcp_f32 v30, v30
    v_rcp_f32 v31, v31
    v_rcp_f32 v32, v32
    v_rcp_f32 v33, v33
    v_rcp_f32 v34, v34
    v_rcp_f32 v35, v35
    s_nop 0
    v_mul_f32 v132, v132, v28
    v_mul_f32 v133, v133, v29
    v_mul_f32 v134, v134, v30
    v_mul_f32 v135, v135, v31
    v_mul_f32 v136, v136, v32
    v_mul_f32 v137, v137, v33
    v_mul_f32 v138, v138, v34
    v_mul_f32 v139, v139, v35
    v_cvt_pk_bf16_f32 v140, v132, v133
    v_cvt_pk_bf16_f32 v142, v136, v137
    v_cvt_pk_bf16_f32 v141, v134, v135
    v_cvt_pk_bf16_f32 v143, v138, v139
    s_nop 0
    v_permlane16_swap_b32 v140, v142
    v_permlane16_swap_b32 v141, v143
    s_nop 0
    buffer_store_dwordx4 v[140:143], v2, s[32:35], s8 offen offset:2048 sc1
    v_fma_f32 v28, -v148, v148, s10
    v_fma_f32 v29, -v149, v149, s10
    v_fma_f32 v30, -v150, v150, s10
    v_fma_f32 v31, -v151, v151, s10
    v_fma_f32 v32, -v152, v152, s10
    v_fma_f32 v33, -v153, v153, s10
    v_fma_f32 v34, -v154, v154, s10
    v_fma_f32 v35, -v155, v155, s10
    v_mul_f32 v28, v28, v148
    v_mul_f32 v29, v29, v149
    v_mul_f32 v30, v30, v150
    v_mul_f32 v31, v31, v151
    v_mul_f32 v32, v32, v152
    v_mul_f32 v33, v33, v153
    v_mul_f32 v34, v34, v154
    v_mul_f32 v35, v35, v155
    v_exp_f32 v28, v28
    v_exp_f32 v29, v29
    v_exp_f32 v30, v30
    v_exp_f32 v31, v31
    v_exp_f32 v32, v32
    v_exp_f32 v33, v33
    v_exp_f32 v34, v34
    v_exp_f32 v35, v35
    v_mul_f32 v148, v148, v156
    v_mul_f32 v149, v149, v157
    v_mul_f32 v150, v150, v158
    v_mul_f32 v151, v151, v159
    v_mul_f32 v152, v152, v160
    v_mul_f32 v153, v153, v161
    v_mul_f32 v154, v154, v162
    v_mul_f32 v155, v155, v163
    v_fma_f32 v28, v28, s11, s11
    v_fma_f32 v29, v29, s11, s11
    v_fma_f32 v30, v30, s11, s11
    v_fma_f32 v31, v31, s11, s11
    v_fma_f32 v32, v32, s11, s11
    v_fma_f32 v33, v33, s11, s11
    v_fma_f32 v34, v34, s11, s11
    v_fma_f32 v35, v35, s11, s11
    v_rcp_f32 v28, v28
    v_rcp_f32 v29, v29
    v_rcp_f32 v30, v30
    v_rcp_f32 v31, v31
    v_rcp_f32 v32, v32
    v_rcp_f32 v33, v33
    v_rcp_f32 v34, v34
    v_rcp_f32 v35, v35
    s_nop 0
    v_mul_f32 v148, v148, v28
    v_mul_f32 v149, v149, v29
    v_mul_f32 v150, v150, v30
    v_mul_f32 v151, v151, v31
    v_mul_f32 v152, v152, v32
    v_mul_f32 v153, v153, v33
    v_mul_f32 v154, v154, v34
    v_mul_f32 v155, v155, v35
    v_cvt_pk_bf16_f32 v156, v148, v149
    v_cvt_pk_bf16_f32 v158, v152, v153
    v_cvt_pk_bf16_f32 v157, v150, v151
    v_cvt_pk_bf16_f32 v159, v154, v155
    s_nop 0
    v_permlane16_swap_b32 v156, v158
    v_permlane16_swap_b32 v157, v159
    s_nop 0
    buffer_store_dwordx4 v[156:159], v2, s[32:35], s9 offen offset:2048 sc1
L_f_gd:
    s_lshl_b32 s8, s4, 2
    s_lshr_b32 s9, s5, 1
    s_add_u32 s8, s8, s9
    s_mul_i32 s8, s8, 256
    s_add_u32 s8, s8, 17047552
    s_add_u32 s36, s32, s8
    s_addc_u32 s37, s33, 0
    s_mov_b32 s40, 1
    s_mov_b32 s41, 1
    s_waitcnt vmcnt(0)
    s_atomic_add s40, s[36:37], 0 glc
    s_atomic_add s41, s[36:37], 128 glc
    v_permlane32_swap_b32 v36, v38
    v_permlane32_swap_b32 v37, v39
    v_permlane32_swap_b32 v40, v42
    v_permlane32_swap_b32 v41, v43
    v_lshlrev_b32 v100, 16, v36
    v_and_b32 v101, 0xffff0000, v36
    v_lshlrev_b32 v102, 16, v37
    v_and_b32 v103, 0xffff0000, v37
    v_lshlrev_b32 v104, 16, v38
    v_and_b32 v105, 0xffff0000, v38
    v_lshlrev_b32 v106, 16, v39
    v_and_b32 v107, 0xffff0000, v39
    v_lshlrev_b32 v108, 16, v40
    v_and_b32 v109, 0xffff0000, v40
    v_lshlrev_b32 v110, 16, v41
    v_and_b32 v111, 0xffff0000, v41
    v_lshlrev_b32 v112, 16, v42
    v_and_b32 v113, 0xffff0000, v42
    v_lshlrev_b32 v114, 16, v43
    v_and_b32 v115, 0xffff0000, v43
    v_and_b32 v8, 15, v1
    v_lshlrev_b32 v8, 10, v8
    v_lshrrev_b32 v164, 5, v1
    v_lshl_add_u32 v8, v164, 4, v8
    v_and_b32 v164, 16, v1
    v_lshl_add_u32 v8, v164, 1, v8
    s_setprio 0
    s_xor_b32 s61, s7, 1
    s_mul_i32 s61, s61, 12288
    s_add_u32 s61, s61, 65792
    s_xor_b32 s62, s7, 2
    s_mul_i32 s62, s62, 12288
    s_add_u32 s62, s62, 65792
    s_xor_b32 s63, s7, 3
    s_mul_i32 s63, s63, 12288
    s_add_u32 s63, s63, 65792
    s_add_u32 s8, s7, 65648
    v_mov_b32 v164, s8
    v_mov_b32 v165, 65648
    v_mov_b32 v166, 1
    s_lshl_b32 s8, s68, 1
    s_add_u32 s8, s8, s17
    s_mul_i32 s8, s8, 4
    s_lshl_b32 s9, s69, 2
    s_add_u32 s9, s9, s7
    s_bfe_u32 s9, s9, 131073
    s_add_u32 s8, s8, s9
    s_lshl_b32 s8, s8, 7
    s_add_u32 s8, s8, 17080320
    s_add_u32 s66, s32, s8
    s_addc_u32 s67, s33, 0
    s_lshl_b32 s8, s68, 2
    s_add_u32 s8, s8, s7
    s_mul_i32 s8, s8, 2
    s_and_b32 s9, s69, 1
    s_add_u32 s8, s8, s9
    s_lshl_b32 s8, s8, 7
    s_add_u32 s8, s8, 17047552
    s_add_u32 s38, s32, s8
    s_addc_u32 s39, s33, 0
    s_mov_b32 s22, 262144
L_hpoll:
    s_load_dword s42, s[38:39], 0 glc
    s_sub_u32 s22, s22, 1
    s_cbranch_scc1 L_hpoll_ok
    s_waitcnt lgkmcnt(0)
    s_cmp_eq_u32 s42, 8
    s_cbranch_scc0 L_hpoll
L_hpoll_ok:
    s_lshr_b32 s8, s73, 4
    s_add_u32 s8, s8, s14
    buffer_load_dwordx4 v[36:39], v3, s[32:35], s8 offen sc1
    buffer_load_dwordx4 v[40:43], v9, s[32:35], s8 offen sc1
    s_add_u32 s73, s73, 16384
    s_cmp_eq_u32 s73, s13
    s_cselect_b32 s73, s12, s73
    s_lshr_b32 s8, s73, 4
    s_add_u32 s8, s8, s14
    buffer_load_dwordx4 v[44:47], v3, s[32:35], s8 offen sc1
    buffer_load_dwordx4 v[48:51], v9, s[32:35], s8 offen sc1
    s_add_u32 s73, s73, 16384
    s_cmp_eq_u32 s73, s13
    s_cselect_b32 s73, s12, s73
    s_lshr_b32 s8, s73, 4
    s_add_u32 s8, s8, s14
    buffer_load_dwordx4 v[52:55], v3, s[32:35], s8 offen sc1
    buffer_load_dwordx4 v[56:59], v9, s[32:35], s8 offen sc1
    s_add_u32 s73, s73, 16384
    s_cmp_eq_u32 s73, s13
    s_cselect_b32 s73, s12, s73
    s_lshr_b32 s8, s73, 4
    s_add_u32 s8, s8, s14
    buffer_load_dwordx4 v[60:63], v3, s[32:35], s8 offen sc1
    buffer_load_dwordx4 v[64:67], v9, s[32:35], s8 offen sc1
    s_add_u32 s73, s73, 16384
    s_cmp_eq_u32 s73, s13
    s_cselect_b32 s73, s12, s73
    s_lshr_b32 s8, s73, 4
    s_add_u32 s8, s8, s14
    buffer_load_dwordx4 v[68:71], v3, s[32:35], s8 offen sc1
    buffer_load_dwordx4 v[72:75], v9, s[32:35], s8 offen sc1
    s_add_u32 s73, s73, 16384
    s_cmp_eq_u32 s73, s13
    s_cselect_b32 s73, s12, s73
    s_lshr_b32 s8, s73, 4
    s_add_u32 s8, s8, s14
    buffer_load_dwordx4 v[76:79], v3, s[32:35], s8 offen sc1
    buffer_load_dwordx4 v[80:83], v9, s[32:35], s8 offen sc1
    s_add_u32 s73, s73, 16384
    s_cmp_eq_u32 s73, s13
    s_cselect_b32 s73, s12, s73
    s_lshr_b32 s8, s73, 4
    s_add_u32 s8, s8, s14
    buffer_load_dwordx4 v[84:87], v3, s[32:35], s8 offen sc1
    buffer_load_dwordx4 v[88:91], v9, s[32:35], s8 offen sc1
    s_add_u32 s73, s73, 16384
    s_cmp_eq_u32 s73, s13
    s_cselect_b32 s73, s12, s73
    s_lshr_b32 s8, s73, 4
    s_add_u32 s8, s8, s14
    buffer_load_dwordx4 v[92:95], v3, s[32:35], s8 offen sc1
    buffer_load_dwordx4 v[96:99], v9, s[32:35], s8 offen sc1
    s_add_u32 s73, s73, 16384
    s_cmp_eq_u32 s73, s13
    s_cselect_b32 s73, s12, s73
    ds_read_b64_tr_b16 v[12:13], v6 offset:0
    ds_read_b64_tr_b16 v[14:15], v6 offset:1024
    ds_read_b64_tr_b16 v[16:17], v7 offset:0
    ds_read_b64_tr_b16 v[18:19], v7 offset:1024
    s_waitcnt vmcnt(14) lgkmcnt(0)
    v_mfma_f32_32x32x16_bf16 v[100:115], v[12:15], v[36:39], v[100:115]
    ds_read_b64_tr_b16 v[20:21], v6 offset:2048
    ds_read_b64_tr_b16 v[22:23], v6 offset:3072
    ds_read_b64_tr_b16 v[24:25], v7 offset:2048
    ds_read_b64_tr_b16 v[26:27], v7 offset:3072
    v_mfma_f32_32x32x16_bf16 v[116:131], v[12:15], v[40:43], 0
    s_add_u32 m0, s16, 0
    s_nop 0
    buffer_load_dwordx4 v4, s[44:47], s72 offen lds
    buffer_load_dwordx4 v5, s[44:47], s72 offen offset:1024 lds
    s_add_u32 s72, s72, 16384
    s_cmp_eq_u32 s72, s13
    s_cselect_b32 s72, s12, s72
    v_mfma_f32_32x32x16_bf16 v[132:147], v[16:19], v[36:39], 0
    v_mfma_f32_32x32x16_bf16 v[148:163], v[16:19], v[40:43], 0
    s_lshr_b32 s8, s73, 4
    s_add_u32 s8, s8, s14
    buffer_load_dwordx4 v[36:39], v3, s[32:35], s8 offen sc1
    buffer_load_dwordx4 v[40:43], v9, s[32:35], s8 offen sc1
    s_add_u32 s73, s73, 16384
    s_cmp_eq_u32 s73, s13
    s_cselect_b32 s73, s12, s73
    s_waitcnt vmcnt(16) lgkmcnt(0)
    v_mfma_f32_32x32x16_bf16 v[100:115], v[20:23], v[44:47], v[100:115]
    ds_read_b64_tr_b16 v[12:13], v6 offset:4096
    ds_read_b64_tr_b16 v[14:15], v6 offset:5120
    ds_read_b64_tr_b16 v[16:17], v7 offset:4096
    ds_read_b64_tr_b16 v[18:19], v7 offset:5120
    v_mfma_f32_32x32x16_bf16 v[116:131], v[20:23], v[48:51], v[116:131]
    s_add_u32 m0, s16, 2048
    s_nop 0
    buffer_load_dwordx4 v4, s[44:47], s72 offen lds
    buffer_load_dwordx4 v5, s[44:47], s72 offen offset:1024 lds
    s_add_u32 s72, s72, 16384
    s_cmp_eq_u32 s72, s13
    s_cselect_b32 s72, s12, s72
    v_mfma_f32_32x32x16_bf16 v[132:147], v[24:27], v[44:47], v[132:147]
    v_mfma_f32_32x32x16_bf16 v[148:163], v[24:27], v[48:51], v[148:163]
    s_lshr_b32 s8, s73, 4
    s_add_u32 s8, s8, s14
    buffer_load_dwordx4 v[44:47], v3, s[32:35], s8 offen sc1
    buffer_load_dwordx4 v[48:51], v9, s[32:35], s8 offen sc1
    s_add_u32 s73, s73, 16384
    s_cmp_eq_u32 s73, s13
    s_cselect_b32 s73, s12, s73
    s_waitcnt vmcnt(18) lgkmcnt(0)
    v_mfma_f32_32x32x16_bf16 v[100:115], v[12:15], v[52:55], v[100:115]
    ds_read_b64_tr_b16 v[20:21], v6 offset:6144
    ds_read_b64_tr_b16 v[22:23], v6 offset:7168
    ds_read_b64_tr_b16 v[24:25], v7 offset:6144
    ds_read_b64_tr_b16 v[26:27], v7 offset:7168
    v_mfma_f32_32x32x16_bf16 v[116:131], v[12:15], v[56:59], v[116:131]
    s_add_u32 m0, s16, 4096
    s_nop 0
    buffer_load_dwordx4 v4, s[44:47], s72 offen lds
    buffer_load_dwordx4 v5, s[44:47], s72 offen offset:1024 lds
    s_add_u32 s72, s72, 16384
    s_cmp_eq_u32 s72, s13
    s_cselect_b32 s72, s12, s72
    v_mfma_f32_32x32x16_bf16 v[132:147], v[16:19], v[52:55], v[132:147]
    v_mfma_f32_32x32x16_bf16 v[148:163], v[16:19], v[56:59], v[148:163]
    s_lshr_b32 s8, s73, 4
    s_add_u32 s8, s8, s14
    buffer_load_dwordx4 v[52:55], v3, s[32:35], s8 offen sc1
    buffer_load_dwordx4 v[56:59], v9, s[32:35], s8 offen sc1
    s_add_u32 s73, s73, 16384
    s_cmp_eq_u32 s73, s13
    s_cselect_b32 s73, s12, s73
    s_waitcnt vmcnt(20) lgkmcnt(0)
    v_mfma_f32_32x32x16_bf16 v[100:115], v[20:23], v[60:63], v[100:115]
    ds_read_b64_tr_b16 v[12:13], v6 offset:8192
    ds_read_b64_tr_b16 v[14:15], v6 offset:9216
    ds_read_b64_tr_b16 v[16:17], v7 offset:8192
    ds_read_b64_tr_b16 v[18:19], v7 offset:9216
    v_mfma_f32_32x32x16_bf16 v[116:131], v[20:23], v[64:67], v[116:131]
    s_add_u32 m0, s16, 6144
    s_nop 0
    buffer_load_dwordx4 v4, s[44:47], s72 offen lds
    buffer_load_dwordx4 v5, s[44:47], s72 offen offset:1024 lds
    s_add_u32 s72, s72, 16384
    s_cmp_eq_u32 s72, s13
    s_cselect_b32 s72, s12, s72
    v_mfma_f32_32x32x16_bf16 v[132:147], v[24:27], v[60:63], v[132:147]
    v_mfma_f32_32x32x16_bf16 v[148:163], v[24:27], v[64:67], v[148:163]
    s_lshr_b32 s8, s73, 4
    s_add_u32 s8, s8, s14
    buffer_load_dwordx4 v[60:63], v3, s[32:35], s8 offen sc1
    buffer_load_dwordx4 v[64:67], v9, s[32:35], s8 offen sc1
    s_add_u32 s73, s73, 16384
    s_cmp_eq_u32 s73, s13
    s_cselect_b32 s73, s12, s73
    s_waitcnt vmcnt(22) lgkmcnt(0)
    v_mfma_f32_32x32x16_bf16 v[100:115], v[12:15], v[68:71], v[100:115]
    ds_read_b64_tr_b16 v[20:21], v6 offset:10240
    ds_read_b64_tr_b16 v[22:23], v6 offset:11264
    ds_read_b64_tr_b16 v[24:25], v7 offset:10240
    ds_read_b64_tr_b16 v[26:27], v7 offset:11264
    v_mfma_f32_32x32x16_bf16 v[116:131], v[12:15], v[72:75], v[116:131]
    s_add_u32 m0, s16, 8192
    s_nop 0
    buffer_load_dwordx4 v4, s[44:47], s72 offen lds
    buffer_load_dwordx4 v5, s[44:47], s72 offen offset:1024 lds
    s_add_u32 s72, s72, 16384
    s_cmp_eq_u32 s72, s13
    s_cselect_b32 s72, s12, s72
    v_mfma_f32_32x32x16_bf16 v[132:147], v[16:19], v[68:71], v[132:147]
    v_mfma_f32_32x32x16_bf16 v[148:163], v[16:19], v[72:75], v[148:163]
    s_lshr_b32 s8, s73, 4
    s_add_u32 s8, s8, s14
    buffer_load_dwordx4 v[68:71], v3, s[32:35], s8 offen sc1
    buffer_load_dwordx4 v[72:75], v9, s[32:35], s8 offen sc1
    s_add_u32 s73, s73, 16384
    s_cmp_eq_u32 s73, s13
    s_cselect_b32 s73, s12, s73
    s_waitcnt vmcnt(24) lgkmcnt(0)
    v_mfma_f32_32x32x16_bf16 v[100:115], v[20:23], v[76:79], v[100:115]
    ds_read_b64_tr_b16 v[12:13], v10 offset:0
    ds_read_b64_tr_b16 v[14:15], v10 offset:1024
    ds_read_b64_tr_b16 v[16:17], v11 offset:0
    ds_read_b64_tr_b16 v[18:19], v11 offset:1024
    v_mfma_f32_32x32x16_bf16 v[116:131], v[20:23], v[80:83], v[116:131]
    s_add_u32 m0, s16, 10240
    s_nop 0
    buffer_load_dwordx4 v4, s[44:47], s72 offen lds
    buffer_load_dwordx4 v5, s[44:47], s72 offen offset:1024 lds
    s_add_u32 s72, s72, 16384
    s_cmp_eq_u32 s72, s13
    s_cselect_b32 s72, s12, s72
    v_mfma_f32_32x32x16_bf16 v[132:147], v[24:27], v[76:79], v[132:147]
    v_mfma_f32_32x32x16_bf16 v[148:163], v[24:27], v[80:83], v[148:163]
    s_lshr_b32 s8, s73, 4
    s_add_u32 s8, s8, s14
    buffer_load_dwordx4 v[76:79], v3, s[32:35], s8 offen sc1
    buffer_load_dwordx4 v[80:83], v9, s[32:35], s8 offen sc1
    s_add_u32 s73, s73, 16384
    s_cmp_eq_u32 s73, s13
    s_cselect_b32 s73, s12, s73
    s_waitcnt vmcnt(26) lgkmcnt(0)
    v_mfma_f32_32x32x16_bf16 v[100:115], v[12:15], v[84:87], v[100:115]
    ds_read_b64_tr_b16 v[20:21], v10 offset:8192
    ds_read_b64_tr_b16 v[22:23], v10 offset:9216
    ds_read_b64_tr_b16 v[24:25], v11 offset:8192
    ds_read_b64_tr_b16 v[26:27], v11 offset:9216
    v_mfma_f32_32x32x16_bf16 v[116:131], v[12:15], v[88:91], v[116:131]
    v_mfma_f32_32x32x16_bf16 v[132:147], v[16:19], v[84:87], v[132:147]
    v_mfma_f32_32x32x16_bf16 v[148:163], v[16:19], v[88:91], v[148:163]
    s_lshr_b32 s8, s73, 4
    s_add_u32 s8, s8, s14
    buffer_load_dwordx4 v[84:87], v3, s[32:35], s8 offen sc1
    buffer_load_dwordx4 v[88:91], v9, s[32:35], s8 offen sc1
    s_add_u32 s73, s73, 16384
    s_cmp_eq_u32 s73, s13
    s_cselect_b32 s73, s12, s73
    s_waitcnt vmcnt(26) lgkmcnt(0)
    v_mfma_f32_32x32x16_bf16 v[100:115], v[20:23], v[92:95], v[100:115]
    ds_read_b64_tr_b16 v[12:13], v10 offset:16384
    ds_read_b64_tr_b16 v[14:15], v10 offset:17408
    ds_read_b64_tr_b16 v[16:17], v11 offset:16384
    ds_read_b64_tr_b16 v[18:19], v11 offset:17408
    v_mfma_f32_32x32x16_bf16 v[116:131], v[20:23], v[96:99], v[116:131]
    v_mfma_f32_32x32x16_bf16 v[132:147], v[24:27], v[92:95], v[132:147]
    v_mfma_f32_32x32x16_bf16 v[148:163], v[24:27], v[96:99], v[148:163]
    s_lshr_b32 s8, s73, 4
    s_add_u32 s8, s8, s14
    buffer_load_dwordx4 v[92:95], v3, s[32:35], s8 offen sc1
    buffer_load_dwordx4 v[96:99], v9, s[32:35], s8 offen sc1
    s_add_u32 s73, s73, 16384
    s_cmp_eq_u32 s73, s13
    s_cselect_b32 s73, s12, s73
    s_waitcnt vmcnt(24) lgkmcnt(0)
    v_mfma_f32_32x32x16_bf16 v[100:115], v[12:15], v[36:39], v[100:115]
    ds_read_b64_tr_b16 v[20:21], v10 offset:24576
    ds_read_b64_tr_b16 v[22:23], v10 offset:25600
    ds_read_b64_tr_b16 v[24:25], v11 offset:24576
    ds_read_b64_tr_b16 v[26:27], v11 offset:25600
    v_mfma_f32_32x32x16_bf16 v[116:131], v[12:15], v[40:43], v[116:131]
    v_mfma_f32_32x32x16_bf16 v[132:147], v[16:19], v[36:39], v[132:147]
    v_mfma_f32_32x32x16_bf16 v[148:163], v[16:19], v[40:43], v[148:163]
    s_lshr_b32 s8, s73, 4
    s_add_u32 s8, s8, s14
    buffer_load_dwordx4 v[36:39], v3, s[32:35], s8 offen sc1
    buffer_load_dwordx4 v[40:43], v9, s[32:35], s8 offen sc1
    s_add_u32 s73, s73, 16384
    s_cmp_eq_u32 s73, s13
    s_cselect_b32 s73, s12, s73
    s_waitcnt vmcnt(22) lgkmcnt(0)
    v_mfma_f32_32x32x16_bf16 v[100:115], v[20:23], v[44:47], v[100:115]
    ds_read_b64_tr_b16 v[12:13], v10 offset:32768
    ds_read_b64_tr_b16 v[14:15], v10 offset:33792
    ds_read_b64_tr_b16 v[16:17], v11 offset:32768
    ds_read_b64_tr_b16 v[18:19], v11 offset:33792
    v_mfma_f32_32x32x16_bf16 v[116:131], v[20:23], v[48:51], v[116:131]
    v_mfma_f32_32x32x16_bf16 v[132:147], v[24:27], v[44:47], v[132:147]
    v_mfma_f32_32x32x16_bf16 v[148:163], v[24:27], v[48:51], v[148:163]
    s_lshr_b32 s8, s73, 4
    s_add_u32 s8, s8, s14
    buffer_load_dwordx4 v[44:47], v3, s[32:35], s8 offen sc1
    buffer_load_dwordx4 v[48:51], v9, s[32:35], s8 offen sc1
    s_add_u32 s73, s73, 16384
    s_cmp_eq_u32 s73, s13
    s_cselect_b32 s73, s12, s73
    s_waitcnt vmcnt(20) lgkmcnt(0)
    v_mfma_f32_32x32x16_bf16 v[100:115], v[12:15], v[52:55], v[100:115]
    ds_read_b64_tr_b16 v[20:21], v10 offset:40960
    ds_read_b64_tr_b16 v[22:23], v10 offset:41984
    ds_read_b64_tr_b16 v[24:25], v11 offset:40960
    ds_read_b64_tr_b16 v[26:27], v11 offset:41984
    v_mfma_f32_32x32x16_bf16 v[116:131], v[12:15], v[56:59], v[116:131]
    v_mfma_f32_32x32x16_bf16 v[132:147], v[16:19], v[52:55], v[132:147]
    v_mfma_f32_32x32x16_bf16 v[148:163], v[16:19], v[56:59], v[148:163]
    s_lshr_b32 s8, s73, 4
    s_add_u32 s8, s8, s14
    buffer_load_dwordx4 v[52:55], v3, s[32:35], s8 offen sc1
    buffer_load_dwordx4 v[56:59], v9, s[32:35], s8 offen sc1
    s_add_u32 s73, s73, 16384
    s_cmp_eq_u32 s73, s13
    s_cselect_b32 s73, s12, s73
    s_waitcnt vmcnt(18) lgkmcnt(0)
    v_mfma_f32_32x32x16_bf16 v[100:115], v[20:23], v[60:63], v[100:115]
    ds_read_b64_tr_b16 v[12:13], v10 offset:49152
    ds_read_b64_tr_b16 v[14:15], v10 offset:50176
    ds_read_b64_tr_b16 v[16:17], v11 offset:49152
    ds_read_b64_tr_b16 v[18:19], v11 offset:50176
    v_mfma_f32_32x32x16_bf16 v[116:131], v[20:23], v[64:67], v[116:131]
    v_mfma_f32_32x32x16_bf16 v[132:147], v[24:27], v[60:63], v[132:147]
    v_mfma_f32_32x32x16_bf16 v[148:163], v[24:27], v[64:67], v[148:163]
    s_lshr_b32 s8, s73, 4
    s_add_u32 s8, s8, s14
    buffer_load_dwordx4 v[60:63], v3, s[32:35], s8 offen sc1
    buffer_load_dwordx4 v[64:67], v9, s[32:35], s8 offen sc1
    s_add_u32 s73, s73, 16384
    s_cmp_eq_u32 s73, s13
    s_cselect_b32 s73, s12, s73
    s_waitcnt vmcnt(16) lgkmcnt(0)
    v_mfma_f32_32x32x16_bf16 v[100:115], v[12:15], v[68:71], v[100:115]
    ds_read_b64_tr_b16 v[20:21], v10 offset:57344
    ds_read_b64_tr_b16 v[22:23], v10 offset:58368
    ds_read_b64_tr_b16 v[24:25], v11 offset:57344
    ds_read_b64_tr_b16 v[26:27], v11 offset:58368
    v_mfma_f32_32x32x16_bf16 v[116:131], v[12:15], v[72:75], v[116:131]
    v_mfma_f32_32x32x16_bf16 v[132:147], v[16:19], v[68:71], v[132:147]
    v_mfma_f32_32x32x16_bf16 v[148:163], v[16:19], v[72:75], v[148:163]
    s_lshr_b32 s8, s73, 4
    s_add_u32 s8, s8, s14
    buffer_load_dwordx4 v[68:71], v3, s[32:35], s8 offen sc1
    buffer_load_dwordx4 v[72:75], v9, s[32:35], s8 offen sc1
    s_add_u32 s73, s73, 16384
    s_cmp_eq_u32 s73, s13
    s_cselect_b32 s73, s12, s73
    s_waitcnt vmcnt(14) lgkmcnt(0)
    v_mfma_f32_32x32x16_bf16 v[100:115], v[20:23], v[76:79], v[100:115]
    ds_read_b64_tr_b16 v[12:13], v6 offset:0
    ds_read_b64_tr_b16 v[14:15], v6 offset:1024
    ds_read_b64_tr_b16 v[16:17], v7 offset:0
    ds_read_b64_tr_b16 v[18:19], v7 offset:1024
    v_mfma_f32_32x32x16_bf16 v[116:131], v[20:23], v[80:83], v[116:131]
    v_mfma_f32_32x32x16_bf16 v[132:147], v[24:27], v[76:79], v[132:147]
    v_mfma_f32_32x32x16_bf16 v[148:163], v[24:27], v[80:83], v[148:163]
    s_lshr_b32 s8, s73, 4
    s_add_u32 s8, s8, s14
    buffer_load_dwordx4 v[76:79], v3, s[32:35], s8 offen sc1
    buffer_load_dwordx4 v[80:83], v9, s[32:35], s8 offen sc1
    s_add_u32 s73, s73, 16384
    s_cmp_eq_u32 s73, s13
    s_cselect_b32 s73, s12, s73
    s_waitcnt vmcnt(14) lgkmcnt(0)
    v_mfma_f32_32x32x16_bf16 v[100:115], v[12:15], v[84:87], v[100:115]
    ds_read_b64_tr_b16 v[20:21], v6 offset:2048
    ds_read_b64_tr_b16 v[22:23], v6 offset:3072
    ds_read_b64_tr_b16 v[24:25], v7 offset:2048
    ds_read_b64_tr_b16 v[26:27], v7 offset:3072
    v_mfma_f32_32x32x16_bf16 v[116:131], v[12:15], v[88:91], v[116:131]
    s_add_u32 m0, s16, 0
    s_nop 0
    buffer_load_dwordx4 v4, s[44:47], s72 offen lds
    buffer_load_dwordx4 v5, s[44:47], s72 offen offset:1024 lds
    s_add_u32 s72, s72, 16384
    s_cmp_eq_u32 s72, s13
    s_cselect_b32 s72, s12, s72
    v_mfma_f32_32x32x16_bf16 v[132:147], v[16:19], v[84:87], v[132:147]
    s_add_u32 m0, s15, 0
    s_nop 0
    buffer_load_dwordx4 v4, s[48:51], s64 offen lds
    buffer_load_dwordx4 v5, s[48:51], s64 offen offset:1024 lds
    s_add_u32 s64, s64, 65536
    v_mfma_f32_32x32x16_bf16 v[148:163], v[16:19], v[88:91], v[148:163]
    s_waitcnt vmcnt(16) lgkmcnt(0)
    v_mfma_f32_32x32x16_bf16 v[100:115], v[20:23], v[92:95], v[100:115]
    ds_read_b64_tr_b16 v[12:13], v6 offset:4096
    ds_read_b64_tr_b16 v[14:15], v6 offset:5120
    ds_read_b64_tr_b16 v[16:17], v7 offset:4096
    ds_read_b64_tr_b16 v[18:19], v7 offset:5120
    v_mfma_f32_32x32x16_bf16 v[116:131], v[20:23], v[96:99], v[116:131]
    s_add_u32 m0, s16, 2048
    s_nop 0
    buffer_load_dwordx4 v4, s[44:47], s72 offen lds
    buffer_load_dwordx4 v5, s[44:47], s72 offen offset:1024 lds
    s_add_u32 s72, s72, 16384
    s_cmp_eq_u32 s72, s13
    s_cselect_b32 s72, s12, s72
    v_mfma_f32_32x32x16_bf16 v[132:147], v[24:27], v[92:95], v[132:147]
    s_add_u32 m0, s15, 8192
    s_nop 0
    buffer_load_dwordx4 v4, s[48:51], s64 offen lds
    buffer_load_dwordx4 v5, s[48:51], s64 offen offset:1024 lds
    s_add_u32 s64, s64, 65536
    v_mfma_f32_32x32x16_bf16 v[148:163], v[24:27], v[96:99], v[148:163]
    s_waitcnt vmcnt(18) lgkmcnt(0)
    v_mfma_f32_32x32x16_bf16 v[100:115], v[12:15], v[36:39], v[100:115]
    ds_read_b64_tr_b16 v[20:21], v6 offset:6144
    ds_read_b64_tr_b16 v[22:23], v6 offset:7168
    ds_read_b64_tr_b16 v[24:25], v7 offset:6144
    ds_read_b64_tr_b16 v[26:27], v7 offset:7168
    v_mfma_f32_32x32x16_bf16 v[116:131], v[12:15], v[40:43], v[116:131]
    s_add_u32 m0, s15, 16384
    s_nop 0
    buffer_load_dwordx4 v4, s[48:51], s64 offen lds
    buffer_load_dwordx4 v5, s[48:51], s64 offen offset:1024 lds
    s_add_u32 s64, s64, 65536
    v_mfma_f32_32x32x16_bf16 v[132:147], v[16:19], v[36:39], v[132:147]
    s_add_u32 m0, s15, 24576
    s_nop 0
    buffer_load_dwordx4 v4, s[48:51], s64 offen lds
    buffer_load_dwordx4 v5, s[48:51], s64 offen offset:1024 lds
    s_add_u32 s64, s64, 65536
    v_mfma_f32_32x32x16_bf16 v[148:163], v[16:19], v[40:43], v[148:163]
    s_waitcnt vmcnt(20) lgkmcnt(0)
    v_mfma_f32_32x32x16_bf16 v[100:115], v[20:23], v[44:47], v[100:115]
    ds_read_b64_tr_b16 v[12:13], v6 offset:8192
    ds_read_b64_tr_b16 v[14:15], v6 offset:9216
    ds_read_b64_tr_b16 v[16:17], v7 offset:8192
    ds_read_b64_tr_b16 v[18:19], v7 offset:9216
    v_mfma_f32_32x32x16_bf16 v[116:131], v[20:23], v[48:51], v[116:131]
    s_add_u32 m0, s15, 32768
    s_nop 0
    buffer_load_dwordx4 v4, s[48:51], s64 offen lds
    buffer_load_dwordx4 v5, s[48:51], s64 offen offset:1024 lds
    s_add_u32 s64, s64, 65536
    v_mfma_f32_32x32x16_bf16 v[132:147], v[24:27], v[44:47], v[132:147]
    s_add_u32 m0, s15, 40960
    s_nop 0
    buffer_load_dwordx4 v4, s[48:51], s64 offen lds
    buffer_load_dwordx4 v5, s[48:51], s64 offen offset:1024 lds
    s_add_u32 s64, s64, 65536
    v_mfma_f32_32x32x16_bf16 v[148:163], v[24:27], v[48:51], v[148:163]
    s_waitcnt vmcnt(22) lgkmcnt(0)
    v_mfma_f32_32x32x16_bf16 v[100:115], v[12:15], v[52:55], v[100:115]
    ds_read_b64_tr_b16 v[20:21], v6 offset:10240
    ds_read_b64_tr_b16 v[22:23], v6 offset:11264
    ds_read_b64_tr_b16 v[24:25], v7 offset:10240
    ds_read_b64_tr_b16 v[26:27], v7 offset:11264
    v_mfma_f32_32x32x16_bf16 v[116:131], v[12:15], v[56:59], v[116:131]
    s_add_u32 m0, s15, 49152
    s_nop 0
    buffer_load_dwordx4 v4, s[48:51], s64 offen lds
    buffer_load_dwordx4 v5, s[48:51], s64 offen offset:1024 lds
    s_add_u32 s64, s64, 65536
    v_mfma_f32_32x32x16_bf16 v[132:147], v[16:19], v[52:55], v[132:147]
    s_add_u32 m0, s15, 57344
    s_nop 0
    buffer_load_dwordx4 v4, s[48:51], s64 offen lds
    buffer_load_dwordx4 v5, s[48:51], s64 offen offset:1024 lds
    s_add_u32 s64, s64, 65536
    v_mfma_f32_32x32x16_bf16 v[148:163], v[16:19], v[56:59], v[148:163]
    s_waitcnt vmcnt(18) lgkmcnt(0)
    v_mfma_f32_32x32x16_bf16 v[100:115], v[20:23], v[60:63], v[100:115]
    ds_read_b64_tr_b16 v[12:13], v6 offset:0
    ds_read_b64_tr_b16 v[14:15], v6 offset:1024
    ds_read_b64_tr_b16 v[16:17], v7 offset:0
    ds_read_b64_tr_b16 v[18:19], v7 offset:1024
    v_mfma_f32_32x32x16_bf16 v[116:131], v[20:23], v[64:67], v[116:131]
    v_mfma_f32_32x32x16_bf16 v[132:147], v[24:27], v[60:63], v[132:147]
    v_mfma_f32_32x32x16_bf16 v[148:163], v[24:27], v[64:67], v[148:163]
    s_cmp_eq_u32 s7, 3
    s_waitcnt vmcnt(14) lgkmcnt(0)
    s_cbranch_scc1 L_d_done
    v_mfma_f32_32x32x16_bf16 v[100:115], v[12:15], v[68:71], v[100:115]
    ds_read_b64_tr_b16 v[20:21], v6 offset:2048
    ds_read_b64_tr_b16 v[22:23], v6 offset:3072
    ds_read_b64_tr_b16 v[24:25], v7 offset:2048
    ds_read_b64_tr_b16 v[26:27], v7 offset:3072
    v_mfma_f32_32x32x16_bf16 v[116:131], v[12:15], v[72:75], v[116:131]
    v_mfma_f32_32x32x16_bf16 v[132:147], v[16:19], v[68:71], v[132:147]
    v_mfma_f32_32x32x16_bf16 v[148:163], v[16:19], v[72:75], v[148:163]
    s_waitcnt vmcnt(20) lgkmcnt(0)
    v_mfma_f32_32x32x16_bf16 v[100:115], v[20:23], v[76:79], v[100:115]
    v_mfma_f32_32x32x16_bf16 v[116:131], v[20:23], v[80:83], v[116:131]
    v_mfma_f32_32x32x16_bf16 v[132:147], v[24:27], v[76:79], v[132:147]
    v_mfma_f32_32x32x16_bf16 v[148:163], v[24:27], v[80:83], v[148:163]
    s_branch L_d_done
L_f_g3:
    s_branch L_f_gd
L_d_done:
    s_setprio 1
    v_add_u32 v4, s16, v2
    v_add_u32 v5, s61, v2
    v_add_u32 v6, s62, v2
    v_add_u32 v7, s63, v2
    v_subrev_u32 v10, s15, v10
    s_nop 3
    ds_write_b128 v4, v[116:119] offset:0
    ds_write_b128 v4, v[120:123] offset:1024
    ds_write_b128 v4, v[124:127] offset:2048
    ds_write_b128 v4, v[128:131] offset:3072
    ds_write_b128 v4, v[132:135] offset:4096
    ds_write_b128 v4, v[136:139] offset:5120
    ds_write_b128 v4, v[140:143] offset:6144
    ds_write_b128 v4, v[144:147] offset:7168
    ds_write_b128 v4, v[148:151] offset:8192
    ds_write_b128 v4, v[152:155] offset:9216
    ds_write_b128 v4, v[156:159] offset:10240
    ds_write_b128 v4, v[160:163] offset:11264
    s_mov_b32 s22, 65536
    s_mov_b32 s20, 0
    s_mov_b64 s[18:19], -1
    s_mov_b32 s21, 0x01010101
    s_waitcnt vmcnt(0)
    ds_write_b8 v164, v166 offset:132
L_rsp:
    ds_read_b32 v167, v165 offset:132
    s_waitcnt lgkmcnt(0)
    v_cmp_ne_u32 vcc, s21, v167
    s_cbranch_vccnz L_rsp
    ds_read_b128 v[52:55], v5 offset:0
    ds_read_b128 v[56:59], v5 offset:1024
    ds_read_b128 v[60:63], v5 offset:2048
    ds_read_b128 v[64:67], v5 offset:3072
    ds_read_b128 v[68:71], v6 offset:4096
    ds_read_b128 v[72:75], v6 offset:5120
    ds_read_b128 v[76:79], v6 offset:6144
    ds_read_b128 v[80:83], v6 offset:7168
    ds_read_b128 v[84:87], v7 offset:8192
    ds_read_b128 v[88:91], v7 offset:9216
    ds_read_b128 v[92:95], v7 offset:10240
    ds_read_b128 v[96:99], v7 offset:11264
    ds_read_b32 v167, v165 offset:132
    s_load_dword s23, s[66:67], 0 glc
    s_waitcnt lgkmcnt(9)
    v_add_f32 v100, v100, v52
    v_add_f32 v101, v101, v53
    v_add_f32 v102, v102, v54
    v_add_f32 v103, v103, v55
    v_add_f32 v104, v104, v56
    v_add_f32 v105, v105, v57
    v_add_f32 v106, v106, v58
    v_add_f32 v107, v107, v59
    v_add_f32 v108, v108, v60
    v_add_f32 v109, v109, v61
    v_add_f32 v110, v110, v62
    v_add_f32 v111, v111, v63
    v_add_f32 v112, v112, v64
    v_add_f32 v113, v113, v65
    v_add_f32 v114, v114, v66
    v_add_f32 v115, v115, v67
    s_waitcnt lgkmcnt(5)
    v_add_f32 v100, v100, v68
    v_add_f32 v101, v101, v69
    v_add_f32 v102, v102, v70
    v_add_f32 v103, v103, v71
    v_add_f32 v104, v104, v72
    v_add_f32 v105, v105, v73
    v_add_f32 v106, v106, v74
    v_add_f32 v107, v107, v75
    v_add_f32 v108, v108, v76
    v_add_f32 v109, v109, v77
    v_add_f32 v110, v110, v78
    v_add_f32 v111, v111, v79
    v_add_f32 v112, v112, v80
    v_add_f32 v113, v113, v81
    v_add_f32 v114, v114, v82
    v_add_f32 v115, v115, v83
    s_waitcnt lgkmcnt(1)
    v_add_f32 v100, v100, v84
    v_add_f32 v101, v101, v85
    v_add_f32 v102, v102, v86
    v_add_f32 v103, v103, v87
    v_add_f32 v104, v104, v88
    v_add_f32 v105, v105, v89
    v_add_f32 v106, v106, v90
    v_add_f32 v107, v107, v91
    v_add_f32 v108, v108, v92
    v_add_f32 v109, v109, v93
    v_add_f32 v110, v110, v94
    v_add_f32 v111, v111, v95
    v_add_f32 v112, v112, v96
    v_add_f32 v113, v113, v97
    v_add_f32 v114, v114, v98
    v_add_f32 v115, v115, v99
    v_add_u32 v3, s74, v3
    s_mov_b32 s15, 0
    s_mov_b32 s13, 0
    s_mov_b32 s16, -1
L_ot0:
    s_sub_u32 s22, s22, 1
    s_cselect_b64 s[18:19], 0, s[18:19]
    s_andn2_b32 s14, s15, s20
    s_waitcnt lgkmcnt(0)
    s_orn2_b32 s9, s23, s18
    s_cmp_eq_u32 s9, -1
    s_cbranch_scc1 L_onp0
    s_load_dword s23, s[66:67], 0 glc
L_onp0:
    s_andn2_b32 s21, s9, s15
    s_cbranch_scc0 L_ow0_0
    s_or_b32 s15, s15, s9
    s_ff1_i32_b32 s36, s21
    s_lshl_b32 s8, s36, 10
    buffer_load_dwordx4 v[12:15], v3, s[32:35], s8 offen sc1
    v_lshl_add_u32 v164, s8, 1, v10
    s_add_u32 s9, s21, -1
    s_and_b32 s21, s21, s9
    ds_read_b64_tr_b16 v[16:17], v164 offset:0
    ds_read_b64_tr_b16 v[18:19], v164 offset:1024
    s_cbranch_scc0 L_ow0_1
    s_ff1_i32_b32 s37, s21
    s_lshl_b32 s8, s37, 10
    buffer_load_dwordx4 v[20:23], v3, s[32:35], s8 offen sc1
    v_lshl_add_u32 v165, s8, 1, v10
    s_add_u32 s9, s21, -1
    s_and_b32 s21, s21, s9
    ds_read_b64_tr_b16 v[24:25], v165 offset:0
    ds_read_b64_tr_b16 v[26:27], v165 offset:1024
    s_cbranch_scc0 L_ow0_2
    s_ff1_i32_b32 s38, s21
    s_lshl_b32 s8, s38, 10
    buffer_load_dwordx4 v[28:31], v3, s[32:35], s8 offen sc1
    v_lshl_add_u32 v164, s8, 1, v10
    s_add_u32 s9, s21, -1
    s_and_b32 s21, s21, s9
    ds_read_b64_tr_b16 v[32:33], v164 offset:0
    ds_read_b64_tr_b16 v[34:35], v164 offset:1024
    s_cbranch_scc0 L_ow0_3
    s_ff1_i32_b32 s39, s21
    s_lshl_b32 s8, s39, 10
    buffer_load_dwordx4 v[36:39], v3, s[32:35], s8 offen sc1
    v_lshl_add_u32 v165, s8, 1, v10
    s_add_u32 s9, s21, -1
    s_and_b32 s21, s21, s9
    ds_read_b64_tr_b16 v[40:41], v165 offset:0
    ds_read_b64_tr_b16 v[42:43], v165 offset:1024
    s_cbranch_scc0 L_ow0_4
    s_ff1_i32_b32 s40, s21
    s_lshl_b32 s8, s40, 10
    buffer_load_dwordx4 v[44:47], v3, s[32:35], s8 offen sc1
    v_lshl_add_u32 v164, s8, 1, v10
    s_add_u32 s9, s21, -1
    s_and_b32 s21, s21, s9
    ds_read_b64_tr_b16 v[48:49], v164 offset:0
    ds_read_b64_tr_b16 v[50:51], v164 offset:1024
    s_cbranch_scc0 L_ow0_5
    s_ff1_i32_b32 s41, s21
    s_lshl_b32 s8, s41, 10
    buffer_load_dwordx4 v[52:55], v3, s[32:35], s8 offen sc1
    v_lshl_add_u32 v165, s8, 1, v10
    s_add_u32 s9, s21, -1
    s_and_b32 s21, s21, s9
    ds_read_b64_tr_b16 v[56:57], v165 offset:0
    ds_read_b64_tr_b16 v[58:59], v165 offset:1024
    s_cbranch_scc0 L_ow0_6
    s_ff1_i32_b32 s42, s21
    s_lshl_b32 s8, s42, 10
    buffer_load_dwordx4 v[60:63], v3, s[32:35], s8 offen sc1
    v_lshl_add_u32 v164, s8, 1, v10
    s_add_u32 s9, s21, -1
    s_and_b32 s21, s21, s9
    ds_read_b64_tr_b16 v[64:65], v164 offset:0
    ds_read_b64_tr_b16 v[66:67], v164 offset:1024
    s_cbranch_scc0 L_ow0_7
    s_ff1_i32_b32 s43, s21
    s_lshl_b32 s8, s43, 10
    buffer_load_dwordx4 v[68:71], v3, s[32:35], s8 offen sc1
    v_lshl_add_u32 v165, s8, 1, v10
    s_add_u32 s9, s21, -1
    s_and_b32 s21, s21, s9
    ds_read_b64_tr_b16 v[72:73], v165 offset:0
    ds_read_b64_tr_b16 v[74:75], v165 offset:1024
L_ocb0:
    s_andn2_b32 s15, s15, s21
    s_mov_b32 s12, 8
    s_waitcnt vmcnt(8)
L_od0:
    s_cmp_eq_u32 s13, 8
    s_cbranch_scc1 L_of0
L_od0_0:
    s_cmp_le_u32 s13, 0
    s_cbranch_scc1 L_od0_8
    v_cmp_eq_u32 vcc, -1, v79
    s_bitset0_b32 s15, s44
    s_and_b64 vcc, vcc, s[18:19]
    s_cbranch_scc1 L_od0_1
    v_mfma_f32_32x32x16_bf16 v[100:115], v[80:83], v[76:79], v[100:115]
    s_bitset1_b32 s20, s44
L_od0_1:
    s_cmp_le_u32 s13, 1
    s_cbranch_scc1 L_od0_8
    v_cmp_eq_u32 vcc, -1, v87
    s_bitset0_b32 s15, s45
    s_and_b64 vcc, vcc, s[18:19]
    s_cbranch_scc1 L_od0_2
    v_mfma_f32_32x32x16_bf16 v[100:115], v[88:91], v[84:87], v[100:115]
    s_bitset1_b32 s20, s45
L_od0_2:
    s_cmp_le_u32 s13, 2
    s_cbranch_scc1 L_od0_8
    v_cmp_eq_u32 vcc, -1, v95
    s_bitset0_b32 s15, s46
    s_and_b64 vcc, vcc, s[18:19]
    s_cbranch_scc1 L_od0_3
    v_mfma_f32_32x32x16_bf16 v[100:115], v[96:99], v[92:95], v[100:115]
    s_bitset1_b32 s20, s46
L_od0_3:
    s_cmp_le_u32 s13, 3
    s_cbranch_scc1 L_od0_8
    v_cmp_eq_u32 vcc, -1, v119
    s_bitset0_b32 s15, s47
    s_and_b64 vcc, vcc, s[18:19]
    s_cbranch_scc1 L_od0_4
    v_mfma_f32_32x32x16_bf16 v[100:115], v[120:123], v[116:119], v[100:115]
    s_bitset1_b32 s20, s47
L_od0_4:
    s_cmp_le_u32 s13, 4
    s_cbranch_scc1 L_od0_8
    v_cmp_eq_u32 vcc, -1, v127
    s_bitset0_b32 s15, s48
    s_and_b64 vcc, vcc, s[18:19]
    s_cbranch_scc1 L_od0_5
    v_mfma_f32_32x32x16_bf16 v[100:115], v[128:131], v[124:127], v[100:115]
    s_bitset1_b32 s20, s48
L_od0_5:
    s_cmp_le_u32 s13, 5
    s_cbranch_scc1 L_od0_8
    v_cmp_eq_u32 vcc, -1, v135
    s_bitset0_b32 s15, s49
    s_and_b64 vcc, vcc, s[18:19]
    s_cbranch_scc1 L_od0_6
    v_mfma_f32_32x32x16_bf16 v[100:115], v[136:139], v[132:135], v[100:115]
    s_bitset1_b32 s20, s49
L_od0_6:
    s_cmp_le_u32 s13, 6
    s_cbranch_scc1 L_od0_8
    v_cmp_eq_u32 vcc, -1, v143
    s_bitset0_b32 s15, s50
    s_and_b64 vcc, vcc, s[18:19]
    s_cbranch_scc1 L_od0_7
    v_mfma_f32_32x32x16_bf16 v[100:115], v[144:147], v[140:143], v[100:115]
    s_bitset1_b32 s20, s50
L_od0_7:
    s_cmp_le_u32 s13, 7
    s_cbranch_scc1 L_od0_8
    v_cmp_eq_u32 vcc, -1, v151
    s_bitset0_b32 s15, s51
    s_and_b64 vcc, vcc, s[18:19]
    s_cbranch_scc1 L_od0_8
    v_mfma_f32_32x32x16_bf16 v[100:115], v[152:155], v[148:151], v[100:115]
    s_bitset1_b32 s20, s51
L_od0_8:
    s_or_b32 s15, s15, s20
    s_cmp_eq_u32 s20, -1
    s_cbranch_scc1 L_oend
L_ot1:
    s_sub_u32 s22, s22, 1
    s_cselect_b64 s[18:19], 0, s[18:19]
    s_andn2_b32 s14, s15, s20
    s_waitcnt lgkmcnt(0)
    s_orn2_b32 s9, s23, s18
    s_cmp_eq_u32 s9, -1
    s_cbranch_scc1 L_onp1
    s_load_dword s23, s[66:67], 0 glc
L_onp1:
    s_andn2_b32 s21, s9, s15
    s_cbranch_scc0 L_ow1_0
    s_or_b32 s15, s15, s9
    s_ff1_i32_b32 s44, s21
    s_lshl_b32 s8, s44, 10
    buffer_load_dwordx4 v[76:79], v3, s[32:35], s8 offen sc1
    v_lshl_add_u32 v164, s8, 1, v10
    s_add_u32 s9, s21, -1
    s_and_b32 s21, s21, s9
    ds_read_b64_tr_b16 v[80:81], v164 offset:0
    ds_read_b64_tr_b16 v[82:83], v164 offset:1024
    s_cbranch_scc0 L_ow1_1
    s_ff1_i32_b32 s45, s21
    s_lshl_b32 s8, s45, 10
    buffer_load_dwordx4 v[84:87], v3, s[32:35], s8 offen sc1
    v_lshl_add_u32 v165, s8, 1, v10
    s_add_u32 s9, s21, -1
    s_and_b32 s21, s21, s9
    ds_read_b64_tr_b16 v[88:89], v165 offset:0
    ds_read_b64_tr_b16 v[90:91], v165 offset:1024
    s_cbranch_scc0 L_ow1_2
    s_ff1_i32_b32 s46, s21
    s_lshl_b32 s8, s46, 10
    buffer_load_dwordx4 v[92:95], v3, s[32:35], s8 offen sc1
    v_lshl_add_u32 v164, s8, 1, v10
    s_add_u32 s9, s21, -1
    s_and_b32 s21, s21, s9
    ds_read_b64_tr_b16 v[96:97], v164 offset:0
    ds_read_b64_tr_b16 v[98:99], v164 offset:1024
    s_cbranch_scc0 L_ow1_3
    s_ff1_i32_b32 s47, s21
    s_lshl_b32 s8, s47, 10
    buffer_load_dwordx4 v[116:119], v3, s[32:35], s8 offen sc1
    v_lshl_add_u32 v165, s8, 1, v10
    s_add_u32 s9, s21, -1
    s_and_b32 s21, s21, s9
    ds_read_b64_tr_b16 v[120:121], v165 offset:0
    ds_read_b64_tr_b16 v[122:123], v165 offset:1024
    s_cbranch_scc0 L_ow1_4
    s_ff1_i32_b32 s48, s21
    s_lshl_b32 s8, s48, 10
    buffer_load_dwordx4 v[124:127], v3, s[32:35], s8 offen sc1
    v_lshl_add_u32 v164, s8, 1, v10
    s_add_u32 s9, s21, -1
    s_and_b32 s21, s21, s9
    ds_read_b64_tr_b16 v[128:129], v164 offset:0
    ds_read_b64_tr_b16 v[130:131], v164 offset:1024
    s_cbranch_scc0 L_ow1_5
    s_ff1_i32_b32 s49, s21
    s_lshl_b32 s8, s49, 10
    buffer_load_dwordx4 v[132:135], v3, s[32:35], s8 offen sc1
    v_lshl_add_u32 v165, s8, 1, v10
    s_add_u32 s9, s21, -1
    s_and_b32 s21, s21, s9
    ds_read_b64_tr_b16 v[136:137], v165 offset:0
    ds_read_b64_tr_b16 v[138:139], v165 offset:1024
    s_cbranch_scc0 L_ow1_6
    s_ff1_i32_b32 s50, s21
    s_lshl_b32 s8, s50, 10
    buffer_load_dwordx4 v[140:143], v3, s[32:35], s8 offen sc1
    v_lshl_add_u32 v164, s8, 1, v10
    s_add_u32 s9, s21, -1
    s_and_b32 s21, s21, s9
    ds_read_b64_tr_b16 v[144:145], v164 offset:0
    ds_read_b64_tr_b16 v[146:147], v164 offset:1024
    s_cbranch_scc0 L_ow1_7
    s_ff1_i32_b32 s51, s21
    s_lshl_b32 s8, s51, 10
    buffer_load_dwordx4 v[148:151], v3, s[32:35], s8 offen sc1
    v_lshl_add_u32 v165, s8, 1, v10
    s_add_u32 s9, s21, -1
    s_and_b32 s21, s21, s9
    ds_read_b64_tr_b16 v[152:153], v165 offset:0
    ds_read_b64_tr_b16 v[154:155], v165 offset:1024
L_ocb1:
    s_andn2_b32 s15, s15, s21
    s_mov_b32 s13, 8
    s_waitcnt vmcnt(8)
L_od1:
    s_cmp_eq_u32 s12, 8
    s_cbranch_scc1 L_of1
L_od1_0:
    s_cmp_le_u32 s12, 0
    s_cbranch_scc1 L_od1_8
    v_cmp_eq_u32 vcc, -1, v15
    s_bitset0_b32 s15, s36
    s_and_b64 vcc, vcc, s[18:19]
    s_cbranch_scc1 L_od1_1
    v_mfma_f32_32x32x16_bf16 v[100:115], v[16:19], v[12:15], v[100:115]
    s_bitset1_b32 s20, s36
L_od1_1:
    s_cmp_le_u32 s12, 1
    s_cbranch_scc1 L_od1_8
    v_cmp_eq_u32 vcc, -1, v23
    s_bitset0_b32 s15, s37
    s_and_b64 vcc, vcc, s[18:19]
    s_cbranch_scc1 L_od1_2
    v_mfma_f32_32x32x16_bf16 v[100:115], v[24:27], v[20:23], v[100:115]
    s_bitset1_b32 s20, s37
L_od1_2:
    s_cmp_le_u32 s12, 2
    s_cbranch_scc1 L_od1_8
    v_cmp_eq_u32 vcc, -1, v31
    s_bitset0_b32 s15, s38
    s_and_b64 vcc, vcc, s[18:19]
    s_cbranch_scc1 L_od1_3
    v_mfma_f32_32x32x16_bf16 v[100:115], v[32:35], v[28:31], v[100:115]
    s_bitset1_b32 s20, s38
L_od1_3:
    s_cmp_le_u32 s12, 3
    s_cbranch_scc1 L_od1_8
    v_cmp_eq_u32 vcc, -1, v39
    s_bitset0_b32 s15, s39
    s_and_b64 vcc, vcc, s[18:19]
    s_cbranch_scc1 L_od1_4
    v_mfma_f32_32x32x16_bf16 v[100:115], v[40:43], v[36:39], v[100:115]
    s_bitset1_b32 s20, s39
L_od1_4:
    s_cmp_le_u32 s12, 4
    s_cbranch_scc1 L_od1_8
    v_cmp_eq_u32 vcc, -1, v47
    s_bitset0_b32 s15, s40
    s_and_b64 vcc, vcc, s[18:19]
    s_cbranch_scc1 L_od1_5
    v_mfma_f32_32x32x16_bf16 v[100:115], v[48:51], v[44:47], v[100:115]
    s_bitset1_b32 s20, s40
L_od1_5:
    s_cmp_le_u32 s12, 5
    s_cbranch_scc1 L_od1_8
    v_cmp_eq_u32 vcc, -1, v55
    s_bitset0_b32 s15, s41
    s_and_b64 vcc, vcc, s[18:19]
    s_cbranch_scc1 L_od1_6
    v_mfma_f32_32x32x16_bf16 v[100:115], v[56:59], v[52:55], v[100:115]
    s_bitset1_b32 s20, s41
L_od1_6:
    s_cmp_le_u32 s12, 6
    s_cbranch_scc1 L_od1_8
    v_cmp_eq_u32 vcc, -1, v63
    s_bitset0_b32 s15, s42
    s_and_b64 vcc, vcc, s[18:19]
    s_cbranch_scc1 L_od1_7
    v_mfma_f32_32x32x16_bf16 v[100:115], v[64:67], v[60:63], v[100:115]
    s_bitset1_b32 s20, s42
L_od1_7:
    s_cmp_le_u32 s12, 7
    s_cbranch_scc1 L_od1_8
    v_cmp_eq_u32 vcc, -1, v71
    s_bitset0_b32 s15, s43
    s_and_b64 vcc, vcc, s[18:19]
    s_cbranch_scc1 L_od1_8
    v_mfma_f32_32x32x16_bf16 v[100:115], v[72:75], v[68:71], v[100:115]
    s_bitset1_b32 s20, s43
L_od1_8:
    s_or_b32 s15, s15, s20
    s_cmp_eq_u32 s20, -1
    s_cbranch_scc0 L_ot0
L_oend:
    s_nop 8
    v_cvt_pk_bf16_f32 v28, v100, v101
    v_cvt_pk_bf16_f32 v29, v102, v103
    v_cvt_pk_bf16_f32 v30, v104, v105
    v_cvt_pk_bf16_f32 v31, v106, v107
    v_cvt_pk_bf16_f32 v32, v108, v109
    v_permlane32_swap_b32 v28, v30
    v_permlane32_swap_b32 v29, v31
    v_cvt_pk_bf16_f32 v33, v110, v111
    v_cvt_pk_bf16_f32 v34, v112, v113
    v_cvt_pk_bf16_f32 v35, v114, v115
    s_add_u32 s8, s75, 16384
    s_nop 0
    v_permlane32_swap_b32 v32, v34
    v_permlane32_swap_b32 v33, v35
    s_nop 1
    v_permlane16_swap_b32 v28, v32
    v_permlane16_swap_b32 v29, v33
    v_permlane16_swap_b32 v30, v34
    v_permlane16_swap_b32 v31, v35
    s_nop 0
    buffer_store_dwordx4 v[28:31], v8, s[52:55], s75 offen sc1
    buffer_store_dwordx4 v[32:35], v8, s[52:55], s8 offen sc1
    s_waitcnt lgkmcnt(0)
    s_endpgm
L_ow0_0:
    s_mov_b32 s12, 0
    s_waitcnt vmcnt(0)
    s_branch L_od0
L_ow0_1:
    s_mov_b32 s12, 1
    s_waitcnt vmcnt(1)
    s_branch L_od0
L_ow0_2:
    s_mov_b32 s12, 2
    s_waitcnt vmcnt(2)
    s_branch L_od0
L_ow0_3:
    s_mov_b32 s12, 3
    s_waitcnt vmcnt(3)
    s_branch L_od0
L_ow0_4:
    s_mov_b32 s12, 4
    s_waitcnt vmcnt(4)
    s_branch L_od0
L_ow0_5:
    s_mov_b32 s12, 5
    s_waitcnt vmcnt(5)
    s_branch L_od0
L_ow0_6:
    s_mov_b32 s12, 6
    s_waitcnt vmcnt(6)
    s_branch L_od0
L_ow0_7:
    s_mov_b32 s12, 7
    s_waitcnt vmcnt(7)
    s_branch L_od0
L_of0:
    v_max3_u32 v166, v79, v87, v95
    v_max3_u32 v167, v119, v127, v135
    v_max3_u32 v166, v166, v143, v151
    v_max_u32 v166, v166, v167
    v_cmp_eq_u32 vcc, -1, v166
    s_cbranch_vccnz L_od0_0
    v_mfma_f32_32x32x16_bf16 v[100:115], v[80:83], v[76:79], v[100:115]
    s_or_b32 s20, s20, s14
    s_andn2_b32 s14, s15, s20
    s_waitcnt lgkmcnt(0)
    s_orn2_b32 s9, s23, s18
    s_cmp_eq_u32 s9, -1
    s_cbranch_scc1 L_ofp0
    s_load_dword s23, s[66:67], 0 glc
L_ofp0:
    v_mfma_f32_32x32x16_bf16 v[100:115], v[88:91], v[84:87], v[100:115]
    s_andn2_b32 s21, s9, s15
    s_bcnt1_i32_b32 s8, s21
    s_cmp_lt_u32 s8, 8
    s_cbranch_scc1 L_ofr0
    s_or_b32 s15, s15, s9
    s_ff1_i32_b32 s44, s21
    s_lshl_b32 s8, s44, 10
    buffer_load_dwordx4 v[76:79], v3, s[32:35], s8 offen sc1
    v_lshl_add_u32 v164, s8, 1, v10
    s_bitset0_b32 s21, s44
    ds_read_b64_tr_b16 v[80:81], v164 offset:0
    ds_read_b64_tr_b16 v[82:83], v164 offset:1024
    v_mfma_f32_32x32x16_bf16 v[100:115], v[96:99], v[92:95], v[100:115]
    s_ff1_i32_b32 s45, s21
    s_lshl_b32 s8, s45, 10
    buffer_load_dwordx4 v[84:87], v3, s[32:35], s8 offen sc1
    v_lshl_add_u32 v165, s8, 1, v10
    s_bitset0_b32 s21, s45
    ds_read_b64_tr_b16 v[88:89], v165 offset:0
    ds_read_b64_tr_b16 v[90:91], v165 offset:1024
    v_mfma_f32_32x32x16_bf16 v[100:115], v[120:123], v[116:119], v[100:115]
    s_ff1_i32_b32 s46, s21
    s_lshl_b32 s8, s46, 10
    buffer_load_dwordx4 v[92:95], v3, s[32:35], s8 offen sc1
    v_lshl_add_u32 v164, s8, 1, v10
    s_bitset0_b32 s21, s46
    ds_read_b64_tr_b16 v[96:97], v164 offset:0
    ds_read_b64_tr_b16 v[98:99], v164 offset:1024
    v_mfma_f32_32x32x16_bf16 v[100:115], v[128:131], v[124:127], v[100:115]
    s_ff1_i32_b32 s47, s21
    s_lshl_b32 s8, s47, 10
    buffer_load_dwordx4 v[116:119], v3, s[32:35], s8 offen sc1
    v_lshl_add_u32 v165, s8, 1, v10
    s_bitset0_b32 s21, s47
    ds_read_b64_tr_b16 v[120:121], v165 offset:0
    ds_read_b64_tr_b16 v[122:123], v165 offset:1024
    v_mfma_f32_32x32x16_bf16 v[100:115], v[136:139], v[132:135], v[100:115]
    s_ff1_i32_b32 s48, s21
    s_lshl_b32 s8, s48, 10
    buffer_load_dwordx4 v[124:127], v3, s[32:35], s8 offen sc1
    v_lshl_add_u32 v164, s8, 1, v10
    s_bitset0_b32 s21, s48
    ds_read_b64_tr_b16 v[128:129], v164 offset:0
    ds_read_b64_tr_b16 v[130:131], v164 offset:1024
    v_mfma_f32_32x32x16_bf16 v[100:115], v[144:147], v[140:143], v[100:115]
    s_ff1_i32_b32 s49, s21
    s_lshl_b32 s8, s49, 10
    buffer_load_dwordx4 v[132:135], v3, s[32:35], s8 offen sc1
    v_lshl_add_u32 v165, s8, 1, v10
    s_bitset0_b32 s21, s49
    ds_read_b64_tr_b16 v[136:137], v165 offset:0
    ds_read_b64_tr_b16 v[138:139], v165 offset:1024
    v_mfma_f32_32x32x16_bf16 v[100:115], v[152:155], v[148:151], v[100:115]
    s_ff1_i32_b32 s50, s21
    s_lshl_b32 s8, s50, 10
    buffer_load_dwordx4 v[140:143], v3, s[32:35], s8 offen sc1
    v_lshl_add_u32 v164, s8, 1, v10
    s_bitset0_b32 s21, s50
    ds_read_b64_tr_b16 v[144:145], v164 offset:0
    ds_read_b64_tr_b16 v[146:147], v164 offset:1024
    s_ff1_i32_b32 s51, s21
    s_lshl_b32 s8, s51, 10
    buffer_load_dwordx4 v[148:151], v3, s[32:35], s8 offen sc1
    v_lshl_add_u32 v165, s8, 1, v10
    s_bitset0_b32 s21, s51
    ds_read_b64_tr_b16 v[152:153], v165 offset:0
    ds_read_b64_tr_b16 v[154:155], v165 offset:1024
    s_andn2_b32 s15, s15, s21
    s_waitcnt vmcnt(8)
    s_branch L_od1
L_ofr0:
    v_mfma_f32_32x32x16_bf16 v[100:115], v[96:99], v[92:95], v[100:115]
    v_mfma_f32_32x32x16_bf16 v[100:115], v[120:123], v[116:119], v[100:115]
    v_mfma_f32_32x32x16_bf16 v[100:115], v[128:131], v[124:127], v[100:115]
    v_mfma_f32_32x32x16_bf16 v[100:115], v[136:139], v[132:135], v[100:115]
    v_mfma_f32_32x32x16_bf16 v[100:115], v[144:147], v[140:143], v[100:115]
    v_mfma_f32_32x32x16_bf16 v[100:115], v[152:155], v[148:151], v[100:115]
    s_cmp_eq_u32 s20, -1
    s_cbranch_scc0 L_onp1
    s_nop 0
    s_branch L_oend
L_ow1_0:
    s_mov_b32 s13, 0
    s_waitcnt vmcnt(0)
    s_branch L_od1
L_ow1_1:
    s_mov_b32 s13, 1
    s_waitcnt vmcnt(1)
    s_branch L_od1
L_ow1_2:
    s_mov_b32 s13, 2
    s_waitcnt vmcnt(2)
    s_branch L_od1
L_ow1_3:
    s_mov_b32 s13, 3
    s_waitcnt vmcnt(3)
    s_branch L_od1
L_ow1_4:
    s_mov_b32 s13, 4
    s_waitcnt vmcnt(4)
    s_branch L_od1
L_ow1_5:
    s_mov_b32 s13, 5
    s_waitcnt vmcnt(5)
    s_branch L_od1
L_ow1_6:
    s_mov_b32 s13, 6
    s_waitcnt vmcnt(6)
    s_branch L_od1
L_ow1_7:
    s_mov_b32 s13, 7
    s_waitcnt vmcnt(7)
    s_branch L_od1
L_of1:
    v_max3_u32 v166, v15, v23, v31
    v_max3_u32 v167, v39, v47, v55
    v_max3_u32 v166, v166, v63, v71
    v_max_u32 v166, v166, v167
    v_cmp_eq_u32 vcc, -1, v166
    s_cbranch_vccnz L_od1_0
    v_mfma_f32_32x32x16_bf16 v[100:115], v[16:19], v[12:15], v[100:115]
    s_or_b32 s20, s20, s14
    s_andn2_b32 s14, s15, s20
    s_waitcnt lgkmcnt(0)
    s_orn2_b32 s9, s23, s18
    s_cmp_eq_u32 s9, -1
    s_cbranch_scc1 L_ofp1
    s_load_dword s23, s[66:67], 0 glc
L_ofp1:
    v_mfma_f32_32x32x16_bf16 v[100:115], v[24:27], v[20:23], v[100:115]
    s_andn2_b32 s21, s9, s15
    s_bcnt1_i32_b32 s8, s21
    s_cmp_lt_u32 s8, 8
    s_cbranch_scc1 L_ofr1
    s_or_b32 s15, s15, s9
    s_ff1_i32_b32 s36, s21
    s_lshl_b32 s8, s36, 10
    buffer_load_dwordx4 v[12:15], v3, s[32:35], s8 offen sc1
    v_lshl_add_u32 v164, s8, 1, v10
    s_bitset0_b32 s21, s36
    ds_read_b64_tr_b16 v[16:17], v164 offset:0
    ds_read_b64_tr_b16 v[18:19], v164 offset:1024
    v_mfma_f32_32x32x16_bf16 v[100:115], v[32:35], v[28:31], v[100:115]
    s_ff1_i32_b32 s37, s21
    s_lshl_b32 s8, s37, 10
    buffer_load_dwordx4 v[20:23], v3, s[32:35], s8 offen sc1
    v_lshl_add_u32 v165, s8, 1, v10
    s_bitset0_b32 s21, s37
    ds_read_b64_tr_b16 v[24:25], v165 offset:0
    ds_read_b64_tr_b16 v[26:27], v165 offset:1024
    v_mfma_f32_32x32x16_bf16 v[100:115], v[40:43], v[36:39], v[100:115]
    s_ff1_i32_b32 s38, s21
    s_lshl_b32 s8, s38, 10
    buffer_load_dwordx4 v[28:31], v3, s[32:35], s8 offen sc1
    v_lshl_add_u32 v164, s8, 1, v10
    s_bitset0_b32 s21, s38
    ds_read_b64_tr_b16 v[32:33], v164 offset:0
    ds_read_b64_tr_b16 v[34:35], v164 offset:1024
    v_mfma_f32_32x32x16_bf16 v[100:115], v[48:51], v[44:47], v[100:115]
    s_ff1_i32_b32 s39, s21
    s_lshl_b32 s8, s39, 10
    buffer_load_dwordx4 v[36:39], v3, s[32:35], s8 offen sc1
    v_lshl_add_u32 v165, s8, 1, v10
    s_bitset0_b32 s21, s39
    ds_read_b64_tr_b16 v[40:41], v165 offset:0
    ds_read_b64_tr_b16 v[42:43], v165 offset:1024
    v_mfma_f32_32x32x16_bf16 v[100:115], v[56:59], v[52:55], v[100:115]
    s_ff1_i32_b32 s40, s21
    s_lshl_b32 s8, s40, 10
    buffer_load_dwordx4 v[44:47], v3, s[32:35], s8 offen sc1
    v_lshl_add_u32 v164, s8, 1, v10
    s_bitset0_b32 s21, s40
    ds_read_b64_tr_b16 v[48:49], v164 offset:0
    ds_read_b64_tr_b16 v[50:51], v164 offset:1024
    v_mfma_f32_32x32x16_bf16 v[100:115], v[64:67], v[60:63], v[100:115]
    s_ff1_i32_b32 s41, s21
    s_lshl_b32 s8, s41, 10
    buffer_load_dwordx4 v[52:55], v3, s[32:35], s8 offen sc1
    v_lshl_add_u32 v165, s8, 1, v10
    s_bitset0_b32 s21, s41
    ds_read_b64_tr_b16 v[56:57], v165 offset:0
    ds_read_b64_tr_b16 v[58:59], v165 offset:1024
    v_mfma_f32_32x32x16_bf16 v[100:115], v[72:75], v[68:71], v[100:115]
    s_ff1_i32_b32 s42, s21
    s_lshl_b32 s8, s42, 10
    buffer_load_dwordx4 v[60:63], v3, s[32:35], s8 offen sc1
    v_lshl_add_u32 v164, s8, 1, v10
    s_bitset0_b32 s21, s42
    ds_read_b64_tr_b16 v[64:65], v164 offset:0
    ds_read_b64_tr_b16 v[66:67], v164 offset:1024
    s_ff1_i32_b32 s43, s21
    s_lshl_b32 s8, s43, 10
    buffer_load_dwordx4 v[68:71], v3, s[32:35], s8 offen sc1
    v_lshl_add_u32 v165, s8, 1, v10
    s_bitset0_b32 s21, s43
    ds_read_b64_tr_b16 v[72:73], v165 offset:0
    ds_read_b64_tr_b16 v[74:75], v165 offset:1024
    s_andn2_b32 s15, s15, s21
    s_waitcnt vmcnt(8)
    s_branch L_od0
L_ofr1:
    v_mfma_f32_32x32x16_bf16 v[100:115], v[32:35], v[28:31], v[100:115]
    v_mfma_f32_32x32x16_bf16 v[100:115], v[40:43], v[36:39], v[100:115]
    v_mfma_f32_32x32x16_bf16 v[100:115], v[48:51], v[44:47], v[100:115]
    v_mfma_f32_32x32x16_bf16 v[100:115], v[56:59], v[52:55], v[100:115]
    v_mfma_f32_32x32x16_bf16 v[100:115], v[64:67], v[60:63], v[100:115]
    v_mfma_f32_32x32x16_bf16 v[100:115], v[72:75], v[68:71], v[100:115]
    s_cmp_eq_u32 s20, -1
    s_cbranch_scc0 L_onp0
    s_nop 0
    s_branch L_oend
L_last:
    s_endpgm

.section .rodata,"a"
.p2align 6
.amdhsa_kernel parallel_sum__mha_block__geglu_ffn__prompt_kernel
  .amdhsa_next_free_vgpr 168
  .amdhsa_next_free_sgpr 102
  .amdhsa_accum_offset 168
  .amdhsa_group_segment_fixed_size 0
  .amdhsa_kernarg_size 80
  .amdhsa_user_sgpr_count 2
  .amdhsa_user_sgpr_kernarg_segment_ptr 1
  .amdhsa_system_sgpr_workgroup_id_x 1
.end_amdhsa_kernel
```
